```python
import torch

def _softmax(x, axis=-1):
    return torch.softmax(x, dim=axis)
def _gelu(x):
    return torch.nn.functional.gelu(x, approximate="tanh")
def _silu(x):
    return torch.nn.functional.silu(x)
def _sigmoid(x):
    return torch.sigmoid(x)
def _layernorm(x, axis=-1, eps=1e-5):
    m = x.mean(dim=axis, keepdim=True)
    v = x.var(dim=axis, keepdim=True, unbiased=False)
    return (x - m) / torch.sqrt(v + eps)
def _scatter_add(tgt, idx, src, axis=0):
    return tgt.clone().index_add_(axis, idx, src)
def _segment_sum(src, seg, n):
    out = torch.zeros((n,) + src.shape[1:], dtype=src.dtype)
    return out.index_add_(0, seg, src)
def _pad(x, pw):
    flat = tuple(v for pair in reversed(pw) for v in pair)
    return torch.nn.functional.pad(x, flat)

kernel_name = 'standalone__paged_block_table_kv_pagedattention__prompt'

def setup_inputs():

    _w = (lambda a: (lambda t: t.to(torch.bfloat16) if t.is_floating_point() else t)(torch.as_tensor(a)))
    B, Hq, Hkv, Sq, Skv, D = 1, 16, 8, 2048, 2048, 256
    bs = 16
    nbps = max(1, Skv // bs)
    num_phys = B * nbps + 4
    bt = torch.randperm(num_phys)[: B * nbps].reshape(B, nbps).to(torch.int64)
    cl = (nbps * bs - (torch.arange(1, B + 1, dtype=torch.int64) * 2654435761) % max(1, nbps * bs // 2)).to(torch.int64)
    return {
        "q": _w((lambda *s: torch.randn(*s, dtype=torch.bfloat16) * 0.8)(B, Hq, Sq, D)),
        "k_cache": _w((lambda *s: torch.randn(*s, dtype=torch.bfloat16) * 0.8)(num_phys, bs, Hkv, D)),
        "v_cache": _w((lambda *s: torch.randn(*s, dtype=torch.bfloat16) * 0.05)(num_phys, bs, Hkv, D)),
        "block_table": _w(bt),
        "context_lens": _w(cl),
    }

def reference(q, k_cache, v_cache, block_table, context_lens):
    B, Hq, Sq, D = q.shape
    bs = k_cache.shape[1]
    Hkv = k_cache.shape[2]
    nbps = block_table.shape[1]
    Skv = nbps * bs
    bt = block_table.reshape(-1)
    k = (lambda x, *d: x.permute(*d))(k_cache[bt].reshape(B, Skv, Hkv, D), 0, 2, 1, 3)
    v = (lambda x, *d: x.permute(*d))(v_cache[bt].reshape(B, Skv, Hkv, D), 0, 2, 1, 3)
    g = Hq // Hkv
    qg = q.reshape(B, Hkv, g, Sq, D)
    scores = torch.einsum("bhgqd,bhkd->bhgqk", qg, k) * (D ** -0.5)
    pos = torch.arange(Skv)
    msk = pos[None, :] < context_lens[:, None]
    scores = torch.where(msk[:, None, None, None, :], scores, -1e9)
    p = _softmax(scores, axis=-1)
    out = torch.einsum("bhgqk,bhkd->bhgqd", p, v)
    return out.reshape(B, Hq, Sq, D)
```

```asm
; @launch grid=(256,1,1) block=(256,1,1) lds=163840
.amdgcn_target "amdgcn-amd-amdhsa--gfx950"
.text
.globl standalone__paged_block_table_kv_pagedattention__prompt_kernel
.p2align 8
.type standalone__paged_block_table_kv_pagedattention__prompt_kernel,@function
standalone__paged_block_table_kv_pagedattention__prompt_kernel:
    s_cmp_ge_u32 s2, 256
    s_cbranch_scc1 L_end
    s_load_dwordx8 s[4:11], s[0:1], 0
    s_load_dwordx8 s[12:19], s[0:1], 32
    s_getpc_b64 s[42:43]
L_pf:
    v_lshlrev_b32 v230, 7, v0
    global_load_dword v231, v230, s[42:43]
    v_and_b32 v216, 63, v0
    v_lshrrev_b32 v217, 6, v0
    s_nop 0
    v_readfirstlane_b32 s49, v217
    s_and_b32 s54, s2, 7
    s_lshr_b32 s55, s2, 3
    s_lshl_b32 s56, s54, 12
    s_lshl_b32 s55, s55, 7
    s_add_u32 s56, s56, s55
    s_lshl_b32 s55, s49, 5
    s_add_u32 s56, s56, s55
    s_lshl_b32 s58, s56, 9
    s_add_u32 s59, s58, 8192
    s_lshl_b32 s52, s49, 12
    v_and_b32 v218, 15, v216
    v_lshrrev_b32 v219, 4, v216
    v_lshlrev_b32 v220, 9, v218
    v_lshl_add_u32 v220, v219, 4, v220
    s_lshr_b32 s55, s49, 1
    s_lshl_b32 s55, s55, 2
    v_lshlrev_b32 v221, 3, v216
    v_add_u32 v221, s55, v221
    s_waitcnt lgkmcnt(0)
    s_mov_b32 s32, s10
    s_and_b32 s33, s11, 0xffff
    s_mov_b32 s34, 0x200
    s_mov_b32 s35, 0x20000
    buffer_load_dword v196, v221, s[32:35], 0 offen
    s_load_dword s44, s[12:13], 0
    s_mov_b32 s20, s4
    s_and_b32 s21, s5, 0xffff
    s_mov_b32 s22, 0x1000000
    s_mov_b32 s23, 0x20000
    buffer_load_dwordx4 v[128:131], v220, s[20:23], s58 offen nt
    buffer_load_dwordx4 v[132:135], v220, s[20:23], s58 offen offset:64 nt
    buffer_load_dwordx4 v[136:139], v220, s[20:23], s58 offen offset:128 nt
    buffer_load_dwordx4 v[140:143], v220, s[20:23], s58 offen offset:192 nt
    buffer_load_dwordx4 v[144:147], v220, s[20:23], s58 offen offset:256 nt
    buffer_load_dwordx4 v[148:151], v220, s[20:23], s58 offen offset:320 nt
    buffer_load_dwordx4 v[152:155], v220, s[20:23], s58 offen offset:384 nt
    buffer_load_dwordx4 v[156:159], v220, s[20:23], s58 offen offset:448 nt
    buffer_load_dwordx4 v[160:163], v220, s[20:23], s59 offen nt
    buffer_load_dwordx4 v[164:167], v220, s[20:23], s59 offen offset:64 nt
    buffer_load_dwordx4 v[168:171], v220, s[20:23], s59 offen offset:128 nt
    buffer_load_dwordx4 v[172:175], v220, s[20:23], s59 offen offset:192 nt
    buffer_load_dwordx4 v[240:243], v220, s[20:23], s59 offen offset:256 nt
    buffer_load_dwordx4 v[244:247], v220, s[20:23], s59 offen offset:320 nt
    buffer_load_dwordx4 v[248:251], v220, s[20:23], s59 offen offset:384 nt
    buffer_load_dwordx4 v[252:255], v220, s[20:23], s59 offen offset:448 nt
    s_mov_b32 s24, s6
    s_and_b32 s25, s7, 0xffff
    s_mov_b32 s26, 0x840000
    s_mov_b32 s27, 0x20000
    s_mov_b32 s28, s8
    s_and_b32 s29, s9, 0xffff
    s_mov_b32 s30, 0x840000
    s_mov_b32 s31, 0x20000
    s_add_u32 s60, s52, 0
    s_add_u32 s61, s52, 16384
    s_add_u32 s62, s52, 32768
    s_add_u32 s63, s52, 49152
    s_add_u32 s64, s52, 65536
    s_add_u32 s65, s52, 81920
    s_add_u32 s66, s52, 98304
    s_add_u32 s67, s52, 114688
    v_and_b32 v226, 31, v216
    v_lshrrev_b32 v227, 5, v216
    s_and_b32 s55, s49, 1
    s_lshl_b32 s55, s55, 3
    s_lshl_b32 s54, s54, 9
    v_add_u32 v222, s55, v227
    v_lshlrev_b32 v223, 12, v222
    v_add_u32 v223, s54, v223
    v_xor_b32 v224, v222, v226
    v_lshl_add_u32 v188, v224, 4, v223
    v_and_b32 v224, 4, v222
    v_and_b32 v225, 3, v222
    v_lshl_or_b32 v224, v224, 1, v225
    v_xor_b32 v224, v224, v226
    v_lshl_add_u32 v192, v224, 4, v223
    v_add_u32 v222, s55, v227
    v_add_u32 v222, 2, v222
    v_lshlrev_b32 v223, 12, v222
    v_add_u32 v223, s54, v223
    v_subrev_u32 v223, 1024, v223
    v_xor_b32 v224, v222, v226
    v_lshl_add_u32 v189, v224, 4, v223
    v_and_b32 v224, 4, v222
    v_and_b32 v225, 3, v222
    v_lshl_or_b32 v224, v224, 1, v225
    v_xor_b32 v224, v224, v226
    v_lshl_add_u32 v193, v224, 4, v223
    v_add_u32 v222, s55, v227
    v_add_u32 v222, 4, v222
    v_lshlrev_b32 v223, 12, v222
    v_add_u32 v223, s54, v223
    v_subrev_u32 v223, 2048, v223
    v_xor_b32 v224, v222, v226
    v_lshl_add_u32 v190, v224, 4, v223
    v_and_b32 v224, 4, v222
    v_and_b32 v225, 3, v222
    v_lshl_or_b32 v224, v224, 1, v225
    v_xor_b32 v224, v224, v226
    v_lshl_add_u32 v194, v224, 4, v223
    v_add_u32 v222, s55, v227
    v_add_u32 v222, 6, v222
    v_lshlrev_b32 v223, 12, v222
    v_add_u32 v223, s54, v223
    v_subrev_u32 v223, 3072, v223
    v_xor_b32 v224, v222, v226
    v_lshl_add_u32 v191, v224, 4, v223
    v_and_b32 v224, 4, v222
    v_and_b32 v225, 3, v222
    v_lshl_or_b32 v224, v224, 1, v225
    v_xor_b32 v224, v224, v226
    v_lshl_add_u32 v195, v224, 4, v223
    s_waitcnt lgkmcnt(0)
    s_mov_b32 s47, 0x3db8aa3b
    s_cmp_lt_i32 s44, 1
    s_cselect_b32 s47, 0, s47
    s_cselect_b32 s44, 2048, s44
    s_min_u32 s44, s44, 2048
    s_add_u32 s45, s44, 31
    s_lshr_b32 s45, s45, 5
    s_sub_u32 s54, s45, 1
    s_max_u32 s101, s45, 4
    s_sub_u32 s101, s101, 2
    v_mov_b32 v228, 0x40000000
    v_cmp_gt_u32 vcc, s54, v216
    s_lshr_b32 s55, s2, 3
    s_and_b32 s55, s55, 1
    s_mul_i32 s55, s55, s54
    s_lshr_b32 s55, s55, 1
    v_add_u32 v229, s55, v216
    v_subrev_u32 v225, s54, v229
    v_min_u32 v229, v229, v225
    v_lshlrev_b32 v229, 2, v229
    s_mov_b32 s36, s14
    s_and_b32 s37, s15, 0xffff
    s_mov_b32 s38, 0x1000000
    s_mov_b32 s39, 0x20000
    v_xor_b32 v222, v218, v219
    v_lshlrev_b32 v223, 9, v218
    v_xor_b32 v224, 0, v222
    v_lshl_add_u32 v176, v224, 4, v223
    v_xor_b32 v224, 4, v222
    v_lshl_add_u32 v177, v224, 4, v223
    v_xor_b32 v224, 8, v222
    v_lshl_add_u32 v178, v224, 4, v223
    v_xor_b32 v224, 12, v222
    v_lshl_add_u32 v179, v224, 4, v223
    v_lshrrev_b32 v222, 2, v216
    v_lshlrev_b32 v223, 9, v222
    v_and_b32 v224, 1, v216
    v_lshl_add_u32 v223, v224, 3, v223
    v_add_u32 v223, 0x10000, v223
    v_and_b32 v224, 4, v222
    v_and_b32 v222, 3, v222
    v_lshl_or_b32 v222, v224, 1, v222
    v_and_b32 v224, 2, v216
    v_lshl_or_b32 v222, v224, 1, v222
    v_xor_b32 v224, 0, v222
    v_lshl_add_u32 v180, v224, 4, v223
    v_xor_b32 v224, 1, v222
    v_lshl_add_u32 v181, v224, 4, v223
    v_xor_b32 v224, 2, v222
    v_lshl_add_u32 v182, v224, 4, v223
    v_xor_b32 v224, 3, v222
    v_lshl_add_u32 v183, v224, 4, v223
    v_xor_b32 v224, 8, v222
    v_lshl_add_u32 v184, v224, 4, v223
    v_xor_b32 v224, 9, v222
    v_lshl_add_u32 v185, v224, 4, v223
    v_xor_b32 v224, 10, v222
    v_lshl_add_u32 v186, v224, 4, v223
    v_xor_b32 v224, 11, v222
    v_lshl_add_u32 v187, v224, 4, v223
    v_mov_b32 v0, 0
    v_mov_b32 v1, 0
    v_mov_b32 v2, 0
    v_mov_b32 v3, 0
    v_mov_b32 v4, 0
    v_mov_b32 v5, 0
    v_mov_b32 v6, 0
    v_mov_b32 v7, 0
    v_mov_b32 v8, 0
    v_mov_b32 v9, 0
    v_mov_b32 v10, 0
    v_mov_b32 v11, 0
    v_mov_b32 v12, 0
    v_mov_b32 v13, 0
    v_mov_b32 v14, 0
    v_mov_b32 v15, 0
    v_mov_b32 v16, 0
    v_mov_b32 v17, 0
    v_mov_b32 v18, 0
    v_mov_b32 v19, 0
    v_mov_b32 v20, 0
    v_mov_b32 v21, 0
    v_mov_b32 v22, 0
    v_mov_b32 v23, 0
    v_mov_b32 v24, 0
    v_mov_b32 v25, 0
    v_mov_b32 v26, 0
    v_mov_b32 v27, 0
    v_mov_b32 v28, 0
    v_mov_b32 v29, 0
    v_mov_b32 v30, 0
    v_mov_b32 v31, 0
    v_mov_b32 v32, 0
    v_mov_b32 v33, 0
    v_mov_b32 v34, 0
    v_mov_b32 v35, 0
    v_mov_b32 v36, 0
    v_mov_b32 v37, 0
    v_mov_b32 v38, 0
    v_mov_b32 v39, 0
    v_mov_b32 v40, 0
    v_mov_b32 v41, 0
    v_mov_b32 v42, 0
    v_mov_b32 v43, 0
    v_mov_b32 v44, 0
    v_mov_b32 v45, 0
    v_mov_b32 v46, 0
    v_mov_b32 v47, 0
    v_mov_b32 v48, 0
    v_mov_b32 v49, 0
    v_mov_b32 v50, 0
    v_mov_b32 v51, 0
    v_mov_b32 v52, 0
    v_mov_b32 v53, 0
    v_mov_b32 v54, 0
    v_mov_b32 v55, 0
    v_mov_b32 v56, 0
    v_mov_b32 v57, 0
    v_mov_b32 v58, 0
    v_mov_b32 v59, 0
    v_mov_b32 v60, 0
    v_mov_b32 v61, 0
    v_mov_b32 v62, 0
    v_mov_b32 v63, 0
    v_mov_b32 v64, 0
    v_mov_b32 v65, 0
    v_mov_b32 v66, 0
    v_mov_b32 v67, 0
    v_mov_b32 v68, 0
    v_mov_b32 v69, 0
    v_mov_b32 v70, 0
    v_mov_b32 v71, 0
    v_mov_b32 v72, 0
    v_mov_b32 v73, 0
    v_mov_b32 v74, 0
    v_mov_b32 v75, 0
    v_mov_b32 v76, 0
    v_mov_b32 v77, 0
    v_mov_b32 v78, 0
    v_mov_b32 v79, 0
    v_mov_b32 v80, 0
    v_mov_b32 v81, 0
    v_mov_b32 v82, 0
    v_mov_b32 v83, 0
    v_mov_b32 v84, 0
    v_mov_b32 v85, 0
    v_mov_b32 v86, 0
    v_mov_b32 v87, 0
    v_mov_b32 v88, 0
    v_mov_b32 v89, 0
    v_mov_b32 v90, 0
    v_mov_b32 v91, 0
    v_mov_b32 v92, 0
    v_mov_b32 v93, 0
    v_mov_b32 v94, 0
    v_mov_b32 v95, 0
    v_mov_b32 v96, 0
    v_mov_b32 v97, 0
    v_mov_b32 v98, 0
    v_mov_b32 v99, 0
    v_mov_b32 v100, 0
    v_mov_b32 v101, 0
    v_mov_b32 v102, 0
    v_mov_b32 v103, 0
    v_mov_b32 v104, 0
    v_mov_b32 v105, 0
    v_mov_b32 v106, 0
    v_mov_b32 v107, 0
    v_mov_b32 v108, 0
    v_mov_b32 v109, 0
    v_mov_b32 v110, 0
    v_mov_b32 v111, 0
    v_mov_b32 v112, 0
    v_mov_b32 v113, 0
    v_mov_b32 v114, 0
    v_mov_b32 v115, 0
    v_mov_b32 v116, 0
    v_mov_b32 v117, 0
    v_mov_b32 v118, 0
    v_mov_b32 v119, 0
    v_mov_b32 v120, 0
    v_mov_b32 v121, 0
    v_mov_b32 v122, 0
    v_mov_b32 v123, 0
    v_mov_b32 v124, 0
    v_mov_b32 v125, 0
    v_mov_b32 v126, 0
    v_mov_b32 v127, 0
    v_mov_b32 v200, 0
    v_mov_b32 v201, 0
    v_mov_b32 v202, 0
    v_mov_b32 v203, 0
    v_mov_b32 v204, 0
    v_mov_b32 v205, 0
    v_mov_b32 v206, 0
    v_mov_b32 v207, 0
    v_mov_b32 v224, 0x3f803f80
    v_accvgpr_write_b32 a128, v224
    v_accvgpr_write_b32 a129, v224
    v_accvgpr_write_b32 a130, v224
    v_accvgpr_write_b32 a131, v224
    s_mov_b32 s48, 0x40004000
    s_mov_b32 s46, 1
    s_lshl_b32 s53, s54, 5
    s_sub_u32 s53, s44, s53
    v_lshlrev_b32 v222, 2, v219
    v_sub_u32 v222, s53, v222
    v_mov_b32 v223, 0xf149f2ca
    v_cmp_lt_i32 s[84:85], 0, v222
    v_cmp_lt_i32 s[86:87], 1, v222
    v_cmp_lt_i32 s[88:89], 2, v222
    v_cmp_lt_i32 s[90:91], 3, v222
    v_cmp_lt_i32 s[92:93], 16, v222
    v_cmp_lt_i32 s[94:95], 17, v222
    v_cmp_lt_i32 s[96:97], 18, v222
    v_cmp_lt_i32 s[98:99], 19, v222
    v_mov_b32 v214, s47
    v_mov_b32 v215, s47
    s_waitcnt vmcnt(16)
    v_lshlrev_b32 v196, 16, v196
    s_nop 0
    v_readlane_b32 s50, v196, s54
    ds_bpermute_b32 v196, v229, v196
    s_nop 3
    s_mov_b32 m0, s60
    s_nop 0
    buffer_load_dwordx4 v188, s[24:27], s50 offen lds
    buffer_load_dwordx4 v189, s[24:27], s50 offen offset:1024 lds
    buffer_load_dwordx4 v190, s[24:27], s50 offen offset:2048 lds
    buffer_load_dwordx4 v191, s[24:27], s50 offen offset:3072 lds
    s_waitcnt lgkmcnt(0)
    v_cndmask_b32 v196, v228, v196, vcc
    s_nop 0
    v_readlane_b32 s55, v196, 0
    v_readlane_b32 s56, v196, 1
    v_readlane_b32 s57, v196, 2
    s_waitcnt vmcnt(19)
    v_lshlrev_b32 v208, 16, v128
    v_and_b32 v209, 0xffff0000, v128
    v_pk_mul_f32 v[208:209], v[208:209], v[214:215]
    v_cvt_pk_bf16_f32 v212, v208, v209
    v_accvgpr_write_b32 a0, v212
    v_lshlrev_b32 v210, 16, v129
    v_and_b32 v211, 0xffff0000, v129
    v_pk_mul_f32 v[210:211], v[210:211], v[214:215]
    v_cvt_pk_bf16_f32 v213, v210, v211
    v_accvgpr_write_b32 a1, v213
    v_lshlrev_b32 v208, 16, v130
    v_and_b32 v209, 0xffff0000, v130
    v_pk_mul_f32 v[208:209], v[208:209], v[214:215]
    v_cvt_pk_bf16_f32 v212, v208, v209
    v_accvgpr_write_b32 a2, v212
    v_lshlrev_b32 v210, 16, v131
    v_and_b32 v211, 0xffff0000, v131
    v_pk_mul_f32 v[210:211], v[210:211], v[214:215]
    v_cvt_pk_bf16_f32 v213, v210, v211
    v_accvgpr_write_b32 a3, v213
    s_waitcnt vmcnt(18)
    v_lshlrev_b32 v208, 16, v132
    v_and_b32 v209, 0xffff0000, v132
    v_pk_mul_f32 v[208:209], v[208:209], v[214:215]
    v_cvt_pk_bf16_f32 v212, v208, v209
    v_accvgpr_write_b32 a4, v212
    v_lshlrev_b32 v210, 16, v133
    v_and_b32 v211, 0xffff0000, v133
    v_pk_mul_f32 v[210:211], v[210:211], v[214:215]
    v_cvt_pk_bf16_f32 v213, v210, v211
    v_accvgpr_write_b32 a5, v213
    v_lshlrev_b32 v208, 16, v134
    v_and_b32 v209, 0xffff0000, v134
    v_pk_mul_f32 v[208:209], v[208:209], v[214:215]
    v_cvt_pk_bf16_f32 v212, v208, v209
    v_accvgpr_write_b32 a6, v212
    v_lshlrev_b32 v210, 16, v135
    v_and_b32 v211, 0xffff0000, v135
    v_pk_mul_f32 v[210:211], v[210:211], v[214:215]
    v_cvt_pk_bf16_f32 v213, v210, v211
    v_accvgpr_write_b32 a7, v213
    s_waitcnt vmcnt(17)
    v_lshlrev_b32 v208, 16, v136
    v_and_b32 v209, 0xffff0000, v136
    v_pk_mul_f32 v[208:209], v[208:209], v[214:215]
    v_cvt_pk_bf16_f32 v212, v208, v209
    v_accvgpr_write_b32 a8, v212
    v_lshlrev_b32 v210, 16, v137
    v_and_b32 v211, 0xffff0000, v137
    v_pk_mul_f32 v[210:211], v[210:211], v[214:215]
    v_cvt_pk_bf16_f32 v213, v210, v211
    v_accvgpr_write_b32 a9, v213
    v_lshlrev_b32 v208, 16, v138
    v_and_b32 v209, 0xffff0000, v138
    v_pk_mul_f32 v[208:209], v[208:209], v[214:215]
    v_cvt_pk_bf16_f32 v212, v208, v209
    v_accvgpr_write_b32 a10, v212
    v_lshlrev_b32 v210, 16, v139
    v_and_b32 v211, 0xffff0000, v139
    v_pk_mul_f32 v[210:211], v[210:211], v[214:215]
    v_cvt_pk_bf16_f32 v213, v210, v211
    v_accvgpr_write_b32 a11, v213
    s_waitcnt vmcnt(16)
    v_lshlrev_b32 v208, 16, v140
    v_and_b32 v209, 0xffff0000, v140
    v_pk_mul_f32 v[208:209], v[208:209], v[214:215]
    v_cvt_pk_bf16_f32 v212, v208, v209
    v_accvgpr_write_b32 a12, v212
    v_lshlrev_b32 v210, 16, v141
    v_and_b32 v211, 0xffff0000, v141
    v_pk_mul_f32 v[210:211], v[210:211], v[214:215]
    v_cvt_pk_bf16_f32 v213, v210, v211
    v_accvgpr_write_b32 a13, v213
    v_lshlrev_b32 v208, 16, v142
    v_and_b32 v209, 0xffff0000, v142
    v_pk_mul_f32 v[208:209], v[208:209], v[214:215]
    v_cvt_pk_bf16_f32 v212, v208, v209
    v_accvgpr_write_b32 a14, v212
    v_lshlrev_b32 v210, 16, v143
    v_and_b32 v211, 0xffff0000, v143
    v_pk_mul_f32 v[210:211], v[210:211], v[214:215]
    v_cvt_pk_bf16_f32 v213, v210, v211
    v_accvgpr_write_b32 a15, v213
    s_nop 2
    s_mov_b32 m0, s61
    s_nop 0
    buffer_load_dwordx4 v188, s[24:27], s55 offen lds
    buffer_load_dwordx4 v189, s[24:27], s55 offen offset:1024 lds
    buffer_load_dwordx4 v190, s[24:27], s55 offen offset:2048 lds
    buffer_load_dwordx4 v191, s[24:27], s55 offen offset:3072 lds
    s_waitcnt vmcnt(19)
    v_lshlrev_b32 v208, 16, v144
    v_and_b32 v209, 0xffff0000, v144
    v_pk_mul_f32 v[208:209], v[208:209], v[214:215]
    v_cvt_pk_bf16_f32 v212, v208, v209
    v_accvgpr_write_b32 a16, v212
    v_lshlrev_b32 v210, 16, v145
    v_and_b32 v211, 0xffff0000, v145
    v_pk_mul_f32 v[210:211], v[210:211], v[214:215]
    v_cvt_pk_bf16_f32 v213, v210, v211
    v_accvgpr_write_b32 a17, v213
    v_lshlrev_b32 v208, 16, v146
    v_and_b32 v209, 0xffff0000, v146
    v_pk_mul_f32 v[208:209], v[208:209], v[214:215]
    v_cvt_pk_bf16_f32 v212, v208, v209
    v_accvgpr_write_b32 a18, v212
    v_lshlrev_b32 v210, 16, v147
    v_and_b32 v211, 0xffff0000, v147
    v_pk_mul_f32 v[210:211], v[210:211], v[214:215]
    v_cvt_pk_bf16_f32 v213, v210, v211
    v_accvgpr_write_b32 a19, v213
    s_waitcnt vmcnt(18)
    v_lshlrev_b32 v208, 16, v148
    v_and_b32 v209, 0xffff0000, v148
    v_pk_mul_f32 v[208:209], v[208:209], v[214:215]
    v_cvt_pk_bf16_f32 v212, v208, v209
    v_accvgpr_write_b32 a20, v212
    v_lshlrev_b32 v210, 16, v149
    v_and_b32 v211, 0xffff0000, v149
    v_pk_mul_f32 v[210:211], v[210:211], v[214:215]
    v_cvt_pk_bf16_f32 v213, v210, v211
    v_accvgpr_write_b32 a21, v213
    v_lshlrev_b32 v208, 16, v150
    v_and_b32 v209, 0xffff0000, v150
    v_pk_mul_f32 v[208:209], v[208:209], v[214:215]
    v_cvt_pk_bf16_f32 v212, v208, v209
    v_accvgpr_write_b32 a22, v212
    v_lshlrev_b32 v210, 16, v151
    v_and_b32 v211, 0xffff0000, v151
    v_pk_mul_f32 v[210:211], v[210:211], v[214:215]
    v_cvt_pk_bf16_f32 v213, v210, v211
    v_accvgpr_write_b32 a23, v213
    s_waitcnt vmcnt(17)
    v_lshlrev_b32 v208, 16, v152
    v_and_b32 v209, 0xffff0000, v152
    v_pk_mul_f32 v[208:209], v[208:209], v[214:215]
    v_cvt_pk_bf16_f32 v212, v208, v209
    v_accvgpr_write_b32 a24, v212
    v_lshlrev_b32 v210, 16, v153
    v_and_b32 v211, 0xffff0000, v153
    v_pk_mul_f32 v[210:211], v[210:211], v[214:215]
    v_cvt_pk_bf16_f32 v213, v210, v211
    v_accvgpr_write_b32 a25, v213
    v_lshlrev_b32 v208, 16, v154
    v_and_b32 v209, 0xffff0000, v154
    v_pk_mul_f32 v[208:209], v[208:209], v[214:215]
    v_cvt_pk_bf16_f32 v212, v208, v209
    v_accvgpr_write_b32 a26, v212
    v_lshlrev_b32 v210, 16, v155
    v_and_b32 v211, 0xffff0000, v155
    v_pk_mul_f32 v[210:211], v[210:211], v[214:215]
    v_cvt_pk_bf16_f32 v213, v210, v211
    v_accvgpr_write_b32 a27, v213
    s_waitcnt vmcnt(16)
    v_lshlrev_b32 v208, 16, v156
    v_and_b32 v209, 0xffff0000, v156
    v_pk_mul_f32 v[208:209], v[208:209], v[214:215]
    v_cvt_pk_bf16_f32 v212, v208, v209
    v_accvgpr_write_b32 a28, v212
    v_lshlrev_b32 v210, 16, v157
    v_and_b32 v211, 0xffff0000, v157
    v_pk_mul_f32 v[210:211], v[210:211], v[214:215]
    v_cvt_pk_bf16_f32 v213, v210, v211
    v_accvgpr_write_b32 a29, v213
    v_lshlrev_b32 v208, 16, v158
    v_and_b32 v209, 0xffff0000, v158
    v_pk_mul_f32 v[208:209], v[208:209], v[214:215]
    v_cvt_pk_bf16_f32 v212, v208, v209
    v_accvgpr_write_b32 a30, v212
    v_lshlrev_b32 v210, 16, v159
    v_and_b32 v211, 0xffff0000, v159
    v_pk_mul_f32 v[210:211], v[210:211], v[214:215]
    v_cvt_pk_bf16_f32 v213, v210, v211
    v_accvgpr_write_b32 a31, v213
    s_waitcnt vmcnt(15)
    v_lshlrev_b32 v208, 16, v160
    v_and_b32 v209, 0xffff0000, v160
    v_pk_mul_f32 v[208:209], v[208:209], v[214:215]
    v_cvt_pk_bf16_f32 v212, v208, v209
    v_accvgpr_write_b32 a32, v212
    v_lshlrev_b32 v210, 16, v161
    v_and_b32 v211, 0xffff0000, v161
    v_pk_mul_f32 v[210:211], v[210:211], v[214:215]
    v_cvt_pk_bf16_f32 v213, v210, v211
    v_accvgpr_write_b32 a33, v213
    v_lshlrev_b32 v208, 16, v162
    v_and_b32 v209, 0xffff0000, v162
    v_pk_mul_f32 v[208:209], v[208:209], v[214:215]
    v_cvt_pk_bf16_f32 v212, v208, v209
    v_accvgpr_write_b32 a34, v212
    v_lshlrev_b32 v210, 16, v163
    v_and_b32 v211, 0xffff0000, v163
    v_pk_mul_f32 v[210:211], v[210:211], v[214:215]
    v_cvt_pk_bf16_f32 v213, v210, v211
    v_accvgpr_write_b32 a35, v213
    s_waitcnt vmcnt(14)
    v_lshlrev_b32 v208, 16, v164
    v_and_b32 v209, 0xffff0000, v164
    v_pk_mul_f32 v[208:209], v[208:209], v[214:215]
    v_cvt_pk_bf16_f32 v212, v208, v209
    v_accvgpr_write_b32 a36, v212
    v_lshlrev_b32 v210, 16, v165
    v_and_b32 v211, 0xffff0000, v165
    v_pk_mul_f32 v[210:211], v[210:211], v[214:215]
    v_cvt_pk_bf16_f32 v213, v210, v211
    v_accvgpr_write_b32 a37, v213
    v_lshlrev_b32 v208, 16, v166
    v_and_b32 v209, 0xffff0000, v166
    v_pk_mul_f32 v[208:209], v[208:209], v[214:215]
    v_cvt_pk_bf16_f32 v212, v208, v209
    v_accvgpr_write_b32 a38, v212
    v_lshlrev_b32 v210, 16, v167
    v_and_b32 v211, 0xffff0000, v167
    v_pk_mul_f32 v[210:211], v[210:211], v[214:215]
    v_cvt_pk_bf16_f32 v213, v210, v211
    v_accvgpr_write_b32 a39, v213
    s_mov_b32 m0, s64
    s_nop 0
    buffer_load_dwordx4 v192, s[28:31], s50 offen lds
    buffer_load_dwordx4 v193, s[28:31], s50 offen offset:1024 lds
    buffer_load_dwordx4 v194, s[28:31], s50 offen offset:2048 lds
    buffer_load_dwordx4 v195, s[28:31], s50 offen offset:3072 lds
    s_waitcnt vmcnt(17)
    v_lshlrev_b32 v208, 16, v168
    v_and_b32 v209, 0xffff0000, v168
    v_pk_mul_f32 v[208:209], v[208:209], v[214:215]
    v_cvt_pk_bf16_f32 v212, v208, v209
    v_accvgpr_write_b32 a40, v212
    v_lshlrev_b32 v210, 16, v169
    v_and_b32 v211, 0xffff0000, v169
    v_pk_mul_f32 v[210:211], v[210:211], v[214:215]
    v_cvt_pk_bf16_f32 v213, v210, v211
    v_accvgpr_write_b32 a41, v213
    v_lshlrev_b32 v208, 16, v170
    v_and_b32 v209, 0xffff0000, v170
    v_pk_mul_f32 v[208:209], v[208:209], v[214:215]
    v_cvt_pk_bf16_f32 v212, v208, v209
    v_accvgpr_write_b32 a42, v212
    v_lshlrev_b32 v210, 16, v171
    v_and_b32 v211, 0xffff0000, v171
    v_pk_mul_f32 v[210:211], v[210:211], v[214:215]
    v_cvt_pk_bf16_f32 v213, v210, v211
    v_accvgpr_write_b32 a43, v213
    s_waitcnt vmcnt(16)
    v_lshlrev_b32 v208, 16, v172
    v_and_b32 v209, 0xffff0000, v172
    v_pk_mul_f32 v[208:209], v[208:209], v[214:215]
    v_cvt_pk_bf16_f32 v212, v208, v209
    v_accvgpr_write_b32 a44, v212
    v_lshlrev_b32 v210, 16, v173
    v_and_b32 v211, 0xffff0000, v173
    v_pk_mul_f32 v[210:211], v[210:211], v[214:215]
    v_cvt_pk_bf16_f32 v213, v210, v211
    v_accvgpr_write_b32 a45, v213
    v_lshlrev_b32 v208, 16, v174
    v_and_b32 v209, 0xffff0000, v174
    v_pk_mul_f32 v[208:209], v[208:209], v[214:215]
    v_cvt_pk_bf16_f32 v212, v208, v209
    v_accvgpr_write_b32 a46, v212
    v_lshlrev_b32 v210, 16, v175
    v_and_b32 v211, 0xffff0000, v175
    v_pk_mul_f32 v[210:211], v[210:211], v[214:215]
    v_cvt_pk_bf16_f32 v213, v210, v211
    v_accvgpr_write_b32 a47, v213
    s_waitcnt vmcnt(15)
    v_lshlrev_b32 v208, 16, v240
    v_and_b32 v209, 0xffff0000, v240
    v_pk_mul_f32 v[208:209], v[208:209], v[214:215]
    v_cvt_pk_bf16_f32 v212, v208, v209
    v_accvgpr_write_b32 a48, v212
    v_lshlrev_b32 v210, 16, v241
    v_and_b32 v211, 0xffff0000, v241
    v_pk_mul_f32 v[210:211], v[210:211], v[214:215]
    v_cvt_pk_bf16_f32 v213, v210, v211
    v_accvgpr_write_b32 a49, v213
    v_lshlrev_b32 v208, 16, v242
    v_and_b32 v209, 0xffff0000, v242
    v_pk_mul_f32 v[208:209], v[208:209], v[214:215]
    v_cvt_pk_bf16_f32 v212, v208, v209
    v_accvgpr_write_b32 a50, v212
    v_lshlrev_b32 v210, 16, v243
    v_and_b32 v211, 0xffff0000, v243
    v_pk_mul_f32 v[210:211], v[210:211], v[214:215]
    v_cvt_pk_bf16_f32 v213, v210, v211
    v_accvgpr_write_b32 a51, v213
    s_waitcnt vmcnt(14)
    v_lshlrev_b32 v208, 16, v244
    v_and_b32 v209, 0xffff0000, v244
    v_pk_mul_f32 v[208:209], v[208:209], v[214:215]
    v_cvt_pk_bf16_f32 v212, v208, v209
    v_accvgpr_write_b32 a52, v212
    v_lshlrev_b32 v210, 16, v245
    v_and_b32 v211, 0xffff0000, v245
    v_pk_mul_f32 v[210:211], v[210:211], v[214:215]
    v_cvt_pk_bf16_f32 v213, v210, v211
    v_accvgpr_write_b32 a53, v213
    v_lshlrev_b32 v208, 16, v246
    v_and_b32 v209, 0xffff0000, v246
    v_pk_mul_f32 v[208:209], v[208:209], v[214:215]
    v_cvt_pk_bf16_f32 v212, v208, v209
    v_accvgpr_write_b32 a54, v212
    v_lshlrev_b32 v210, 16, v247
    v_and_b32 v211, 0xffff0000, v247
    v_pk_mul_f32 v[210:211], v[210:211], v[214:215]
    v_cvt_pk_bf16_f32 v213, v210, v211
    v_accvgpr_write_b32 a55, v213
    s_waitcnt vmcnt(13)
    v_lshlrev_b32 v208, 16, v248
    v_and_b32 v209, 0xffff0000, v248
    v_pk_mul_f32 v[208:209], v[208:209], v[214:215]
    v_cvt_pk_bf16_f32 v212, v208, v209
    v_accvgpr_write_b32 a56, v212
    v_lshlrev_b32 v210, 16, v249
    v_and_b32 v211, 0xffff0000, v249
    v_pk_mul_f32 v[210:211], v[210:211], v[214:215]
    v_cvt_pk_bf16_f32 v213, v210, v211
    v_accvgpr_write_b32 a57, v213
    v_lshlrev_b32 v208, 16, v250
    v_and_b32 v209, 0xffff0000, v250
    v_pk_mul_f32 v[208:209], v[208:209], v[214:215]
    v_cvt_pk_bf16_f32 v212, v208, v209
    v_accvgpr_write_b32 a58, v212
    v_lshlrev_b32 v210, 16, v251
    v_and_b32 v211, 0xffff0000, v251
    v_pk_mul_f32 v[210:211], v[210:211], v[214:215]
    v_cvt_pk_bf16_f32 v213, v210, v211
    v_accvgpr_write_b32 a59, v213
    s_waitcnt vmcnt(12)
    v_lshlrev_b32 v208, 16, v252
    v_and_b32 v209, 0xffff0000, v252
    v_pk_mul_f32 v[208:209], v[208:209], v[214:215]
    v_cvt_pk_bf16_f32 v212, v208, v209
    v_accvgpr_write_b32 a60, v212
    v_lshlrev_b32 v210, 16, v253
    v_and_b32 v211, 0xffff0000, v253
    v_pk_mul_f32 v[210:211], v[210:211], v[214:215]
    v_cvt_pk_bf16_f32 v213, v210, v211
    v_accvgpr_write_b32 a61, v213
    v_lshlrev_b32 v208, 16, v254
    v_and_b32 v209, 0xffff0000, v254
    v_pk_mul_f32 v[208:209], v[208:209], v[214:215]
    v_cvt_pk_bf16_f32 v212, v208, v209
    v_accvgpr_write_b32 a62, v212
    v_lshlrev_b32 v210, 16, v255
    v_and_b32 v211, 0xffff0000, v255
    v_pk_mul_f32 v[210:211], v[210:211], v[214:215]
    v_cvt_pk_bf16_f32 v213, v210, v211
    v_accvgpr_write_b32 a63, v213
    s_waitcnt vmcnt(8)
    v_lshrrev_b32 v230, 3, v230
    v_add_u32 v230, 32768, v230
    global_load_dword v231, v230, s[42:43]
    s_barrier
    ds_read_b128 a[64:67], v176
    ds_read_b128 a[68:71], v177
    ds_read_b128 a[72:75], v178
    ds_read_b128 a[76:79], v179
    ds_read_b128 a[80:83], v176 offset:256
    ds_read_b128 a[84:87], v177 offset:256
    ds_read_b128 a[88:91], v178 offset:256
    ds_read_b128 a[92:95], v179 offset:256
    ds_read_b128 a[96:99], v176 offset:8192
    ds_read_b128 a[100:103], v177 offset:8192
    ds_read_b128 a[104:107], v178 offset:8192
    ds_read_b128 a[108:111], v179 offset:8192
    ds_read_b128 a[112:115], v176 offset:8448
    ds_read_b128 a[116:119], v177 offset:8448
    ds_read_b128 a[120:123], v178 offset:8448
    s_waitcnt lgkmcnt(7)
    ds_read_b128 a[124:127], v179 offset:8448
    v_mfma_f32_16x16x32_bf16 v[128:131], a[64:67], a[0:3], 0
    s_mov_b32 m0, s62
    v_mfma_f32_16x16x32_bf16 v[128:131], a[68:71], a[4:7], v[128:131]
    buffer_load_dwordx4 v188, s[24:27], s56 offen lds
    v_mfma_f32_16x16x32_bf16 v[128:131], a[72:75], a[8:11], v[128:131]
    v_mfma_f32_16x16x32_bf16 v[128:131], a[76:79], a[12:15], v[128:131]
    v_mfma_f32_16x16x32_bf16 v[128:131], a[80:83], a[16:19], v[128:131]
    buffer_load_dwordx4 v189, s[24:27], s56 offen offset:1024 lds
    v_mfma_f32_16x16x32_bf16 v[128:131], a[84:87], a[20:23], v[128:131]
    v_mfma_f32_16x16x32_bf16 v[128:131], a[88:91], a[24:27], v[128:131]
    v_mfma_f32_16x16x32_bf16 v[128:131], a[92:95], a[28:31], v[128:131]
    buffer_load_dwordx4 v190, s[24:27], s56 offen offset:2048 lds
    s_waitcnt lgkmcnt(0)
    v_mfma_f32_16x16x32_bf16 v[136:139], a[96:99], a[0:3], 0
    v_mfma_f32_16x16x32_bf16 v[136:139], a[100:103], a[4:7], v[136:139]
    v_mfma_f32_16x16x32_bf16 v[136:139], a[104:107], a[8:11], v[136:139]
    buffer_load_dwordx4 v191, s[24:27], s56 offen offset:3072 lds
    v_mfma_f32_16x16x32_bf16 v[136:139], a[108:111], a[12:15], v[136:139]
    v_mfma_f32_16x16x32_bf16 v[136:139], a[112:115], a[16:19], v[136:139]
    s_mov_b32 m0, s65
    v_cndmask_b32 v128, v223, v128, s[84:85]
    v_mfma_f32_16x16x32_bf16 v[136:139], a[116:119], a[20:23], v[136:139]
    buffer_load_dwordx4 v192, s[28:31], s55 offen lds
    v_mfma_f32_16x16x32_bf16 v[136:139], a[120:123], a[24:27], v[136:139]
    v_cndmask_b32 v129, v223, v129, s[86:87]
    v_cndmask_b32 v130, v223, v130, s[88:89]
    v_mfma_f32_16x16x32_bf16 v[136:139], a[124:127], a[28:31], v[136:139]
    v_cndmask_b32 v131, v223, v131, s[90:91]
    v_mfma_f32_16x16x32_bf16 v[132:135], a[64:67], a[32:35], 0
    buffer_load_dwordx4 v193, s[28:31], s55 offen offset:1024 lds
    v_mfma_f32_16x16x32_bf16 v[132:135], a[68:71], a[36:39], v[132:135]
    v_readlane_b32 s51, v196, 1
    v_readlane_b32 s50, v196, 3
    v_mfma_f32_16x16x32_bf16 v[132:135], a[72:75], a[40:43], v[132:135]
    v_mfma_f32_16x16x32_bf16 v[132:135], a[76:79], a[44:47], v[132:135]
    buffer_load_dwordx4 v194, s[28:31], s55 offen offset:2048 lds
    v_cndmask_b32 v136, v223, v136, s[92:93]
    v_mfma_f32_16x16x32_bf16 v[132:135], a[80:83], a[48:51], v[132:135]
    v_cndmask_b32 v137, v223, v137, s[94:95]
    v_cndmask_b32 v138, v223, v138, s[96:97]
    v_cndmask_b32 v139, v223, v139, s[98:99]
    v_mfma_f32_16x16x32_bf16 v[132:135], a[84:87], a[52:55], v[132:135]
    v_max3_f32 v224, v128, v129, v130
    v_max3_f32 v224, v224, v131, v136
    v_max3_f32 v224, v224, v137, v138
    v_mfma_f32_16x16x32_bf16 v[132:135], a[88:91], a[56:59], v[132:135]
    s_waitcnt vmcnt(12)
    s_barrier
    v_max_f32 v224, v224, v139
    v_mfma_f32_16x16x32_bf16 v[132:135], a[92:95], a[60:63], v[132:135]
    buffer_load_dwordx4 v195, s[28:31], s55 offen offset:3072 lds
    v_mov_b32 v225, v224
    v_mfma_f32_16x16x32_bf16 v[140:143], a[96:99], a[32:35], 0
    ds_read_b128 a[64:67], v176 offset:16384
    s_nop 1
    v_permlane32_swap_b32 v224, v225
    v_mfma_f32_16x16x32_bf16 v[140:143], a[100:103], a[36:39], v[140:143]
    s_mov_b32 m0, s63
    ds_read_b128 a[68:71], v177 offset:16384
    s_nop 0
    v_mfma_f32_16x16x32_bf16 v[140:143], a[104:107], a[40:43], v[140:143]
    buffer_load_dwordx4 v188, s[24:27], s57 offen lds
    ds_read_b128 a[72:75], v178 offset:16384
    v_mfma_f32_16x16x32_bf16 v[140:143], a[108:111], a[44:47], v[140:143]
    ds_read_b128 a[76:79], v179 offset:16384
    v_max_f32 v224, v224, v225
    v_mov_b32 v225, v224
    v_mfma_f32_16x16x32_bf16 v[140:143], a[112:115], a[48:51], v[140:143]
    ds_read_b128 a[80:83], v176 offset:16640
    s_nop 1
    v_permlane16_swap_b32 v224, v225
    v_mfma_f32_16x16x32_bf16 v[140:143], a[116:119], a[52:55], v[140:143]
    buffer_load_dwordx4 v189, s[24:27], s57 offen offset:1024 lds
    ds_read_b128 a[84:87], v177 offset:16640
    v_mfma_f32_16x16x32_bf16 v[140:143], a[120:123], a[56:59], v[140:143]
    ds_read_b128 a[88:91], v178 offset:16640
    s_nop 0
    v_max_f32 v224, v224, v225
    v_sub_f32 v232, 0xc1c00000, v224
    v_mov_b32 v233, v232
    v_mov_b32 v234, v232
    v_mov_b32 v235, v232
    v_add_f32 v128, v128, v232
    v_add_f32 v129, v129, v232
    v_add_f32 v130, v130, v232
    v_add_f32 v131, v131, v232
    v_add_f32 v136, v136, v232
    v_add_f32 v137, v137, v232
    v_add_f32 v138, v138, v232
    v_add_f32 v139, v139, v232
    v_mfma_f32_16x16x32_bf16 v[140:143], a[124:127], a[60:63], v[140:143]
    ds_read_b128 a[92:95], v179 offset:16640
    v_cndmask_b32 v132, v223, v132, s[84:85]
    v_cndmask_b32 v133, v223, v133, s[86:87]
    v_cndmask_b32 v134, v223, v134, s[88:89]
    s_waitcnt lgkmcnt(6)
    v_mfma_f32_16x16x32_bf16 v[144:147], a[64:67], a[0:3], v[232:235]
    buffer_load_dwordx4 v190, s[24:27], s57 offen offset:2048 lds
    ds_read_b128 a[96:99], v176 offset:24576
    ds_read_b128 a[100:103], v177 offset:24576
    v_mfma_f32_16x16x32_bf16 v[144:147], a[68:71], a[4:7], v[144:147]
    v_cndmask_b32 v135, v223, v135, s[90:91]
    v_exp_f32 v208, v128
    s_waitcnt lgkmcnt(4)
    v_mfma_f32_16x16x32_bf16 v[144:147], a[72:75], a[8:11], v[144:147]
    v_exp_f32 v209, v129
    v_exp_f32 v210, v130
    v_cvt_pk_bf16_f32 v160, v208, v209
    v_exp_f32 v211, v131
    v_exp_f32 v212, v136
    v_mfma_f32_16x16x32_bf16 v[144:147], a[76:79], a[12:15], v[144:147]
    buffer_load_dwordx4 v191, s[24:27], s57 offen offset:3072 lds
    v_cndmask_b32 v140, v223, v140, s[92:93]
    v_cndmask_b32 v141, v223, v141, s[94:95]
    v_cndmask_b32 v142, v223, v142, s[96:97]
    s_waitcnt lgkmcnt(2)
    v_mfma_f32_16x16x32_bf16 v[144:147], a[80:83], a[16:19], v[144:147]
    ds_read_b128 a[104:107], v178 offset:24576
    ds_read_b128 a[108:111], v179 offset:24576
    v_cndmask_b32 v143, v223, v143, s[98:99]
    v_max3_f32 v226, v132, v133, v134
    v_max3_f32 v226, v226, v135, v140
    v_mfma_f32_16x16x32_bf16 v[144:147], a[84:87], a[20:23], v[144:147]
    s_mov_b32 m0, s66
    v_max3_f32 v226, v226, v141, v142
    v_max_f32 v226, v226, v143
    v_mov_b32 v227, v226
    s_nop 1
    v_mfma_f32_16x16x32_bf16 v[144:147], a[88:91], a[24:27], v[144:147]
    buffer_load_dwordx4 v192, s[28:31], s51 offen lds
    v_permlane32_swap_b32 v226, v227
    s_nop 0
    v_max_f32 v226, v226, v227
    v_mov_b32 v227, v226
    s_nop 1
    v_permlane16_swap_b32 v226, v227
    s_nop 0
    v_max_f32 v226, v226, v227
    v_sub_f32 v236, 0xc1c00000, v226
    v_mov_b32 v237, v236
    v_mov_b32 v238, v236
    v_mov_b32 v239, v236
    v_mfma_f32_16x16x32_bf16 v[144:147], a[92:95], a[28:31], v[144:147]
    v_add_f32 v132, v132, v236
    v_add_f32 v133, v133, v236
    v_add_f32 v134, v134, v236
    v_mfma_f32_16x16x32_bf16 v[148:151], a[64:67], a[32:35], v[236:239]
    ds_read_b128 a[112:115], v176 offset:24832
    ds_read_b128 a[116:119], v177 offset:24832
    v_add_f32 v135, v135, v236
    v_mfma_f32_16x16x32_bf16 v[148:151], a[68:71], a[36:39], v[148:151]
    buffer_load_dwordx4 v193, s[28:31], s51 offen offset:1024 lds
    v_add_f32 v140, v140, v236
    v_mfma_f32_16x16x32_bf16 v[148:151], a[72:75], a[40:43], v[148:151]
    v_add_f32 v141, v141, v236
    v_add_f32 v142, v142, v236
    v_add_f32 v143, v143, v236
    v_mfma_f32_16x16x32_bf16 v[148:151], a[76:79], a[44:47], v[148:151]
    v_cvt_pk_bf16_f32 v161, v210, v211
    v_exp_f32 v213, v137
    v_mfma_f32_16x16x32_bf16 v[148:151], a[80:83], a[48:51], v[148:151]
    buffer_load_dwordx4 v194, s[28:31], s51 offen offset:2048 lds
    ds_read_b128 a[120:123], v178 offset:24832
    ds_read_b128 a[124:127], v179 offset:24832
    v_mfma_f32_16x16x32_bf16 v[148:151], a[84:87], a[52:55], v[148:151]
    v_exp_f32 v214, v138
    v_cvt_pk_bf16_f32 v162, v212, v213
    v_mfma_f32_16x16x32_bf16 v[148:151], a[88:91], a[56:59], v[148:151]
    v_exp_f32 v215, v139
    v_mfma_f32_16x16x32_bf16 v[148:151], a[92:95], a[60:63], v[148:151]
    buffer_load_dwordx4 v195, s[28:31], s51 offen offset:3072 lds
    s_waitcnt lgkmcnt(0)
    v_mfma_f32_16x16x32_bf16 v[152:155], a[96:99], a[0:3], v[232:235]
    v_exp_f32 v208, v132
    v_cvt_pk_bf16_f32 v163, v214, v215
    v_mfma_f32_16x16x32_bf16 v[152:155], a[100:103], a[4:7], v[152:155]
    s_mov_b32 m0, s60
    v_exp_f32 v209, v133
    v_mfma_f32_16x16x32_bf16 v[152:155], a[104:107], a[8:11], v[152:155]
    buffer_load_dwordx4 v188, s[24:27], s50 offen lds
    v_mfma_f32_16x16x32_bf16 v[152:155], a[108:111], a[12:15], v[152:155]
    s_waitcnt vmcnt(18)
    s_barrier
    v_mfma_f32_16x16x32_bf16 v[152:155], a[112:115], a[16:19], v[152:155]
    v_exp_f32 v210, v134
    v_cvt_pk_bf16_f32 v164, v208, v209
    v_mfma_f32_16x16x32_bf16 v[152:155], a[116:119], a[20:23], v[152:155]
    buffer_load_dwordx4 v189, s[24:27], s50 offen offset:1024 lds
    v_mfma_f32_16x16x32_bf16 v[152:155], a[120:123], a[24:27], v[152:155]
    ds_read_b64_tr_b16 a[64:65], v180
    ds_read_b64_tr_b16 a[66:67], v180 offset:8192
    v_mfma_f32_16x16x32_bf16 v[152:155], a[124:127], a[28:31], v[152:155]
    v_exp_f32 v211, v135
    v_mfma_f32_16x16x32_bf16 v[156:159], a[96:99], a[32:35], v[236:239]
    buffer_load_dwordx4 v190, s[24:27], s50 offen offset:2048 lds
    ds_read_b64_tr_b16 a[68:69], v181
    ds_read_b64_tr_b16 a[70:71], v181 offset:8192
    v_mfma_f32_16x16x32_bf16 v[156:159], a[100:103], a[36:39], v[156:159]
    v_exp_f32 v212, v140
    v_cvt_pk_bf16_f32 v165, v210, v211
    v_mfma_f32_16x16x32_bf16 v[156:159], a[104:107], a[40:43], v[156:159]
    ds_read_b64_tr_b16 a[72:73], v182
    ds_read_b64_tr_b16 a[74:75], v182 offset:8192
    v_mfma_f32_16x16x32_bf16 v[156:159], a[108:111], a[44:47], v[156:159]
    buffer_load_dwordx4 v191, s[24:27], s50 offen offset:3072 lds
    v_mfma_f32_16x16x32_bf16 v[156:159], a[112:115], a[48:51], v[156:159]
    ds_read_b64_tr_b16 a[76:77], v183
    ds_read_b64_tr_b16 a[78:79], v183 offset:8192
    v_mfma_f32_16x16x32_bf16 v[156:159], a[116:119], a[52:55], v[156:159]
    v_exp_f32 v213, v141
    v_mfma_f32_16x16x32_bf16 v[156:159], a[120:123], a[56:59], v[156:159]
    ds_read_b64_tr_b16 a[80:81], v184
    ds_read_b64_tr_b16 a[82:83], v184 offset:8192
    v_exp_f32 v214, v142
    v_cvt_pk_bf16_f32 v166, v212, v213
    v_exp_f32 v215, v143
    s_nop 0
    v_cvt_pk_bf16_f32 v167, v214, v215
    v_mfma_f32_16x16x32_bf16 v[156:159], a[124:127], a[60:63], v[156:159]
    s_mov_b32 s46, 2
    s_cmp_ge_u32 s46, s101
    s_cbranch_scc1 L_fin0
L_loop:
L_A1:
    v_mfma_f32_16x16x32_bf16 v[200:203], v[160:163], a[128:131], v[200:203]
    ds_read_b64_tr_b16 a[84:85], v185
    ds_read_b64_tr_b16 a[86:87], v185 offset:8192
    v_mfma_f32_16x16x32_bf16 v[204:207], v[164:167], a[128:131], v[204:207]
    v_readlane_b32 s51, v196, s46
    s_waitcnt lgkmcnt(6)
    v_mfma_f32_16x16x32_bf16 v[0:3], v[160:163], a[64:67], v[0:3]
    ds_read_b64_tr_b16 a[88:89], v186
    ds_read_b64_tr_b16 a[90:91], v186 offset:8192
    v_mfma_f32_16x16x32_bf16 v[64:67], v[164:167], a[64:67], v[64:67]
    s_add_u32 s53, s46, 2
    v_readlane_b32 s50, v196, s53
    v_mfma_f32_16x16x32_bf16 v[4:7], v[160:163], a[68:71], v[4:7]
    ds_read_b64_tr_b16 a[92:93], v187
    ds_read_b64_tr_b16 a[94:95], v187 offset:8192
    v_mfma_f32_16x16x32_bf16 v[68:71], v[164:167], a[68:71], v[68:71]
    s_waitcnt vmcnt(12)
    s_barrier
    v_mfma_f32_16x16x32_bf16 v[8:11], v[160:163], a[72:75], v[8:11]
    ds_read_b64_tr_b16 a[96:97], v180 offset:256
    ds_read_b64_tr_b16 a[98:99], v180 offset:8448
    v_mfma_f32_16x16x32_bf16 v[72:75], v[164:167], a[72:75], v[72:75]
    s_mov_b32 m0, s67
    s_waitcnt lgkmcnt(6)
    v_mfma_f32_16x16x32_bf16 v[12:15], v[160:163], a[76:79], v[12:15]
    ds_read_b64_tr_b16 a[100:101], v181 offset:256
    ds_read_b64_tr_b16 a[102:103], v181 offset:8448
    v_mfma_f32_16x16x32_bf16 v[76:79], v[164:167], a[76:79], v[76:79]
    buffer_load_dwordx4 v192, s[28:31], s51 offen lds
    v_mfma_f32_16x16x32_bf16 v[16:19], v[160:163], a[80:83], v[16:19]
    ds_read_b64_tr_b16 a[104:105], v182 offset:256
    ds_read_b64_tr_b16 a[106:107], v182 offset:8448
    v_mfma_f32_16x16x32_bf16 v[80:83], v[164:167], a[80:83], v[80:83]
    buffer_load_dwordx4 v193, s[28:31], s51 offen offset:1024 lds
    v_mfma_f32_16x16x32_bf16 v[20:23], v[160:163], a[84:87], v[20:23]
    ds_read_b64_tr_b16 a[108:109], v183 offset:256
    ds_read_b64_tr_b16 a[110:111], v183 offset:8448
    v_mfma_f32_16x16x32_bf16 v[84:87], v[164:167], a[84:87], v[84:87]
    s_waitcnt lgkmcnt(6)
    v_mfma_f32_16x16x32_bf16 v[24:27], v[160:163], a[88:91], v[24:27]
    ds_read_b64_tr_b16 a[112:113], v184 offset:256
    ds_read_b64_tr_b16 a[114:115], v184 offset:8448
    v_mfma_f32_16x16x32_bf16 v[88:91], v[164:167], a[88:91], v[88:91]
    buffer_load_dwordx4 v194, s[28:31], s51 offen offset:2048 lds
    v_mfma_f32_16x16x32_bf16 v[28:31], v[160:163], a[92:95], v[28:31]
    ds_read_b64_tr_b16 a[116:117], v185 offset:256
    ds_read_b64_tr_b16 a[118:119], v185 offset:8448
    v_mfma_f32_16x16x32_bf16 v[92:95], v[164:167], a[92:95], v[92:95]
    buffer_load_dwordx4 v195, s[28:31], s51 offen offset:3072 lds
    v_mfma_f32_16x16x32_bf16 v[32:35], v[160:163], a[96:99], v[32:35]
    ds_read_b64_tr_b16 a[120:121], v186 offset:256
    ds_read_b64_tr_b16 a[122:123], v186 offset:8448
    v_mfma_f32_16x16x32_bf16 v[96:99], v[164:167], a[96:99], v[96:99]
    s_waitcnt lgkmcnt(6)
    v_mfma_f32_16x16x32_bf16 v[36:39], v[160:163], a[100:103], v[36:39]
    ds_read_b64_tr_b16 a[124:125], v187 offset:256
    ds_read_b64_tr_b16 a[126:127], v187 offset:8448
    v_mfma_f32_16x16x32_bf16 v[100:103], v[164:167], a[100:103], v[100:103]
    v_exp_f32 v208, v144
    v_mfma_f32_16x16x32_bf16 v[40:43], v[160:163], a[104:107], v[40:43]
    ds_read_b128 a[64:67], v176 offset:32768
    ds_read_b128 a[68:71], v177 offset:32768
    v_mfma_f32_16x16x32_bf16 v[104:107], v[164:167], a[104:107], v[104:107]
    v_exp_f32 v209, v145
    v_mfma_f32_16x16x32_bf16 v[44:47], v[160:163], a[108:111], v[44:47]
    ds_read_b128 a[72:75], v178 offset:32768
    ds_read_b128 a[76:79], v179 offset:32768
    v_mfma_f32_16x16x32_bf16 v[108:111], v[164:167], a[108:111], v[108:111]
    v_cvt_pk_bf16_f32 v168, v208, v209
    s_waitcnt lgkmcnt(4)
    v_mfma_f32_16x16x32_bf16 v[48:51], v[160:163], a[112:115], v[48:51]
    ds_read_b128 a[80:83], v176 offset:33024
    ds_read_b128 a[84:87], v177 offset:33024
    v_mfma_f32_16x16x32_bf16 v[112:115], v[164:167], a[112:115], v[112:115]
    v_exp_f32 v210, v146
    v_mfma_f32_16x16x32_bf16 v[52:55], v[160:163], a[116:119], v[52:55]
    ds_read_b128 a[88:91], v178 offset:33024
    ds_read_b128 a[92:95], v179 offset:33024
    v_mfma_f32_16x16x32_bf16 v[116:119], v[164:167], a[116:119], v[116:119]
    v_exp_f32 v211, v147
    v_mfma_f32_16x16x32_bf16 v[56:59], v[160:163], a[120:123], v[56:59]
    v_exp_f32 v212, v152
    v_mfma_f32_16x16x32_bf16 v[120:123], v[164:167], a[120:123], v[120:123]
    v_cvt_pk_bf16_f32 v169, v210, v211
    v_mfma_f32_16x16x32_bf16 v[60:63], v[160:163], a[124:127], v[60:63]
    v_exp_f32 v213, v153
    v_mfma_f32_16x16x32_bf16 v[124:127], v[164:167], a[124:127], v[124:127]
    s_mov_b32 m0, s61
    s_waitcnt lgkmcnt(0)
    v_mfma_f32_16x16x32_bf16 v[128:131], a[64:67], a[0:3], v[232:235]
    ds_read_b128 a[96:99], v176 offset:40960
    ds_read_b128 a[100:103], v177 offset:40960
    v_mfma_f32_16x16x32_bf16 v[128:131], a[68:71], a[4:7], v[128:131]
    buffer_load_dwordx4 v188, s[24:27], s50 offen lds
    v_mfma_f32_16x16x32_bf16 v[128:131], a[72:75], a[8:11], v[128:131]
    v_exp_f32 v214, v154
    v_mfma_f32_16x16x32_bf16 v[128:131], a[76:79], a[12:15], v[128:131]
    v_cvt_pk_bf16_f32 v170, v212, v213
    v_or3_b32 v197, v168, v169, v170
    v_mfma_f32_16x16x32_bf16 v[128:131], a[80:83], a[16:19], v[128:131]
    ds_read_b128 a[104:107], v178 offset:40960
    ds_read_b128 a[108:111], v179 offset:40960
    v_mfma_f32_16x16x32_bf16 v[128:131], a[84:87], a[20:23], v[128:131]
    buffer_load_dwordx4 v189, s[24:27], s50 offen offset:1024 lds
    v_mfma_f32_16x16x32_bf16 v[128:131], a[88:91], a[24:27], v[128:131]
    v_exp_f32 v215, v155
    v_mfma_f32_16x16x32_bf16 v[128:131], a[92:95], a[28:31], v[128:131]
    v_exp_f32 v208, v148
    v_mfma_f32_16x16x32_bf16 v[132:135], a[64:67], a[32:35], v[236:239]
    ds_read_b128 a[112:115], v176 offset:41216
    ds_read_b128 a[116:119], v177 offset:41216
    v_mfma_f32_16x16x32_bf16 v[132:135], a[68:71], a[36:39], v[132:135]
    buffer_load_dwordx4 v190, s[24:27], s50 offen offset:2048 lds
    v_mfma_f32_16x16x32_bf16 v[132:135], a[72:75], a[40:43], v[132:135]
    v_cvt_pk_bf16_f32 v171, v214, v215
    v_mfma_f32_16x16x32_bf16 v[132:135], a[76:79], a[44:47], v[132:135]
    v_exp_f32 v209, v149
    v_mfma_f32_16x16x32_bf16 v[132:135], a[80:83], a[48:51], v[132:135]
    ds_read_b128 a[120:123], v178 offset:41216
    ds_read_b128 a[124:127], v179 offset:41216
    v_mfma_f32_16x16x32_bf16 v[132:135], a[84:87], a[52:55], v[132:135]
    buffer_load_dwordx4 v191, s[24:27], s50 offen offset:3072 lds
    v_mfma_f32_16x16x32_bf16 v[132:135], a[88:91], a[56:59], v[132:135]
    v_exp_f32 v210, v150
    v_mfma_f32_16x16x32_bf16 v[132:135], a[92:95], a[60:63], v[132:135]
    v_cvt_pk_bf16_f32 v172, v208, v209
    s_waitcnt lgkmcnt(0)
    v_mfma_f32_16x16x32_bf16 v[136:139], a[96:99], a[0:3], v[232:235]
    v_exp_f32 v211, v151
    v_mfma_f32_16x16x32_bf16 v[136:139], a[100:103], a[4:7], v[136:139]
    v_exp_f32 v212, v156
    v_mfma_f32_16x16x32_bf16 v[136:139], a[104:107], a[8:11], v[136:139]
    v_cvt_pk_bf16_f32 v173, v210, v211
    v_or3_b32 v197, v197, v171, v172
    v_mfma_f32_16x16x32_bf16 v[136:139], a[108:111], a[12:15], v[136:139]
    v_exp_f32 v213, v157
    v_mfma_f32_16x16x32_bf16 v[136:139], a[112:115], a[16:19], v[136:139]
    v_exp_f32 v214, v158
    v_mfma_f32_16x16x32_bf16 v[136:139], a[116:119], a[20:23], v[136:139]
    v_cvt_pk_bf16_f32 v174, v212, v213
    v_or3_b32 v197, v197, v173, v174
    v_mfma_f32_16x16x32_bf16 v[136:139], a[120:123], a[24:27], v[136:139]
    ds_read_b64_tr_b16 a[64:65], v180 offset:16384
    ds_read_b64_tr_b16 a[66:67], v180 offset:24576
    v_mfma_f32_16x16x32_bf16 v[136:139], a[124:127], a[28:31], v[136:139]
    v_exp_f32 v215, v159
    v_mfma_f32_16x16x32_bf16 v[140:143], a[96:99], a[32:35], v[236:239]
    ds_read_b64_tr_b16 a[68:69], v181 offset:16384
    ds_read_b64_tr_b16 a[70:71], v181 offset:24576
    v_mfma_f32_16x16x32_bf16 v[140:143], a[100:103], a[36:39], v[140:143]
    v_cvt_pk_bf16_f32 v175, v214, v215
    v_or_b32 v197, v197, v175
    v_mfma_f32_16x16x32_bf16 v[140:143], a[104:107], a[40:43], v[140:143]
    ds_read_b64_tr_b16 a[72:73], v182 offset:16384
    ds_read_b64_tr_b16 a[74:75], v182 offset:24576
    v_mfma_f32_16x16x32_bf16 v[140:143], a[108:111], a[44:47], v[140:143]
    v_and_b32 v197, s48, v197
    v_cmp_ne_u32 vcc, 0, v197
    v_mfma_f32_16x16x32_bf16 v[140:143], a[112:115], a[48:51], v[140:143]
    ds_read_b64_tr_b16 a[76:77], v183 offset:16384
    ds_read_b64_tr_b16 a[78:79], v183 offset:24576
    v_mfma_f32_16x16x32_bf16 v[140:143], a[116:119], a[52:55], v[140:143]
    s_add_u32 s46, s46, 1
    s_cmp_ge_u32 s46, s101
    v_mfma_f32_16x16x32_bf16 v[140:143], a[120:123], a[56:59], v[140:143]
    ds_read_b64_tr_b16 a[80:81], v184 offset:16384
    ds_read_b64_tr_b16 a[82:83], v184 offset:24576
    v_mfma_f32_16x16x32_bf16 v[140:143], a[124:127], a[60:63], v[140:143]
    s_cbranch_vccnz L_rare1
L_back1:
    s_cbranch_scc1 L_fin1
L_A2:
    v_mfma_f32_16x16x32_bf16 v[200:203], v[168:171], a[128:131], v[200:203]
    ds_read_b64_tr_b16 a[84:85], v185 offset:16384
    ds_read_b64_tr_b16 a[86:87], v185 offset:24576
    v_mfma_f32_16x16x32_bf16 v[204:207], v[172:175], a[128:131], v[204:207]
    v_readlane_b32 s51, v196, s46
    s_waitcnt lgkmcnt(6)
    v_mfma_f32_16x16x32_bf16 v[0:3], v[168:171], a[64:67], v[0:3]
    ds_read_b64_tr_b16 a[88:89], v186 offset:16384
    ds_read_b64_tr_b16 a[90:91], v186 offset:24576
    v_mfma_f32_16x16x32_bf16 v[64:67], v[172:175], a[64:67], v[64:67]
    s_add_u32 s53, s46, 2
    v_readlane_b32 s50, v196, s53
    v_mfma_f32_16x16x32_bf16 v[4:7], v[168:171], a[68:71], v[4:7]
    ds_read_b64_tr_b16 a[92:93], v187 offset:16384
    ds_read_b64_tr_b16 a[94:95], v187 offset:24576
    v_mfma_f32_16x16x32_bf16 v[68:71], v[172:175], a[68:71], v[68:71]
    s_waitcnt vmcnt(12)
    s_barrier
    v_mfma_f32_16x16x32_bf16 v[8:11], v[168:171], a[72:75], v[8:11]
    ds_read_b64_tr_b16 a[96:97], v180 offset:16640
    ds_read_b64_tr_b16 a[98:99], v180 offset:24832
    v_mfma_f32_16x16x32_bf16 v[72:75], v[172:175], a[72:75], v[72:75]
    s_mov_b32 m0, s64
    s_waitcnt lgkmcnt(6)
    v_mfma_f32_16x16x32_bf16 v[12:15], v[168:171], a[76:79], v[12:15]
    ds_read_b64_tr_b16 a[100:101], v181 offset:16640
    ds_read_b64_tr_b16 a[102:103], v181 offset:24832
    v_mfma_f32_16x16x32_bf16 v[76:79], v[172:175], a[76:79], v[76:79]
    buffer_load_dwordx4 v192, s[28:31], s51 offen lds
    v_mfma_f32_16x16x32_bf16 v[16:19], v[168:171], a[80:83], v[16:19]
    ds_read_b64_tr_b16 a[104:105], v182 offset:16640
    ds_read_b64_tr_b16 a[106:107], v182 offset:24832
    v_mfma_f32_16x16x32_bf16 v[80:83], v[172:175], a[80:83], v[80:83]
    buffer_load_dwordx4 v193, s[28:31], s51 offen offset:1024 lds
    v_mfma_f32_16x16x32_bf16 v[20:23], v[168:171], a[84:87], v[20:23]
    ds_read_b64_tr_b16 a[108:109], v183 offset:16640
    ds_read_b64_tr_b16 a[110:111], v183 offset:24832
    v_mfma_f32_16x16x32_bf16 v[84:87], v[172:175], a[84:87], v[84:87]
    s_waitcnt lgkmcnt(6)
    v_mfma_f32_16x16x32_bf16 v[24:27], v[168:171], a[88:91], v[24:27]
    ds_read_b64_tr_b16 a[112:113], v184 offset:16640
    ds_read_b64_tr_b16 a[114:115], v184 offset:24832
    v_mfma_f32_16x16x32_bf16 v[88:91], v[172:175], a[88:91], v[88:91]
    buffer_load_dwordx4 v194, s[28:31], s51 offen offset:2048 lds
    v_mfma_f32_16x16x32_bf16 v[28:31], v[168:171], a[92:95], v[28:31]
    ds_read_b64_tr_b16 a[116:117], v185 offset:16640
    ds_read_b64_tr_b16 a[118:119], v185 offset:24832
    v_mfma_f32_16x16x32_bf16 v[92:95], v[172:175], a[92:95], v[92:95]
    buffer_load_dwordx4 v195, s[28:31], s51 offen offset:3072 lds
    v_mfma_f32_16x16x32_bf16 v[32:35], v[168:171], a[96:99], v[32:35]
    ds_read_b64_tr_b16 a[120:121], v186 offset:16640
    ds_read_b64_tr_b16 a[122:123], v186 offset:24832
    v_mfma_f32_16x16x32_bf16 v[96:99], v[172:175], a[96:99], v[96:99]
    s_waitcnt lgkmcnt(6)
    v_mfma_f32_16x16x32_bf16 v[36:39], v[168:171], a[100:103], v[36:39]
    ds_read_b64_tr_b16 a[124:125], v187 offset:16640
    ds_read_b64_tr_b16 a[126:127], v187 offset:24832
    v_mfma_f32_16x16x32_bf16 v[100:103], v[172:175], a[100:103], v[100:103]
    v_exp_f32 v208, v128
    v_mfma_f32_16x16x32_bf16 v[40:43], v[168:171], a[104:107], v[40:43]
    ds_read_b128 a[64:67], v176 offset:49152
    ds_read_b128 a[68:71], v177 offset:49152
    v_mfma_f32_16x16x32_bf16 v[104:107], v[172:175], a[104:107], v[104:107]
    v_exp_f32 v209, v129
    v_mfma_f32_16x16x32_bf16 v[44:47], v[168:171], a[108:111], v[44:47]
    ds_read_b128 a[72:75], v178 offset:49152
    ds_read_b128 a[76:79], v179 offset:49152
    v_mfma_f32_16x16x32_bf16 v[108:111], v[172:175], a[108:111], v[108:111]
    v_cvt_pk_bf16_f32 v160, v208, v209
    s_waitcnt lgkmcnt(4)
    v_mfma_f32_16x16x32_bf16 v[48:51], v[168:171], a[112:115], v[48:51]
    ds_read_b128 a[80:83], v176 offset:49408
    ds_read_b128 a[84:87], v177 offset:49408
    v_mfma_f32_16x16x32_bf16 v[112:115], v[172:175], a[112:115], v[112:115]
    v_exp_f32 v210, v130
    v_mfma_f32_16x16x32_bf16 v[52:55], v[168:171], a[116:119], v[52:55]
    ds_read_b128 a[88:91], v178 offset:49408
    ds_read_b128 a[92:95], v179 offset:49408
    v_mfma_f32_16x16x32_bf16 v[116:119], v[172:175], a[116:119], v[116:119]
    v_exp_f32 v211, v131
    v_mfma_f32_16x16x32_bf16 v[56:59], v[168:171], a[120:123], v[56:59]
    v_exp_f32 v212, v136
    v_mfma_f32_16x16x32_bf16 v[120:123], v[172:175], a[120:123], v[120:123]
    v_cvt_pk_bf16_f32 v161, v210, v211
    v_mfma_f32_16x16x32_bf16 v[60:63], v[168:171], a[124:127], v[60:63]
    v_exp_f32 v213, v137
    v_mfma_f32_16x16x32_bf16 v[124:127], v[172:175], a[124:127], v[124:127]
    s_mov_b32 m0, s62
    s_waitcnt lgkmcnt(0)
    v_mfma_f32_16x16x32_bf16 v[144:147], a[64:67], a[0:3], v[232:235]
    ds_read_b128 a[96:99], v176 offset:57344
    ds_read_b128 a[100:103], v177 offset:57344
    v_mfma_f32_16x16x32_bf16 v[144:147], a[68:71], a[4:7], v[144:147]
    buffer_load_dwordx4 v188, s[24:27], s50 offen lds
    v_mfma_f32_16x16x32_bf16 v[144:147], a[72:75], a[8:11], v[144:147]
    v_exp_f32 v214, v138
    v_mfma_f32_16x16x32_bf16 v[144:147], a[76:79], a[12:15], v[144:147]
    v_cvt_pk_bf16_f32 v162, v212, v213
    v_or3_b32 v197, v160, v161, v162
    v_mfma_f32_16x16x32_bf16 v[144:147], a[80:83], a[16:19], v[144:147]
    ds_read_b128 a[104:107], v178 offset:57344
    ds_read_b128 a[108:111], v179 offset:57344
    v_mfma_f32_16x16x32_bf16 v[144:147], a[84:87], a[20:23], v[144:147]
    buffer_load_dwordx4 v189, s[24:27], s50 offen offset:1024 lds
    v_mfma_f32_16x16x32_bf16 v[144:147], a[88:91], a[24:27], v[144:147]
    v_exp_f32 v215, v139
    v_mfma_f32_16x16x32_bf16 v[144:147], a[92:95], a[28:31], v[144:147]
    v_exp_f32 v208, v132
    v_mfma_f32_16x16x32_bf16 v[148:151], a[64:67], a[32:35], v[236:239]
    ds_read_b128 a[112:115], v176 offset:57600
    ds_read_b128 a[116:119], v177 offset:57600
    v_mfma_f32_16x16x32_bf16 v[148:151], a[68:71], a[36:39], v[148:151]
    buffer_load_dwordx4 v190, s[24:27], s50 offen offset:2048 lds
    v_mfma_f32_16x16x32_bf16 v[148:151], a[72:75], a[40:43], v[148:151]
    v_cvt_pk_bf16_f32 v163, v214, v215
    v_mfma_f32_16x16x32_bf16 v[148:151], a[76:79], a[44:47], v[148:151]
    v_exp_f32 v209, v133
    v_mfma_f32_16x16x32_bf16 v[148:151], a[80:83], a[48:51], v[148:151]
    ds_read_b128 a[120:123], v178 offset:57600
    ds_read_b128 a[124:127], v179 offset:57600
    v_mfma_f32_16x16x32_bf16 v[148:151], a[84:87], a[52:55], v[148:151]
    buffer_load_dwordx4 v191, s[24:27], s50 offen offset:3072 lds
    v_mfma_f32_16x16x32_bf16 v[148:151], a[88:91], a[56:59], v[148:151]
    v_exp_f32 v210, v134
    v_mfma_f32_16x16x32_bf16 v[148:151], a[92:95], a[60:63], v[148:151]
    v_cvt_pk_bf16_f32 v164, v208, v209
    s_waitcnt lgkmcnt(0)
    v_mfma_f32_16x16x32_bf16 v[152:155], a[96:99], a[0:3], v[232:235]
    v_exp_f32 v211, v135
    v_mfma_f32_16x16x32_bf16 v[152:155], a[100:103], a[4:7], v[152:155]
    v_exp_f32 v212, v140
    v_mfma_f32_16x16x32_bf16 v[152:155], a[104:107], a[8:11], v[152:155]
    v_cvt_pk_bf16_f32 v165, v210, v211
    v_or3_b32 v197, v197, v163, v164
    v_mfma_f32_16x16x32_bf16 v[152:155], a[108:111], a[12:15], v[152:155]
    v_exp_f32 v213, v141
    v_mfma_f32_16x16x32_bf16 v[152:155], a[112:115], a[16:19], v[152:155]
    v_exp_f32 v214, v142
    v_mfma_f32_16x16x32_bf16 v[152:155], a[116:119], a[20:23], v[152:155]
    v_cvt_pk_bf16_f32 v166, v212, v213
    v_or3_b32 v197, v197, v165, v166
    v_mfma_f32_16x16x32_bf16 v[152:155], a[120:123], a[24:27], v[152:155]
    ds_read_b64_tr_b16 a[64:65], v180 offset:32768
    ds_read_b64_tr_b16 a[66:67], v180 offset:40960
    v_mfma_f32_16x16x32_bf16 v[152:155], a[124:127], a[28:31], v[152:155]
    v_exp_f32 v215, v143
    v_mfma_f32_16x16x32_bf16 v[156:159], a[96:99], a[32:35], v[236:239]
    ds_read_b64_tr_b16 a[68:69], v181 offset:32768
    ds_read_b64_tr_b16 a[70:71], v181 offset:40960
    v_mfma_f32_16x16x32_bf16 v[156:159], a[100:103], a[36:39], v[156:159]
    v_cvt_pk_bf16_f32 v167, v214, v215
    v_or_b32 v197, v197, v167
    v_mfma_f32_16x16x32_bf16 v[156:159], a[104:107], a[40:43], v[156:159]
    ds_read_b64_tr_b16 a[72:73], v182 offset:32768
    ds_read_b64_tr_b16 a[74:75], v182 offset:40960
    v_mfma_f32_16x16x32_bf16 v[156:159], a[108:111], a[44:47], v[156:159]
    v_and_b32 v197, s48, v197
    v_cmp_ne_u32 vcc, 0, v197
    v_mfma_f32_16x16x32_bf16 v[156:159], a[112:115], a[48:51], v[156:159]
    ds_read_b64_tr_b16 a[76:77], v183 offset:32768
    ds_read_b64_tr_b16 a[78:79], v183 offset:40960
    v_mfma_f32_16x16x32_bf16 v[156:159], a[116:119], a[52:55], v[156:159]
    s_add_u32 s46, s46, 1
    s_cmp_ge_u32 s46, s101
    v_mfma_f32_16x16x32_bf16 v[156:159], a[120:123], a[56:59], v[156:159]
    ds_read_b64_tr_b16 a[80:81], v184 offset:32768
    ds_read_b64_tr_b16 a[82:83], v184 offset:40960
    v_mfma_f32_16x16x32_bf16 v[156:159], a[124:127], a[60:63], v[156:159]
    s_cbranch_vccnz L_rare2
L_back2:
    s_cbranch_scc1 L_fin2
L_A3:
    v_mfma_f32_16x16x32_bf16 v[200:203], v[160:163], a[128:131], v[200:203]
    ds_read_b64_tr_b16 a[84:85], v185 offset:32768
    ds_read_b64_tr_b16 a[86:87], v185 offset:40960
    v_mfma_f32_16x16x32_bf16 v[204:207], v[164:167], a[128:131], v[204:207]
    v_readlane_b32 s51, v196, s46
    s_waitcnt lgkmcnt(6)
    v_mfma_f32_16x16x32_bf16 v[0:3], v[160:163], a[64:67], v[0:3]
    ds_read_b64_tr_b16 a[88:89], v186 offset:32768
    ds_read_b64_tr_b16 a[90:91], v186 offset:40960
    v_mfma_f32_16x16x32_bf16 v[64:67], v[164:167], a[64:67], v[64:67]
    s_add_u32 s53, s46, 2
    v_readlane_b32 s50, v196, s53
    v_mfma_f32_16x16x32_bf16 v[4:7], v[160:163], a[68:71], v[4:7]
    ds_read_b64_tr_b16 a[92:93], v187 offset:32768
    ds_read_b64_tr_b16 a[94:95], v187 offset:40960
    v_mfma_f32_16x16x32_bf16 v[68:71], v[164:167], a[68:71], v[68:71]
    s_waitcnt vmcnt(12)
    s_barrier
    v_mfma_f32_16x16x32_bf16 v[8:11], v[160:163], a[72:75], v[8:11]
    ds_read_b64_tr_b16 a[96:97], v180 offset:33024
    ds_read_b64_tr_b16 a[98:99], v180 offset:41216
    v_mfma_f32_16x16x32_bf16 v[72:75], v[164:167], a[72:75], v[72:75]
    s_mov_b32 m0, s65
    s_waitcnt lgkmcnt(6)
    v_mfma_f32_16x16x32_bf16 v[12:15], v[160:163], a[76:79], v[12:15]
    ds_read_b64_tr_b16 a[100:101], v181 offset:33024
    ds_read_b64_tr_b16 a[102:103], v181 offset:41216
    v_mfma_f32_16x16x32_bf16 v[76:79], v[164:167], a[76:79], v[76:79]
    buffer_load_dwordx4 v192, s[28:31], s51 offen lds
    v_mfma_f32_16x16x32_bf16 v[16:19], v[160:163], a[80:83], v[16:19]
    ds_read_b64_tr_b16 a[104:105], v182 offset:33024
    ds_read_b64_tr_b16 a[106:107], v182 offset:41216
    v_mfma_f32_16x16x32_bf16 v[80:83], v[164:167], a[80:83], v[80:83]
    buffer_load_dwordx4 v193, s[28:31], s51 offen offset:1024 lds
    v_mfma_f32_16x16x32_bf16 v[20:23], v[160:163], a[84:87], v[20:23]
    ds_read_b64_tr_b16 a[108:109], v183 offset:33024
    ds_read_b64_tr_b16 a[110:111], v183 offset:41216
    v_mfma_f32_16x16x32_bf16 v[84:87], v[164:167], a[84:87], v[84:87]
    s_waitcnt lgkmcnt(6)
    v_mfma_f32_16x16x32_bf16 v[24:27], v[160:163], a[88:91], v[24:27]
    ds_read_b64_tr_b16 a[112:113], v184 offset:33024
    ds_read_b64_tr_b16 a[114:115], v184 offset:41216
    v_mfma_f32_16x16x32_bf16 v[88:91], v[164:167], a[88:91], v[88:91]
    buffer_load_dwordx4 v194, s[28:31], s51 offen offset:2048 lds
    v_mfma_f32_16x16x32_bf16 v[28:31], v[160:163], a[92:95], v[28:31]
    ds_read_b64_tr_b16 a[116:117], v185 offset:33024
    ds_read_b64_tr_b16 a[118:119], v185 offset:41216
    v_mfma_f32_16x16x32_bf16 v[92:95], v[164:167], a[92:95], v[92:95]
    buffer_load_dwordx4 v195, s[28:31], s51 offen offset:3072 lds
    v_mfma_f32_16x16x32_bf16 v[32:35], v[160:163], a[96:99], v[32:35]
    ds_read_b64_tr_b16 a[120:121], v186 offset:33024
    ds_read_b64_tr_b16 a[122:123], v186 offset:41216
    v_mfma_f32_16x16x32_bf16 v[96:99], v[164:167], a[96:99], v[96:99]
    s_waitcnt lgkmcnt(6)
    v_mfma_f32_16x16x32_bf16 v[36:39], v[160:163], a[100:103], v[36:39]
    ds_read_b64_tr_b16 a[124:125], v187 offset:33024
    ds_read_b64_tr_b16 a[126:127], v187 offset:41216
    v_mfma_f32_16x16x32_bf16 v[100:103], v[164:167], a[100:103], v[100:103]
    v_exp_f32 v208, v144
    v_mfma_f32_16x16x32_bf16 v[40:43], v[160:163], a[104:107], v[40:43]
    ds_read_b128 a[64:67], v176
    ds_read_b128 a[68:71], v177
    v_mfma_f32_16x16x32_bf16 v[104:107], v[164:167], a[104:107], v[104:107]
    v_exp_f32 v209, v145
    v_mfma_f32_16x16x32_bf16 v[44:47], v[160:163], a[108:111], v[44:47]
    ds_read_b128 a[72:75], v178
    ds_read_b128 a[76:79], v179
    v_mfma_f32_16x16x32_bf16 v[108:111], v[164:167], a[108:111], v[108:111]
    v_cvt_pk_bf16_f32 v168, v208, v209
    s_waitcnt lgkmcnt(4)
    v_mfma_f32_16x16x32_bf16 v[48:51], v[160:163], a[112:115], v[48:51]
    ds_read_b128 a[80:83], v176 offset:256
    ds_read_b128 a[84:87], v177 offset:256
    v_mfma_f32_16x16x32_bf16 v[112:115], v[164:167], a[112:115], v[112:115]
    v_exp_f32 v210, v146
    v_mfma_f32_16x16x32_bf16 v[52:55], v[160:163], a[116:119], v[52:55]
    ds_read_b128 a[88:91], v178 offset:256
    ds_read_b128 a[92:95], v179 offset:256
    v_mfma_f32_16x16x32_bf16 v[116:119], v[164:167], a[116:119], v[116:119]
    v_exp_f32 v211, v147
    v_mfma_f32_16x16x32_bf16 v[56:59], v[160:163], a[120:123], v[56:59]
    v_exp_f32 v212, v152
    v_mfma_f32_16x16x32_bf16 v[120:123], v[164:167], a[120:123], v[120:123]
    v_cvt_pk_bf16_f32 v169, v210, v211
    v_mfma_f32_16x16x32_bf16 v[60:63], v[160:163], a[124:127], v[60:63]
    v_exp_f32 v213, v153
    v_mfma_f32_16x16x32_bf16 v[124:127], v[164:167], a[124:127], v[124:127]
    s_mov_b32 m0, s63
    s_waitcnt lgkmcnt(0)
    v_mfma_f32_16x16x32_bf16 v[128:131], a[64:67], a[0:3], v[232:235]
    ds_read_b128 a[96:99], v176 offset:8192
    ds_read_b128 a[100:103], v177 offset:8192
    v_mfma_f32_16x16x32_bf16 v[128:131], a[68:71], a[4:7], v[128:131]
    buffer_load_dwordx4 v188, s[24:27], s50 offen lds
    v_mfma_f32_16x16x32_bf16 v[128:131], a[72:75], a[8:11], v[128:131]
    v_exp_f32 v214, v154
    v_mfma_f32_16x16x32_bf16 v[128:131], a[76:79], a[12:15], v[128:131]
    v_cvt_pk_bf16_f32 v170, v212, v213
    v_or3_b32 v197, v168, v169, v170
    v_mfma_f32_16x16x32_bf16 v[128:131], a[80:83], a[16:19], v[128:131]
    ds_read_b128 a[104:107], v178 offset:8192
    ds_read_b128 a[108:111], v179 offset:8192
    v_mfma_f32_16x16x32_bf16 v[128:131], a[84:87], a[20:23], v[128:131]
    buffer_load_dwordx4 v189, s[24:27], s50 offen offset:1024 lds
    v_mfma_f32_16x16x32_bf16 v[128:131], a[88:91], a[24:27], v[128:131]
    v_exp_f32 v215, v155
    v_mfma_f32_16x16x32_bf16 v[128:131], a[92:95], a[28:31], v[128:131]
    v_exp_f32 v208, v148
    v_mfma_f32_16x16x32_bf16 v[132:135], a[64:67], a[32:35], v[236:239]
    ds_read_b128 a[112:115], v176 offset:8448
    ds_read_b128 a[116:119], v177 offset:8448
    v_mfma_f32_16x16x32_bf16 v[132:135], a[68:71], a[36:39], v[132:135]
    buffer_load_dwordx4 v190, s[24:27], s50 offen offset:2048 lds
    v_mfma_f32_16x16x32_bf16 v[132:135], a[72:75], a[40:43], v[132:135]
    v_cvt_pk_bf16_f32 v171, v214, v215
    v_mfma_f32_16x16x32_bf16 v[132:135], a[76:79], a[44:47], v[132:135]
    v_exp_f32 v209, v149
    v_mfma_f32_16x16x32_bf16 v[132:135], a[80:83], a[48:51], v[132:135]
    ds_read_b128 a[120:123], v178 offset:8448
    ds_read_b128 a[124:127], v179 offset:8448
    v_mfma_f32_16x16x32_bf16 v[132:135], a[84:87], a[52:55], v[132:135]
    buffer_load_dwordx4 v191, s[24:27], s50 offen offset:3072 lds
    v_mfma_f32_16x16x32_bf16 v[132:135], a[88:91], a[56:59], v[132:135]
    v_exp_f32 v210, v150
    v_mfma_f32_16x16x32_bf16 v[132:135], a[92:95], a[60:63], v[132:135]
    v_cvt_pk_bf16_f32 v172, v208, v209
    s_waitcnt lgkmcnt(0)
    v_mfma_f32_16x16x32_bf16 v[136:139], a[96:99], a[0:3], v[232:235]
    v_exp_f32 v211, v151
    v_mfma_f32_16x16x32_bf16 v[136:139], a[100:103], a[4:7], v[136:139]
    v_exp_f32 v212, v156
    v_mfma_f32_16x16x32_bf16 v[136:139], a[104:107], a[8:11], v[136:139]
    v_cvt_pk_bf16_f32 v173, v210, v211
    v_or3_b32 v197, v197, v171, v172
    v_mfma_f32_16x16x32_bf16 v[136:139], a[108:111], a[12:15], v[136:139]
    v_exp_f32 v213, v157
    v_mfma_f32_16x16x32_bf16 v[136:139], a[112:115], a[16:19], v[136:139]
    v_exp_f32 v214, v158
    v_mfma_f32_16x16x32_bf16 v[136:139], a[116:119], a[20:23], v[136:139]
    v_cvt_pk_bf16_f32 v174, v212, v213
    v_or3_b32 v197, v197, v173, v174
    v_mfma_f32_16x16x32_bf16 v[136:139], a[120:123], a[24:27], v[136:139]
    ds_read_b64_tr_b16 a[64:65], v180 offset:49152
    ds_read_b64_tr_b16 a[66:67], v180 offset:57344
    v_mfma_f32_16x16x32_bf16 v[136:139], a[124:127], a[28:31], v[136:139]
    v_exp_f32 v215, v159
    v_mfma_f32_16x16x32_bf16 v[140:143], a[96:99], a[32:35], v[236:239]
    ds_read_b64_tr_b16 a[68:69], v181 offset:49152
    ds_read_b64_tr_b16 a[70:71], v181 offset:57344
    v_mfma_f32_16x16x32_bf16 v[140:143], a[100:103], a[36:39], v[140:143]
    v_cvt_pk_bf16_f32 v175, v214, v215
    v_or_b32 v197, v197, v175
    v_mfma_f32_16x16x32_bf16 v[140:143], a[104:107], a[40:43], v[140:143]
    ds_read_b64_tr_b16 a[72:73], v182 offset:49152
    ds_read_b64_tr_b16 a[74:75], v182 offset:57344
    v_mfma_f32_16x16x32_bf16 v[140:143], a[108:111], a[44:47], v[140:143]
    v_and_b32 v197, s48, v197
    v_cmp_ne_u32 vcc, 0, v197
    v_mfma_f32_16x16x32_bf16 v[140:143], a[112:115], a[48:51], v[140:143]
    ds_read_b64_tr_b16 a[76:77], v183 offset:49152
    ds_read_b64_tr_b16 a[78:79], v183 offset:57344
    v_mfma_f32_16x16x32_bf16 v[140:143], a[116:119], a[52:55], v[140:143]
    s_add_u32 s46, s46, 1
    s_cmp_ge_u32 s46, s101
    v_mfma_f32_16x16x32_bf16 v[140:143], a[120:123], a[56:59], v[140:143]
    ds_read_b64_tr_b16 a[80:81], v184 offset:49152
    ds_read_b64_tr_b16 a[82:83], v184 offset:57344
    v_mfma_f32_16x16x32_bf16 v[140:143], a[124:127], a[60:63], v[140:143]
    s_cbranch_vccnz L_rare3
L_back3:
    s_cbranch_scc1 L_fin3
L_A0:
    v_mfma_f32_16x16x32_bf16 v[200:203], v[168:171], a[128:131], v[200:203]
    ds_read_b64_tr_b16 a[84:85], v185 offset:49152
    ds_read_b64_tr_b16 a[86:87], v185 offset:57344
    v_mfma_f32_16x16x32_bf16 v[204:207], v[172:175], a[128:131], v[204:207]
    v_readlane_b32 s51, v196, s46
    s_waitcnt lgkmcnt(6)
    v_mfma_f32_16x16x32_bf16 v[0:3], v[168:171], a[64:67], v[0:3]
    ds_read_b64_tr_b16 a[88:89], v186 offset:49152
    ds_read_b64_tr_b16 a[90:91], v186 offset:57344
    v_mfma_f32_16x16x32_bf16 v[64:67], v[172:175], a[64:67], v[64:67]
    s_add_u32 s53, s46, 2
    v_readlane_b32 s50, v196, s53
    v_mfma_f32_16x16x32_bf16 v[4:7], v[168:171], a[68:71], v[4:7]
    ds_read_b64_tr_b16 a[92:93], v187 offset:49152
    ds_read_b64_tr_b16 a[94:95], v187 offset:57344
    v_mfma_f32_16x16x32_bf16 v[68:71], v[172:175], a[68:71], v[68:71]
    s_waitcnt vmcnt(12)
    s_barrier
    v_mfma_f32_16x16x32_bf16 v[8:11], v[168:171], a[72:75], v[8:11]
    ds_read_b64_tr_b16 a[96:97], v180 offset:49408
    ds_read_b64_tr_b16 a[98:99], v180 offset:57600
    v_mfma_f32_16x16x32_bf16 v[72:75], v[172:175], a[72:75], v[72:75]
    s_mov_b32 m0, s66
    s_waitcnt lgkmcnt(6)
    v_mfma_f32_16x16x32_bf16 v[12:15], v[168:171], a[76:79], v[12:15]
    ds_read_b64_tr_b16 a[100:101], v181 offset:49408
    ds_read_b64_tr_b16 a[102:103], v181 offset:57600
    v_mfma_f32_16x16x32_bf16 v[76:79], v[172:175], a[76:79], v[76:79]
    buffer_load_dwordx4 v192, s[28:31], s51 offen lds
    v_mfma_f32_16x16x32_bf16 v[16:19], v[168:171], a[80:83], v[16:19]
    ds_read_b64_tr_b16 a[104:105], v182 offset:49408
    ds_read_b64_tr_b16 a[106:107], v182 offset:57600
    v_mfma_f32_16x16x32_bf16 v[80:83], v[172:175], a[80:83], v[80:83]
    buffer_load_dwordx4 v193, s[28:31], s51 offen offset:1024 lds
    v_mfma_f32_16x16x32_bf16 v[20:23], v[168:171], a[84:87], v[20:23]
    ds_read_b64_tr_b16 a[108:109], v183 offset:49408
    ds_read_b64_tr_b16 a[110:111], v183 offset:57600
    v_mfma_f32_16x16x32_bf16 v[84:87], v[172:175], a[84:87], v[84:87]
    s_waitcnt lgkmcnt(6)
    v_mfma_f32_16x16x32_bf16 v[24:27], v[168:171], a[88:91], v[24:27]
    ds_read_b64_tr_b16 a[112:113], v184 offset:49408
    ds_read_b64_tr_b16 a[114:115], v184 offset:57600
    v_mfma_f32_16x16x32_bf16 v[88:91], v[172:175], a[88:91], v[88:91]
    buffer_load_dwordx4 v194, s[28:31], s51 offen offset:2048 lds
    v_mfma_f32_16x16x32_bf16 v[28:31], v[168:171], a[92:95], v[28:31]
    ds_read_b64_tr_b16 a[116:117], v185 offset:49408
    ds_read_b64_tr_b16 a[118:119], v185 offset:57600
    v_mfma_f32_16x16x32_bf16 v[92:95], v[172:175], a[92:95], v[92:95]
    buffer_load_dwordx4 v195, s[28:31], s51 offen offset:3072 lds
    v_mfma_f32_16x16x32_bf16 v[32:35], v[168:171], a[96:99], v[32:35]
    ds_read_b64_tr_b16 a[120:121], v186 offset:49408
    ds_read_b64_tr_b16 a[122:123], v186 offset:57600
    v_mfma_f32_16x16x32_bf16 v[96:99], v[172:175], a[96:99], v[96:99]
    s_waitcnt lgkmcnt(6)
    v_mfma_f32_16x16x32_bf16 v[36:39], v[168:171], a[100:103], v[36:39]
    ds_read_b64_tr_b16 a[124:125], v187 offset:49408
    ds_read_b64_tr_b16 a[126:127], v187 offset:57600
    v_mfma_f32_16x16x32_bf16 v[100:103], v[172:175], a[100:103], v[100:103]
    v_exp_f32 v208, v128
    v_mfma_f32_16x16x32_bf16 v[40:43], v[168:171], a[104:107], v[40:43]
    ds_read_b128 a[64:67], v176 offset:16384
    ds_read_b128 a[68:71], v177 offset:16384
    v_mfma_f32_16x16x32_bf16 v[104:107], v[172:175], a[104:107], v[104:107]
    v_exp_f32 v209, v129
    v_mfma_f32_16x16x32_bf16 v[44:47], v[168:171], a[108:111], v[44:47]
    ds_read_b128 a[72:75], v178 offset:16384
    ds_read_b128 a[76:79], v179 offset:16384
    v_mfma_f32_16x16x32_bf16 v[108:111], v[172:175], a[108:111], v[108:111]
    v_cvt_pk_bf16_f32 v160, v208, v209
    s_waitcnt lgkmcnt(4)
    v_mfma_f32_16x16x32_bf16 v[48:51], v[168:171], a[112:115], v[48:51]
    ds_read_b128 a[80:83], v176 offset:16640
    ds_read_b128 a[84:87], v177 offset:16640
    v_mfma_f32_16x16x32_bf16 v[112:115], v[172:175], a[112:115], v[112:115]
    v_exp_f32 v210, v130
    v_mfma_f32_16x16x32_bf16 v[52:55], v[168:171], a[116:119], v[52:55]
    ds_read_b128 a[88:91], v178 offset:16640
    ds_read_b128 a[92:95], v179 offset:16640
    v_mfma_f32_16x16x32_bf16 v[116:119], v[172:175], a[116:119], v[116:119]
    v_exp_f32 v211, v131
    v_mfma_f32_16x16x32_bf16 v[56:59], v[168:171], a[120:123], v[56:59]
    v_exp_f32 v212, v136
    v_mfma_f32_16x16x32_bf16 v[120:123], v[172:175], a[120:123], v[120:123]
    v_cvt_pk_bf16_f32 v161, v210, v211
    v_mfma_f32_16x16x32_bf16 v[60:63], v[168:171], a[124:127], v[60:63]
    v_exp_f32 v213, v137
    v_mfma_f32_16x16x32_bf16 v[124:127], v[172:175], a[124:127], v[124:127]
    s_mov_b32 m0, s60
    s_waitcnt lgkmcnt(0)
    v_mfma_f32_16x16x32_bf16 v[144:147], a[64:67], a[0:3], v[232:235]
    ds_read_b128 a[96:99], v176 offset:24576
    ds_read_b128 a[100:103], v177 offset:24576
    v_mfma_f32_16x16x32_bf16 v[144:147], a[68:71], a[4:7], v[144:147]
    buffer_load_dwordx4 v188, s[24:27], s50 offen lds
    v_mfma_f32_16x16x32_bf16 v[144:147], a[72:75], a[8:11], v[144:147]
    v_exp_f32 v214, v138
    v_mfma_f32_16x16x32_bf16 v[144:147], a[76:79], a[12:15], v[144:147]
    v_cvt_pk_bf16_f32 v162, v212, v213
    v_or3_b32 v197, v160, v161, v162
    v_mfma_f32_16x16x32_bf16 v[144:147], a[80:83], a[16:19], v[144:147]
    ds_read_b128 a[104:107], v178 offset:24576
    ds_read_b128 a[108:111], v179 offset:24576
    v_mfma_f32_16x16x32_bf16 v[144:147], a[84:87], a[20:23], v[144:147]
    buffer_load_dwordx4 v189, s[24:27], s50 offen offset:1024 lds
    v_mfma_f32_16x16x32_bf16 v[144:147], a[88:91], a[24:27], v[144:147]
    v_exp_f32 v215, v139
    v_mfma_f32_16x16x32_bf16 v[144:147], a[92:95], a[28:31], v[144:147]
    v_exp_f32 v208, v132
    v_mfma_f32_16x16x32_bf16 v[148:151], a[64:67], a[32:35], v[236:239]
    ds_read_b128 a[112:115], v176 offset:24832
    ds_read_b128 a[116:119], v177 offset:24832
    v_mfma_f32_16x16x32_bf16 v[148:151], a[68:71], a[36:39], v[148:151]
    buffer_load_dwordx4 v190, s[24:27], s50 offen offset:2048 lds
    v_mfma_f32_16x16x32_bf16 v[148:151], a[72:75], a[40:43], v[148:151]
    v_cvt_pk_bf16_f32 v163, v214, v215
    v_mfma_f32_16x16x32_bf16 v[148:151], a[76:79], a[44:47], v[148:151]
    v_exp_f32 v209, v133
    v_mfma_f32_16x16x32_bf16 v[148:151], a[80:83], a[48:51], v[148:151]
    ds_read_b128 a[120:123], v178 offset:24832
    ds_read_b128 a[124:127], v179 offset:24832
    v_mfma_f32_16x16x32_bf16 v[148:151], a[84:87], a[52:55], v[148:151]
    buffer_load_dwordx4 v191, s[24:27], s50 offen offset:3072 lds
    v_mfma_f32_16x16x32_bf16 v[148:151], a[88:91], a[56:59], v[148:151]
    v_exp_f32 v210, v134
    v_mfma_f32_16x16x32_bf16 v[148:151], a[92:95], a[60:63], v[148:151]
    v_cvt_pk_bf16_f32 v164, v208, v209
    s_waitcnt lgkmcnt(0)
    v_mfma_f32_16x16x32_bf16 v[152:155], a[96:99], a[0:3], v[232:235]
    v_exp_f32 v211, v135
    v_mfma_f32_16x16x32_bf16 v[152:155], a[100:103], a[4:7], v[152:155]
    v_exp_f32 v212, v140
    v_mfma_f32_16x16x32_bf16 v[152:155], a[104:107], a[8:11], v[152:155]
    v_cvt_pk_bf16_f32 v165, v210, v211
    v_or3_b32 v197, v197, v163, v164
    v_mfma_f32_16x16x32_bf16 v[152:155], a[108:111], a[12:15], v[152:155]
    v_exp_f32 v213, v141
    v_mfma_f32_16x16x32_bf16 v[152:155], a[112:115], a[16:19], v[152:155]
    v_exp_f32 v214, v142
    v_mfma_f32_16x16x32_bf16 v[152:155], a[116:119], a[20:23], v[152:155]
    v_cvt_pk_bf16_f32 v166, v212, v213
    v_or3_b32 v197, v197, v165, v166
    v_mfma_f32_16x16x32_bf16 v[152:155], a[120:123], a[24:27], v[152:155]
    ds_read_b64_tr_b16 a[64:65], v180
    ds_read_b64_tr_b16 a[66:67], v180 offset:8192
    v_mfma_f32_16x16x32_bf16 v[152:155], a[124:127], a[28:31], v[152:155]
    v_exp_f32 v215, v143
    v_mfma_f32_16x16x32_bf16 v[156:159], a[96:99], a[32:35], v[236:239]
    ds_read_b64_tr_b16 a[68:69], v181
    ds_read_b64_tr_b16 a[70:71], v181 offset:8192
    v_mfma_f32_16x16x32_bf16 v[156:159], a[100:103], a[36:39], v[156:159]
    v_cvt_pk_bf16_f32 v167, v214, v215
    v_or_b32 v197, v197, v167
    v_mfma_f32_16x16x32_bf16 v[156:159], a[104:107], a[40:43], v[156:159]
    ds_read_b64_tr_b16 a[72:73], v182
    ds_read_b64_tr_b16 a[74:75], v182 offset:8192
    v_mfma_f32_16x16x32_bf16 v[156:159], a[108:111], a[44:47], v[156:159]
    v_and_b32 v197, s48, v197
    v_cmp_ne_u32 vcc, 0, v197
    v_mfma_f32_16x16x32_bf16 v[156:159], a[112:115], a[48:51], v[156:159]
    ds_read_b64_tr_b16 a[76:77], v183
    ds_read_b64_tr_b16 a[78:79], v183 offset:8192
    v_mfma_f32_16x16x32_bf16 v[156:159], a[116:119], a[52:55], v[156:159]
    s_add_u32 s46, s46, 1
    s_cmp_ge_u32 s46, s101
    v_mfma_f32_16x16x32_bf16 v[156:159], a[120:123], a[56:59], v[156:159]
    ds_read_b64_tr_b16 a[80:81], v184
    ds_read_b64_tr_b16 a[82:83], v184 offset:8192
    v_mfma_f32_16x16x32_bf16 v[156:159], a[124:127], a[60:63], v[156:159]
    s_cbranch_vccnz L_rare0
L_back0:
    s_cbranch_scc1 L_fin0
    s_branch L_loop
    .p2align 6
L_fin0:
    v_readlane_b32 s51, v196, s46
    s_waitcnt vmcnt(8) lgkmcnt(0)
    s_barrier
    ds_read_b128 a[64:67], v176 offset:32768
    ds_read_b128 a[68:71], v177 offset:32768
    ds_read_b128 a[72:75], v178 offset:32768
    ds_read_b128 a[76:79], v179 offset:32768
    ds_read_b128 a[80:83], v176 offset:33024
    ds_read_b128 a[84:87], v177 offset:33024
    ds_read_b128 a[88:91], v178 offset:33024
    ds_read_b128 a[92:95], v179 offset:33024
    v_exp_f32 v208, v144
    v_exp_f32 v209, v145
    v_exp_f32 v210, v146
    v_cvt_pk_bf16_f32 v168, v208, v209
    s_waitcnt lgkmcnt(7)
    v_mfma_f32_16x16x32_bf16 v[128:131], a[64:67], a[0:3], v[232:235]
    ds_read_b128 a[96:99], v176 offset:40960
    ds_read_b128 a[100:103], v177 offset:40960
    s_waitcnt lgkmcnt(8)
    v_mfma_f32_16x16x32_bf16 v[128:131], a[68:71], a[4:7], v[128:131]
    ds_read_b128 a[104:107], v178 offset:40960
    ds_read_b128 a[108:111], v179 offset:40960
    s_waitcnt lgkmcnt(9)
    v_mfma_f32_16x16x32_bf16 v[128:131], a[72:75], a[8:11], v[128:131]
    ds_read_b128 a[112:115], v176 offset:41216
    ds_read_b128 a[116:119], v177 offset:41216
    s_waitcnt lgkmcnt(10)
    v_mfma_f32_16x16x32_bf16 v[128:131], a[76:79], a[12:15], v[128:131]
    ds_read_b128 a[120:123], v178 offset:41216
    ds_read_b128 a[124:127], v179 offset:41216
    s_waitcnt lgkmcnt(8)
    v_mfma_f32_16x16x32_bf16 v[128:131], a[80:83], a[16:19], v[128:131]
    s_mov_b32 m0, s67
    s_nop 0
    v_mfma_f32_16x16x32_bf16 v[128:131], a[84:87], a[20:23], v[128:131]
    buffer_load_dwordx4 v192, s[28:31], s51 offen lds
    v_mfma_f32_16x16x32_bf16 v[128:131], a[88:91], a[24:27], v[128:131]
    v_exp_f32 v211, v147
    v_mfma_f32_16x16x32_bf16 v[128:131], a[92:95], a[28:31], v[128:131]
    v_exp_f32 v212, v152
    v_cvt_pk_bf16_f32 v169, v210, v211
    v_mfma_f32_16x16x32_bf16 v[132:135], a[64:67], a[32:35], v[236:239]
    v_exp_f32 v213, v153
    v_mfma_f32_16x16x32_bf16 v[132:135], a[68:71], a[36:39], v[132:135]
    buffer_load_dwordx4 v193, s[28:31], s51 offen offset:1024 lds
    v_mfma_f32_16x16x32_bf16 v[132:135], a[72:75], a[40:43], v[132:135]
    v_exp_f32 v214, v154
    v_cvt_pk_bf16_f32 v170, v212, v213
    v_mfma_f32_16x16x32_bf16 v[132:135], a[76:79], a[44:47], v[132:135]
    v_exp_f32 v215, v155
    v_mfma_f32_16x16x32_bf16 v[132:135], a[80:83], a[48:51], v[132:135]
    v_exp_f32 v208, v148
    v_cvt_pk_bf16_f32 v171, v214, v215
    v_mfma_f32_16x16x32_bf16 v[132:135], a[84:87], a[52:55], v[132:135]
    buffer_load_dwordx4 v194, s[28:31], s51 offen offset:2048 lds
    v_or3_b32 v197, v168, v169, v170
    v_mfma_f32_16x16x32_bf16 v[132:135], a[88:91], a[56:59], v[132:135]
    v_exp_f32 v209, v149
    v_mfma_f32_16x16x32_bf16 v[132:135], a[92:95], a[60:63], v[132:135]
    v_exp_f32 v210, v150
    v_cvt_pk_bf16_f32 v172, v208, v209
    s_waitcnt lgkmcnt(0)
    v_mfma_f32_16x16x32_bf16 v[136:139], a[96:99], a[0:3], v[232:235]
    v_exp_f32 v211, v151
    v_mfma_f32_16x16x32_bf16 v[136:139], a[100:103], a[4:7], v[136:139]
    ds_read_b128 a[64:67], v176 offset:49152
    ds_read_b128 a[68:71], v177 offset:49152
    buffer_load_dwordx4 v195, s[28:31], s51 offen offset:3072 lds
    v_mfma_f32_16x16x32_bf16 v[136:139], a[104:107], a[8:11], v[136:139]
    ds_read_b128 a[72:75], v178 offset:49152
    ds_read_b128 a[76:79], v179 offset:49152
    v_mfma_f32_16x16x32_bf16 v[136:139], a[108:111], a[12:15], v[136:139]
    ds_read_b128 a[80:83], v176 offset:49408
    ds_read_b128 a[84:87], v177 offset:49408
    v_mfma_f32_16x16x32_bf16 v[136:139], a[112:115], a[16:19], v[136:139]
    ds_read_b128 a[88:91], v178 offset:49408
    ds_read_b128 a[92:95], v179 offset:49408
    v_mfma_f32_16x16x32_bf16 v[136:139], a[116:119], a[20:23], v[136:139]
    v_exp_f32 v212, v156
    v_cvt_pk_bf16_f32 v173, v210, v211
    v_mfma_f32_16x16x32_bf16 v[136:139], a[120:123], a[24:27], v[136:139]
    v_or3_b32 v197, v197, v171, v172
    v_exp_f32 v213, v157
    v_mfma_f32_16x16x32_bf16 v[136:139], a[124:127], a[28:31], v[136:139]
    v_exp_f32 v214, v158
    v_cvt_pk_bf16_f32 v174, v212, v213
    v_mfma_f32_16x16x32_bf16 v[140:143], a[96:99], a[32:35], v[236:239]
    v_exp_f32 v215, v159
    v_or3_b32 v197, v197, v173, v174
    v_mfma_f32_16x16x32_bf16 v[140:143], a[100:103], a[36:39], v[140:143]
    v_cvt_pk_bf16_f32 v175, v214, v215
    v_or_b32 v197, v197, v175
    v_and_b32 v197, s48, v197
    v_mfma_f32_16x16x32_bf16 v[140:143], a[104:107], a[40:43], v[140:143]
    v_cmp_ne_u32 vcc, 0, v197
    v_mfma_f32_16x16x32_bf16 v[140:143], a[108:111], a[44:47], v[140:143]
    v_mfma_f32_16x16x32_bf16 v[140:143], a[112:115], a[48:51], v[140:143]
    v_mfma_f32_16x16x32_bf16 v[140:143], a[116:119], a[52:55], v[140:143]
    v_mfma_f32_16x16x32_bf16 v[140:143], a[120:123], a[56:59], v[140:143]
    v_mfma_f32_16x16x32_bf16 v[140:143], a[124:127], a[60:63], v[140:143]
    s_add_u32 s54, s46, -1
    s_cmp_lt_u32 s54, s45
    s_cbranch_scc1 L_fok0_1
    v_mov_b32 v168, 0
    v_mov_b32 v169, 0
    v_mov_b32 v170, 0
    v_mov_b32 v171, 0
    v_mov_b32 v172, 0
    v_mov_b32 v173, 0
    v_mov_b32 v174, 0
    v_mov_b32 v175, 0
    s_branch L_fback0_1
L_fok0_1:
    s_cbranch_vccnz L_frare0_1
L_fback0_1:
    s_waitcnt lgkmcnt(0)
    v_mfma_f32_16x16x32_bf16 v[144:147], a[64:67], a[0:3], v[232:235]
    ds_read_b128 a[96:99], v176 offset:57344
    ds_read_b128 a[100:103], v177 offset:57344
    s_lshl_b32 s56, s49, 13
    v_mfma_f32_16x16x32_bf16 v[144:147], a[68:71], a[4:7], v[144:147]
    ds_read_b128 a[104:107], v178 offset:57344
    ds_read_b128 a[108:111], v179 offset:57344
    s_add_u32 s56, s56, 131072
    v_mfma_f32_16x16x32_bf16 v[144:147], a[72:75], a[8:11], v[144:147]
    ds_read_b128 a[112:115], v176 offset:57600
    ds_read_b128 a[116:119], v177 offset:57600
    v_and_b32 v227, 3, v216
    v_mfma_f32_16x16x32_bf16 v[144:147], a[76:79], a[12:15], v[144:147]
    ds_read_b128 a[120:123], v178 offset:57600
    ds_read_b128 a[124:127], v179 offset:57600
    v_bfe_u32 v198, v216, 3, 1
    v_mfma_f32_16x16x32_bf16 v[144:147], a[80:83], a[16:19], v[144:147]
    v_exp_f32 v208, v128
    v_lshl_add_u32 v227, v198, 2, v227
    v_mfma_f32_16x16x32_bf16 v[144:147], a[84:87], a[20:23], v[144:147]
    v_exp_f32 v209, v129
    v_lshrrev_b32 v198, 4, v216
    v_mfma_f32_16x16x32_bf16 v[144:147], a[88:91], a[24:27], v[144:147]
    v_exp_f32 v210, v130
    v_cvt_pk_bf16_f32 v240, v208, v209
    v_mfma_f32_16x16x32_bf16 v[144:147], a[92:95], a[28:31], v[144:147]
    v_exp_f32 v211, v131
    v_lshl_add_u32 v227, v198, 6, v227
    v_mfma_f32_16x16x32_bf16 v[148:151], a[64:67], a[32:35], v[236:239]
    v_exp_f32 v212, v136
    v_cvt_pk_bf16_f32 v241, v210, v211
    v_mfma_f32_16x16x32_bf16 v[148:151], a[68:71], a[36:39], v[148:151]
    v_exp_f32 v213, v137
    v_bfe_u32 v198, v216, 2, 1
    v_mfma_f32_16x16x32_bf16 v[148:151], a[72:75], a[40:43], v[148:151]
    v_exp_f32 v214, v138
    v_cvt_pk_bf16_f32 v242, v212, v213
    v_mfma_f32_16x16x32_bf16 v[148:151], a[76:79], a[44:47], v[148:151]
    v_exp_f32 v215, v139
    v_lshl_add_u32 v227, v198, 5, v227
    v_mfma_f32_16x16x32_bf16 v[148:151], a[80:83], a[48:51], v[148:151]
    v_exp_f32 v208, v132
    v_cvt_pk_bf16_f32 v243, v214, v215
    v_mfma_f32_16x16x32_bf16 v[148:151], a[84:87], a[52:55], v[148:151]
    v_or3_b32 v197, v240, v241, v242
    v_exp_f32 v209, v133
    v_mfma_f32_16x16x32_bf16 v[148:151], a[88:91], a[56:59], v[148:151]
    v_exp_f32 v210, v134
    v_cvt_pk_bf16_f32 v244, v208, v209
    v_mfma_f32_16x16x32_bf16 v[148:151], a[92:95], a[60:63], v[148:151]
    v_exp_f32 v211, v135
    v_lshl_add_u32 v227, v198, 3, v227
    s_waitcnt lgkmcnt(0)
    v_mfma_f32_16x16x32_bf16 v[152:155], a[96:99], a[0:3], v[232:235]
    v_exp_f32 v212, v140
    v_cvt_pk_bf16_f32 v245, v210, v211
    v_mfma_f32_16x16x32_bf16 v[152:155], a[100:103], a[4:7], v[152:155]
    v_or3_b32 v197, v197, v243, v244
    v_exp_f32 v213, v141
    v_mfma_f32_16x16x32_bf16 v[152:155], a[104:107], a[8:11], v[152:155]
    v_exp_f32 v214, v142
    v_cvt_pk_bf16_f32 v246, v212, v213
    v_mfma_f32_16x16x32_bf16 v[152:155], a[108:111], a[12:15], v[152:155]
    v_exp_f32 v215, v143
    v_or3_b32 v197, v197, v245, v246
    v_mfma_f32_16x16x32_bf16 v[152:155], a[112:115], a[16:19], v[152:155]
    v_cvt_pk_bf16_f32 v247, v214, v215
    v_or_b32 v197, v197, v247
    v_and_b32 v197, s48, v197
    v_mfma_f32_16x16x32_bf16 v[152:155], a[116:119], a[20:23], v[152:155]
    v_cmp_ne_u32 vcc, 0, v197
    v_xor_b32 v228, 8, v227
    v_lshl_add_u32 v227, v227, 3, s56
    v_mfma_f32_16x16x32_bf16 v[152:155], a[120:123], a[24:27], v[152:155]
    v_lshl_add_u32 v228, v228, 3, s56
    v_bfe_u32 v229, v216, 2, 2
    v_and_b32 v198, 3, v216
    v_mfma_f32_16x16x32_bf16 v[152:155], a[124:127], a[28:31], v[152:155]
    v_lshl_add_u32 v229, v198, 2, v229
    v_bfe_u32 v198, v216, 4, 1
    v_lshl_add_u32 v229, v198, 4, v229
    v_mfma_f32_16x16x32_bf16 v[156:159], a[96:99], a[32:35], v[236:239]
    v_bfe_u32 v198, v216, 5, 1
    v_lshl_add_u32 v229, v198, 6, v229
    v_xor_b32 v230, 8, v229
    v_mfma_f32_16x16x32_bf16 v[156:159], a[100:103], a[36:39], v[156:159]
    v_lshl_add_u32 v229, v229, 3, s56
    v_lshl_add_u32 v230, v230, 3, s56
    v_lshrrev_b32 v198, 3, v216
    v_mfma_f32_16x16x32_bf16 v[156:159], a[104:107], a[40:43], v[156:159]
    v_lshlrev_b32 v198, 9, v198
    v_and_b32 v199, 7, v216
    v_lshl_add_u32 v231, v199, 4, v198
    v_mfma_f32_16x16x32_bf16 v[156:159], a[108:111], a[44:47], v[156:159]
    s_add_u32 s84, s58, 0
    s_add_u32 s85, s58, 4096
    s_add_u32 s86, s58, 8192
    v_mfma_f32_16x16x32_bf16 v[156:159], a[112:115], a[48:51], v[156:159]
    s_add_u32 s87, s58, 12288
    v_mfma_f32_16x16x32_bf16 v[156:159], a[116:119], a[52:55], v[156:159]
    v_mfma_f32_16x16x32_bf16 v[156:159], a[120:123], a[56:59], v[156:159]
    v_mfma_f32_16x16x32_bf16 v[156:159], a[124:127], a[60:63], v[156:159]
    s_mov_b32 s54, s46
    s_cmp_lt_u32 s54, s45
    s_cbranch_scc1 L_fok0_2
    v_mov_b32 v240, 0
    v_mov_b32 v241, 0
    v_mov_b32 v242, 0
    v_mov_b32 v243, 0
    v_mov_b32 v244, 0
    v_mov_b32 v245, 0
    v_mov_b32 v246, 0
    v_mov_b32 v247, 0
    s_branch L_fback0_2
L_fok0_2:
    s_cbranch_vccnz L_frare0_2
L_fback0_2:
    s_waitcnt vmcnt(0)
    s_barrier
    ds_read_b64_tr_b16 a[64:65], v180
    ds_read_b64_tr_b16 a[66:67], v180 offset:8192
    ds_read_b64_tr_b16 a[68:69], v180 offset:16384
    ds_read_b64_tr_b16 a[70:71], v180 offset:24576
    ds_read_b64_tr_b16 a[72:73], v180 offset:32768
    ds_read_b64_tr_b16 a[74:75], v180 offset:40960
    ds_read_b64_tr_b16 a[76:77], v180 offset:49152
    ds_read_b64_tr_b16 a[78:79], v180 offset:57344
    ds_read_b64_tr_b16 a[80:81], v181
    ds_read_b64_tr_b16 a[82:83], v181 offset:8192
    ds_read_b64_tr_b16 a[84:85], v181 offset:16384
    ds_read_b64_tr_b16 a[86:87], v181 offset:24576
    v_mfma_f32_16x16x32_bf16 v[200:203], v[160:163], a[128:131], v[200:203]
    v_mfma_f32_16x16x32_bf16 v[200:203], v[168:171], a[128:131], v[200:203]
    v_exp_f32 v208, v144
    v_exp_f32 v209, v145
    v_mfma_f32_16x16x32_bf16 v[200:203], v[240:243], a[128:131], v[200:203]
    v_exp_f32 v210, v146
    v_cvt_pk_bf16_f32 v248, v208, v209
    v_mfma_f32_16x16x32_bf16 v[204:207], v[164:167], a[128:131], v[204:207]
    v_exp_f32 v211, v147
    v_exp_f32 v212, v152
    v_mfma_f32_16x16x32_bf16 v[204:207], v[172:175], a[128:131], v[204:207]
    v_cvt_pk_bf16_f32 v249, v210, v211
    v_exp_f32 v213, v153
    v_mfma_f32_16x16x32_bf16 v[204:207], v[244:247], a[128:131], v[204:207]
    v_exp_f32 v214, v154
    v_cvt_pk_bf16_f32 v250, v212, v213
    v_exp_f32 v215, v155
    v_exp_f32 v208, v148
    v_cvt_pk_bf16_f32 v251, v214, v215
    v_or3_b32 v197, v248, v249, v250
    v_exp_f32 v209, v149
    v_exp_f32 v210, v150
    v_cvt_pk_bf16_f32 v252, v208, v209
    v_exp_f32 v211, v151
    v_exp_f32 v212, v156
    v_cvt_pk_bf16_f32 v253, v210, v211
    v_or3_b32 v197, v197, v251, v252
    v_exp_f32 v213, v157
    v_exp_f32 v214, v158
    v_cvt_pk_bf16_f32 v254, v212, v213
    v_exp_f32 v215, v159
    v_or3_b32 v197, v197, v253, v254
    v_cvt_pk_bf16_f32 v255, v214, v215
    v_or_b32 v197, v197, v255
    v_and_b32 v197, s48, v197
    v_cmp_ne_u32 vcc, 0, v197
    s_add_u32 s54, s46, 1
    s_cmp_lt_u32 s54, s45
    s_cbranch_scc1 L_fok0_3
    v_mov_b32 v248, 0
    v_mov_b32 v249, 0
    v_mov_b32 v250, 0
    v_mov_b32 v251, 0
    v_mov_b32 v252, 0
    v_mov_b32 v253, 0
    v_mov_b32 v254, 0
    v_mov_b32 v255, 0
    s_branch L_fback0_3
L_fok0_3:
    s_cbranch_vccnz L_frare0_3
L_fback0_3:
    s_nop 7
    v_mfma_f32_16x16x32_bf16 v[200:203], v[248:251], a[128:131], v[200:203]
    v_mfma_f32_16x16x32_bf16 v[204:207], v[252:255], a[128:131], v[204:207]
    s_waitcnt lgkmcnt(0)
    v_mfma_f32_16x16x32_bf16 v[0:3], v[160:163], a[64:67], v[0:3]
    ds_read_b64_tr_b16 a[88:89], v181 offset:32768
    ds_read_b64_tr_b16 a[90:91], v181 offset:40960
    v_mfma_f32_16x16x32_bf16 v[0:3], v[168:171], a[68:71], v[0:3]
    v_mfma_f32_16x16x32_bf16 v[0:3], v[240:243], a[72:75], v[0:3]
    ds_read_b64_tr_b16 a[92:93], v181 offset:49152
    ds_read_b64_tr_b16 a[94:95], v181 offset:57344
    v_mfma_f32_16x16x32_bf16 v[0:3], v[248:251], a[76:79], v[0:3]
    v_mfma_f32_16x16x32_bf16 v[64:67], v[164:167], a[64:67], v[64:67]
    ds_read_b64_tr_b16 a[96:97], v182
    ds_read_b64_tr_b16 a[98:99], v182 offset:8192
    v_mfma_f32_16x16x32_bf16 v[64:67], v[172:175], a[68:71], v[64:67]
    v_rcp_f32 v200, v200
    v_mfma_f32_16x16x32_bf16 v[64:67], v[244:247], a[72:75], v[64:67]
    ds_read_b64_tr_b16 a[100:101], v182 offset:16384
    ds_read_b64_tr_b16 a[102:103], v182 offset:24576
    v_mfma_f32_16x16x32_bf16 v[64:67], v[252:255], a[76:79], v[64:67]
    v_rcp_f32 v201, v201
    v_mfma_f32_16x16x32_bf16 v[4:7], v[160:163], a[80:83], v[4:7]
    ds_read_b64_tr_b16 a[104:105], v182 offset:32768
    ds_read_b64_tr_b16 a[106:107], v182 offset:40960
    v_mfma_f32_16x16x32_bf16 v[4:7], v[168:171], a[84:87], v[4:7]
    v_rcp_f32 v202, v202
    s_waitcnt lgkmcnt(8)
    v_mfma_f32_16x16x32_bf16 v[4:7], v[240:243], a[88:91], v[4:7]
    ds_read_b64_tr_b16 a[108:109], v182 offset:49152
    ds_read_b64_tr_b16 a[110:111], v182 offset:57344
    s_waitcnt lgkmcnt(8)
    v_mfma_f32_16x16x32_bf16 v[4:7], v[248:251], a[92:95], v[4:7]
    v_rcp_f32 v203, v203
    v_mfma_f32_16x16x32_bf16 v[68:71], v[164:167], a[80:83], v[68:71]
    ds_read_b64_tr_b16 a[112:113], v183
    ds_read_b64_tr_b16 a[114:115], v183 offset:8192
    v_mfma_f32_16x16x32_bf16 v[68:71], v[172:175], a[84:87], v[68:71]
    v_rcp_f32 v204, v204
    v_mfma_f32_16x16x32_bf16 v[68:71], v[244:247], a[88:91], v[68:71]
    ds_read_b64_tr_b16 a[116:117], v183 offset:16384
    ds_read_b64_tr_b16 a[118:119], v183 offset:24576
    v_mfma_f32_16x16x32_bf16 v[68:71], v[252:255], a[92:95], v[68:71]
    v_rcp_f32 v205, v205
    s_waitcnt lgkmcnt(7)
    v_mfma_f32_16x16x32_bf16 v[8:11], v[160:163], a[96:99], v[8:11]
    ds_read_b64_tr_b16 a[120:121], v183 offset:32768
    ds_read_b64_tr_b16 a[122:123], v183 offset:40960
    v_mfma_f32_16x16x32_bf16 v[8:11], v[168:171], a[100:103], v[8:11]
    v_rcp_f32 v206, v206
    s_waitcnt lgkmcnt(7)
    v_mfma_f32_16x16x32_bf16 v[8:11], v[240:243], a[104:107], v[8:11]
    ds_read_b64_tr_b16 a[124:125], v183 offset:49152
    ds_read_b64_tr_b16 a[126:127], v183 offset:57344
    s_waitcnt lgkmcnt(8)
    v_mfma_f32_16x16x32_bf16 v[8:11], v[248:251], a[108:111], v[8:11]
    v_rcp_f32 v207, v207
    v_mfma_f32_16x16x32_bf16 v[72:75], v[164:167], a[96:99], v[72:75]
    ds_read_b64_tr_b16 a[64:65], v184
    ds_read_b64_tr_b16 a[66:67], v184 offset:8192
    v_mfma_f32_16x16x32_bf16 v[72:75], v[172:175], a[100:103], v[72:75]
    v_mfma_f32_16x16x32_bf16 v[72:75], v[244:247], a[104:107], v[72:75]
    ds_read_b64_tr_b16 a[68:69], v184 offset:16384
    ds_read_b64_tr_b16 a[70:71], v184 offset:24576
    v_mfma_f32_16x16x32_bf16 v[72:75], v[252:255], a[108:111], v[72:75]
    s_waitcnt lgkmcnt(8)
    v_mfma_f32_16x16x32_bf16 v[12:15], v[160:163], a[112:115], v[12:15]
    ds_read_b64_tr_b16 a[72:73], v184 offset:32768
    ds_read_b64_tr_b16 a[74:75], v184 offset:40960
    v_mfma_f32_16x16x32_bf16 v[12:15], v[168:171], a[116:119], v[12:15]
    s_waitcnt lgkmcnt(8)
    v_mfma_f32_16x16x32_bf16 v[12:15], v[240:243], a[120:123], v[12:15]
    ds_read_b64_tr_b16 a[76:77], v184 offset:49152
    ds_read_b64_tr_b16 a[78:79], v184 offset:57344
    s_waitcnt lgkmcnt(8)
    v_mfma_f32_16x16x32_bf16 v[12:15], v[248:251], a[124:127], v[12:15]
    v_mfma_f32_16x16x32_bf16 v[76:79], v[164:167], a[112:115], v[76:79]
    ds_read_b64_tr_b16 a[80:81], v185
    ds_read_b64_tr_b16 a[82:83], v185 offset:8192
    v_mfma_f32_16x16x32_bf16 v[76:79], v[172:175], a[116:119], v[76:79]
    v_mfma_f32_16x16x32_bf16 v[76:79], v[244:247], a[120:123], v[76:79]
    ds_read_b64_tr_b16 a[84:85], v185 offset:16384
    ds_read_b64_tr_b16 a[86:87], v185 offset:24576
    v_mfma_f32_16x16x32_bf16 v[76:79], v[252:255], a[124:127], v[76:79]
    s_waitcnt lgkmcnt(8)
    v_mfma_f32_16x16x32_bf16 v[16:19], v[160:163], a[64:67], v[16:19]
    ds_read_b64_tr_b16 a[88:89], v185 offset:32768
    ds_read_b64_tr_b16 a[90:91], v185 offset:40960
    v_mfma_f32_16x16x32_bf16 v[16:19], v[168:171], a[68:71], v[16:19]
    s_waitcnt lgkmcnt(8)
    v_mfma_f32_16x16x32_bf16 v[16:19], v[240:243], a[72:75], v[16:19]
    ds_read_b64_tr_b16 a[92:93], v185 offset:49152
    ds_read_b64_tr_b16 a[94:95], v185 offset:57344
    s_waitcnt lgkmcnt(8)
    v_mfma_f32_16x16x32_bf16 v[16:19], v[248:251], a[76:79], v[16:19]
    v_mul_f32 v0, v0, v200
    v_mul_f32 v1, v1, v201
    v_mul_f32 v4, v4, v200
    v_mfma_f32_16x16x32_bf16 v[80:83], v[164:167], a[64:67], v[80:83]
    ds_read_b64_tr_b16 a[96:97], v186
    ds_read_b64_tr_b16 a[98:99], v186 offset:8192
    v_mul_f32 v5, v5, v201
    v_mfma_f32_16x16x32_bf16 v[80:83], v[172:175], a[68:71], v[80:83]
    v_mul_f32 v8, v8, v200
    v_mul_f32 v9, v9, v201
    v_mul_f32 v12, v12, v200
    v_mfma_f32_16x16x32_bf16 v[80:83], v[244:247], a[72:75], v[80:83]
    ds_read_b64_tr_b16 a[100:101], v186 offset:16384
    ds_read_b64_tr_b16 a[102:103], v186 offset:24576
    v_mul_f32 v13, v13, v201
    v_mfma_f32_16x16x32_bf16 v[80:83], v[252:255], a[76:79], v[80:83]
    v_cvt_pk_bf16_f32 v128, v0, v4
    v_cvt_pk_bf16_f32 v129, v8, v12
    ds_write_b64 v227, v[128:129]
    s_waitcnt lgkmcnt(5)
    v_mfma_f32_16x16x32_bf16 v[20:23], v[160:163], a[80:83], v[20:23]
    ds_read_b64_tr_b16 a[104:105], v186 offset:32768
    ds_read_b64_tr_b16 a[106:107], v186 offset:40960
    v_cvt_pk_bf16_f32 v130, v1, v5
    v_mfma_f32_16x16x32_bf16 v[20:23], v[168:171], a[84:87], v[20:23]
    v_cvt_pk_bf16_f32 v131, v9, v13
    ds_write_b64 v228, v[130:131]
    v_mul_f32 v2, v2, v202
    v_mfma_f32_16x16x32_bf16 v[20:23], v[240:243], a[88:91], v[20:23]
    ds_read_b64_tr_b16 a[108:109], v186 offset:49152
    ds_read_b64_tr_b16 a[110:111], v186 offset:57344
    v_mul_f32 v3, v3, v203
    v_mfma_f32_16x16x32_bf16 v[20:23], v[248:251], a[92:95], v[20:23]
    v_mul_f32 v6, v6, v202
    v_mul_f32 v7, v7, v203
    v_mul_f32 v10, v10, v202
    v_mfma_f32_16x16x32_bf16 v[84:87], v[164:167], a[80:83], v[84:87]
    ds_read_b64_tr_b16 a[112:113], v187
    ds_read_b64_tr_b16 a[114:115], v187 offset:8192
    v_mul_f32 v11, v11, v203
    v_mfma_f32_16x16x32_bf16 v[84:87], v[172:175], a[84:87], v[84:87]
    v_mul_f32 v14, v14, v202
    v_mul_f32 v15, v15, v203
    v_cvt_pk_bf16_f32 v132, v2, v6
    v_mfma_f32_16x16x32_bf16 v[84:87], v[244:247], a[88:91], v[84:87]
    ds_read_b64_tr_b16 a[116:117], v187 offset:16384
    ds_read_b64_tr_b16 a[118:119], v187 offset:24576
    v_cvt_pk_bf16_f32 v133, v10, v14
    v_mfma_f32_16x16x32_bf16 v[84:87], v[252:255], a[92:95], v[84:87]
    ds_write_b64 v227, v[132:133] offset:128
    v_cvt_pk_bf16_f32 v134, v3, v7
    v_cvt_pk_bf16_f32 v135, v11, v15
    s_waitcnt lgkmcnt(5)
    v_mfma_f32_16x16x32_bf16 v[24:27], v[160:163], a[96:99], v[24:27]
    ds_read_b64_tr_b16 a[120:121], v187 offset:32768
    ds_read_b64_tr_b16 a[122:123], v187 offset:40960
    ds_write_b64 v228, v[134:135] offset:128
    v_mfma_f32_16x16x32_bf16 v[24:27], v[168:171], a[100:103], v[24:27]
    ds_read_b64_tr_b16 v[144:145], v229
    ds_read_b64_tr_b16 v[146:147], v230 offset:256
    ds_read_b64_tr_b16 v[148:149], v229 offset:1024
    v_mfma_f32_16x16x32_bf16 v[24:27], v[240:243], a[104:107], v[24:27]
    ds_read_b64_tr_b16 a[124:125], v187 offset:49152
    ds_read_b64_tr_b16 a[126:127], v187 offset:57344
    ds_read_b64_tr_b16 v[150:151], v230 offset:1280
    v_mfma_f32_16x16x32_bf16 v[24:27], v[248:251], a[108:111], v[24:27]
    v_mul_f32 v64, v64, v204
    v_mul_f32 v65, v65, v205
    v_mul_f32 v68, v68, v204
    v_mfma_f32_16x16x32_bf16 v[88:91], v[164:167], a[96:99], v[88:91]
    ds_read_b64_tr_b16 a[64:65], v180 offset:256
    s_waitcnt lgkmcnt(10)
    ds_read_b64_tr_b16 a[66:67], v180 offset:8448
    v_mul_f32 v69, v69, v205
    v_mfma_f32_16x16x32_bf16 v[88:91], v[172:175], a[100:103], v[88:91]
    v_mul_f32 v72, v72, v204
    v_mul_f32 v73, v73, v205
    v_mul_f32 v76, v76, v204
    v_mfma_f32_16x16x32_bf16 v[88:91], v[244:247], a[104:107], v[88:91]
    ds_read_b64_tr_b16 a[68:69], v180 offset:16640
    ds_read_b64_tr_b16 a[70:71], v180 offset:24832
    v_mul_f32 v77, v77, v205
    v_mfma_f32_16x16x32_bf16 v[88:91], v[252:255], a[108:111], v[88:91]
    v_cvt_pk_bf16_f32 v136, v64, v68
    v_cvt_pk_bf16_f32 v137, v72, v76
    v_mfma_f32_16x16x32_bf16 v[28:31], v[160:163], a[112:115], v[28:31]
    ds_read_b64_tr_b16 a[72:73], v180 offset:33024
    ds_read_b64_tr_b16 a[74:75], v180 offset:41216
    v_mfma_f32_16x16x32_bf16 v[28:31], v[168:171], a[116:119], v[28:31]
    s_waitcnt lgkmcnt(6)
    buffer_store_dwordx4 v[144:147], v231, s[36:39], s84 offen nt
    v_mfma_f32_16x16x32_bf16 v[28:31], v[240:243], a[120:123], v[28:31]
    ds_read_b64_tr_b16 a[76:77], v180 offset:49408
    ds_read_b64_tr_b16 a[78:79], v180 offset:57600
    v_mfma_f32_16x16x32_bf16 v[28:31], v[248:251], a[124:127], v[28:31]
    buffer_store_dwordx4 v[148:151], v231, s[36:39], s85 offen nt
    ds_write_b64 v227, v[136:137] offset:2048
    v_mfma_f32_16x16x32_bf16 v[92:95], v[164:167], a[112:115], v[92:95]
    ds_read_b64_tr_b16 a[80:81], v181 offset:256
    ds_read_b64_tr_b16 a[82:83], v181 offset:8448
    v_cvt_pk_bf16_f32 v138, v65, v69
    v_mfma_f32_16x16x32_bf16 v[92:95], v[172:175], a[116:119], v[92:95]
    v_cvt_pk_bf16_f32 v139, v73, v77
    ds_write_b64 v228, v[138:139] offset:2048
    v_mul_f32 v66, v66, v206
    v_mfma_f32_16x16x32_bf16 v[92:95], v[244:247], a[120:123], v[92:95]
    ds_read_b64_tr_b16 a[84:85], v181 offset:16640
    ds_read_b64_tr_b16 a[86:87], v181 offset:24832
    v_mul_f32 v67, v67, v207
    v_mfma_f32_16x16x32_bf16 v[92:95], v[252:255], a[124:127], v[92:95]
    v_mul_f32 v70, v70, v206
    v_mul_f32 v71, v71, v207
    v_mul_f32 v74, v74, v206
    v_mul_f32 v75, v75, v207
    v_mul_f32 v78, v78, v206
    v_mul_f32 v79, v79, v207
    v_cvt_pk_bf16_f32 v140, v66, v70
    v_cvt_pk_bf16_f32 v141, v74, v78
    ds_write_b64 v227, v[140:141] offset:2176
    v_cvt_pk_bf16_f32 v142, v67, v71
    v_cvt_pk_bf16_f32 v143, v75, v79
    s_waitcnt lgkmcnt(4)
    ds_write_b64 v228, v[142:143] offset:2176
    ds_read_b64_tr_b16 v[152:153], v229 offset:2048
    ds_read_b64_tr_b16 v[154:155], v230 offset:2304
    ds_read_b64_tr_b16 v[156:157], v229 offset:3072
    ds_read_b64_tr_b16 v[158:159], v230 offset:3328
    v_mfma_f32_16x16x32_bf16 v[32:35], v[160:163], a[64:67], v[32:35]
    ds_read_b64_tr_b16 a[88:89], v181 offset:33024
    ds_read_b64_tr_b16 a[90:91], v181 offset:41216
    v_mfma_f32_16x16x32_bf16 v[32:35], v[168:171], a[68:71], v[32:35]
    v_mfma_f32_16x16x32_bf16 v[32:35], v[240:243], a[72:75], v[32:35]
    ds_read_b64_tr_b16 a[92:93], v181 offset:49408
    ds_read_b64_tr_b16 a[94:95], v181 offset:57600
    v_mfma_f32_16x16x32_bf16 v[32:35], v[248:251], a[76:79], v[32:35]
    s_waitcnt lgkmcnt(6)
    buffer_store_dwordx4 v[152:155], v231, s[36:39], s86 offen nt
    v_mfma_f32_16x16x32_bf16 v[96:99], v[164:167], a[64:67], v[96:99]
    ds_read_b64_tr_b16 a[96:97], v182 offset:256
    ds_read_b64_tr_b16 a[98:99], v182 offset:8448
    v_mfma_f32_16x16x32_bf16 v[96:99], v[172:175], a[68:71], v[96:99]
    s_waitcnt lgkmcnt(6)
    buffer_store_dwordx4 v[156:159], v231, s[36:39], s87 offen nt
    v_mul_f32 v16, v16, v200
    v_mfma_f32_16x16x32_bf16 v[96:99], v[244:247], a[72:75], v[96:99]
    ds_read_b64_tr_b16 a[100:101], v182 offset:16640
    ds_read_b64_tr_b16 a[102:103], v182 offset:24832
    v_mul_f32 v17, v17, v201
    v_mfma_f32_16x16x32_bf16 v[96:99], v[252:255], a[76:79], v[96:99]
    v_mul_f32 v20, v20, v200
    v_mul_f32 v21, v21, v201
    v_mul_f32 v24, v24, v200
    v_mfma_f32_16x16x32_bf16 v[36:39], v[160:163], a[80:83], v[36:39]
    ds_read_b64_tr_b16 a[104:105], v182 offset:33024
    ds_read_b64_tr_b16 a[106:107], v182 offset:41216
    v_mul_f32 v25, v25, v201
    v_mfma_f32_16x16x32_bf16 v[36:39], v[168:171], a[84:87], v[36:39]
    v_mul_f32 v28, v28, v200
    v_mul_f32 v29, v29, v201
    v_cvt_pk_bf16_f32 v128, v16, v20
    s_waitcnt lgkmcnt(4)
    v_mfma_f32_16x16x32_bf16 v[36:39], v[240:243], a[88:91], v[36:39]
    ds_read_b64_tr_b16 a[108:109], v182 offset:49408
    ds_read_b64_tr_b16 a[110:111], v182 offset:57600
    v_cvt_pk_bf16_f32 v129, v24, v28
    v_mfma_f32_16x16x32_bf16 v[36:39], v[248:251], a[92:95], v[36:39]
    ds_write_b64 v227, v[128:129] offset:4096
    v_cvt_pk_bf16_f32 v130, v17, v21
    v_cvt_pk_bf16_f32 v131, v25, v29
    v_mfma_f32_16x16x32_bf16 v[100:103], v[164:167], a[80:83], v[100:103]
    ds_read_b64_tr_b16 a[112:113], v183 offset:256
    ds_read_b64_tr_b16 a[114:115], v183 offset:8448
    ds_write_b64 v228, v[130:131] offset:4096
    v_mfma_f32_16x16x32_bf16 v[100:103], v[172:175], a[84:87], v[100:103]
    v_mul_f32 v18, v18, v202
    v_mul_f32 v19, v19, v203
    v_mul_f32 v22, v22, v202
    v_mfma_f32_16x16x32_bf16 v[100:103], v[244:247], a[88:91], v[100:103]
    ds_read_b64_tr_b16 a[116:117], v183 offset:16640
    ds_read_b64_tr_b16 a[118:119], v183 offset:24832
    v_mul_f32 v23, v23, v203
    v_mfma_f32_16x16x32_bf16 v[100:103], v[252:255], a[92:95], v[100:103]
    v_mul_f32 v26, v26, v202
    v_mul_f32 v27, v27, v203
    v_mul_f32 v30, v30, v202
    v_mfma_f32_16x16x32_bf16 v[40:43], v[160:163], a[96:99], v[40:43]
    ds_read_b64_tr_b16 a[120:121], v183 offset:33024
    ds_read_b64_tr_b16 a[122:123], v183 offset:41216
    v_mul_f32 v31, v31, v203
    s_waitcnt lgkmcnt(7)
    v_mfma_f32_16x16x32_bf16 v[40:43], v[168:171], a[100:103], v[40:43]
    v_cvt_pk_bf16_f32 v132, v18, v22
    v_cvt_pk_bf16_f32 v133, v26, v30
    ds_write_b64 v227, v[132:133] offset:4224
    v_mfma_f32_16x16x32_bf16 v[40:43], v[240:243], a[104:107], v[40:43]
    ds_read_b64_tr_b16 a[124:125], v183 offset:49408
    ds_read_b64_tr_b16 a[126:127], v183 offset:57600
    v_cvt_pk_bf16_f32 v134, v19, v23
    v_mfma_f32_16x16x32_bf16 v[40:43], v[248:251], a[108:111], v[40:43]
    v_cvt_pk_bf16_f32 v135, v27, v31
    ds_write_b64 v228, v[134:135] offset:4224
    ds_read_b64_tr_b16 v[144:145], v229 offset:4096
    v_mfma_f32_16x16x32_bf16 v[104:107], v[164:167], a[96:99], v[104:107]
    ds_read_b64_tr_b16 a[64:65], v184 offset:256
    ds_read_b64_tr_b16 a[66:67], v184 offset:8448
    ds_read_b64_tr_b16 v[146:147], v230 offset:4352
    v_mfma_f32_16x16x32_bf16 v[104:107], v[172:175], a[100:103], v[104:107]
    s_waitcnt lgkmcnt(9)
    ds_read_b64_tr_b16 v[148:149], v229 offset:5120
    ds_read_b64_tr_b16 v[150:151], v230 offset:5376
    v_mul_f32 v80, v80, v204
    v_mfma_f32_16x16x32_bf16 v[104:107], v[244:247], a[104:107], v[104:107]
    ds_read_b64_tr_b16 a[68:69], v184 offset:16640
    ds_read_b64_tr_b16 a[70:71], v184 offset:24832
    v_mul_f32 v81, v81, v205
    v_mfma_f32_16x16x32_bf16 v[104:107], v[252:255], a[108:111], v[104:107]
    v_mul_f32 v84, v84, v204
    v_mul_f32 v85, v85, v205
    v_mul_f32 v88, v88, v204
    v_mfma_f32_16x16x32_bf16 v[44:47], v[160:163], a[112:115], v[44:47]
    ds_read_b64_tr_b16 a[72:73], v184 offset:33024
    ds_read_b64_tr_b16 a[74:75], v184 offset:41216
    v_mul_f32 v89, v89, v205
    v_mfma_f32_16x16x32_bf16 v[44:47], v[168:171], a[116:119], v[44:47]
    v_mul_f32 v92, v92, v204
    v_mul_f32 v93, v93, v205
    v_cvt_pk_bf16_f32 v136, v80, v84
    s_waitcnt lgkmcnt(6)
    v_mfma_f32_16x16x32_bf16 v[44:47], v[240:243], a[120:123], v[44:47]
    ds_read_b64_tr_b16 a[76:77], v184 offset:49408
    ds_read_b64_tr_b16 a[78:79], v184 offset:57600
    v_cvt_pk_bf16_f32 v137, v88, v92
    v_mfma_f32_16x16x32_bf16 v[44:47], v[248:251], a[124:127], v[44:47]
    buffer_store_dwordx4 v[144:147], v231, s[36:39], s84 offen offset:128 nt
    v_mfma_f32_16x16x32_bf16 v[108:111], v[164:167], a[112:115], v[108:111]
    ds_read_b64_tr_b16 a[80:81], v185 offset:256
    ds_read_b64_tr_b16 a[82:83], v185 offset:8448
    v_mfma_f32_16x16x32_bf16 v[108:111], v[172:175], a[116:119], v[108:111]
    s_waitcnt lgkmcnt(6)
    buffer_store_dwordx4 v[148:151], v231, s[36:39], s85 offen offset:128 nt
    ds_write_b64 v227, v[136:137] offset:6144
    v_mfma_f32_16x16x32_bf16 v[108:111], v[244:247], a[120:123], v[108:111]
    ds_read_b64_tr_b16 a[84:85], v185 offset:16640
    ds_read_b64_tr_b16 a[86:87], v185 offset:24832
    v_cvt_pk_bf16_f32 v138, v81, v85
    v_mfma_f32_16x16x32_bf16 v[108:111], v[252:255], a[124:127], v[108:111]
    v_cvt_pk_bf16_f32 v139, v89, v93
    ds_write_b64 v228, v[138:139] offset:6144
    v_mul_f32 v82, v82, v206
    v_mul_f32 v83, v83, v207
    v_mul_f32 v86, v86, v206
    v_mul_f32 v87, v87, v207
    v_mul_f32 v90, v90, v206
    v_mul_f32 v91, v91, v207
    v_mul_f32 v94, v94, v206
    v_mul_f32 v95, v95, v207
    v_cvt_pk_bf16_f32 v140, v82, v86
    v_cvt_pk_bf16_f32 v141, v90, v94
    ds_write_b64 v227, v[140:141] offset:6272
    v_cvt_pk_bf16_f32 v142, v83, v87
    v_cvt_pk_bf16_f32 v143, v91, v95
    ds_write_b64 v228, v[142:143] offset:6272
    ds_read_b64_tr_b16 v[152:153], v229 offset:6144
    ds_read_b64_tr_b16 v[154:155], v230 offset:6400
    ds_read_b64_tr_b16 v[156:157], v229 offset:7168
    s_waitcnt lgkmcnt(6)
    ds_read_b64_tr_b16 v[158:159], v230 offset:7424
    v_mfma_f32_16x16x32_bf16 v[48:51], v[160:163], a[64:67], v[48:51]
    ds_read_b64_tr_b16 a[88:89], v185 offset:33024
    ds_read_b64_tr_b16 a[90:91], v185 offset:41216
    v_mfma_f32_16x16x32_bf16 v[48:51], v[168:171], a[68:71], v[48:51]
    v_mfma_f32_16x16x32_bf16 v[48:51], v[240:243], a[72:75], v[48:51]
    ds_read_b64_tr_b16 a[92:93], v185 offset:49408
    ds_read_b64_tr_b16 a[94:95], v185 offset:57600
    v_mfma_f32_16x16x32_bf16 v[48:51], v[248:251], a[76:79], v[48:51]
    s_waitcnt lgkmcnt(6)
    buffer_store_dwordx4 v[152:155], v231, s[36:39], s86 offen offset:128 nt
    v_mfma_f32_16x16x32_bf16 v[112:115], v[164:167], a[64:67], v[112:115]
    ds_read_b64_tr_b16 a[96:97], v186 offset:256
    ds_read_b64_tr_b16 a[98:99], v186 offset:8448
    v_mfma_f32_16x16x32_bf16 v[112:115], v[172:175], a[68:71], v[112:115]
    s_waitcnt lgkmcnt(6)
    buffer_store_dwordx4 v[156:159], v231, s[36:39], s87 offen offset:128 nt
    v_mul_f32 v32, v32, v200
    v_mfma_f32_16x16x32_bf16 v[112:115], v[244:247], a[72:75], v[112:115]
    ds_read_b64_tr_b16 a[100:101], v186 offset:16640
    ds_read_b64_tr_b16 a[102:103], v186 offset:24832
    v_mul_f32 v33, v33, v201
    v_mfma_f32_16x16x32_bf16 v[112:115], v[252:255], a[76:79], v[112:115]
    v_mul_f32 v36, v36, v200
    v_mul_f32 v37, v37, v201
    v_mul_f32 v40, v40, v200
    v_mfma_f32_16x16x32_bf16 v[52:55], v[160:163], a[80:83], v[52:55]
    ds_read_b64_tr_b16 a[104:105], v186 offset:33024
    ds_read_b64_tr_b16 a[106:107], v186 offset:41216
    v_mul_f32 v41, v41, v201
    v_mfma_f32_16x16x32_bf16 v[52:55], v[168:171], a[84:87], v[52:55]
    v_mul_f32 v44, v44, v200
    v_mul_f32 v45, v45, v201
    v_cvt_pk_bf16_f32 v128, v32, v36
    s_waitcnt lgkmcnt(4)
    v_mfma_f32_16x16x32_bf16 v[52:55], v[240:243], a[88:91], v[52:55]
    ds_read_b64_tr_b16 a[108:109], v186 offset:49408
    ds_read_b64_tr_b16 a[110:111], v186 offset:57600
    v_cvt_pk_bf16_f32 v129, v40, v44
    v_mfma_f32_16x16x32_bf16 v[52:55], v[248:251], a[92:95], v[52:55]
    ds_write_b64 v227, v[128:129]
    v_cvt_pk_bf16_f32 v130, v33, v37
    v_cvt_pk_bf16_f32 v131, v41, v45
    v_mfma_f32_16x16x32_bf16 v[116:119], v[164:167], a[80:83], v[116:119]
    ds_read_b64_tr_b16 a[112:113], v187 offset:256
    ds_read_b64_tr_b16 a[114:115], v187 offset:8448
    ds_write_b64 v228, v[130:131]
    v_mfma_f32_16x16x32_bf16 v[116:119], v[172:175], a[84:87], v[116:119]
    v_mul_f32 v34, v34, v202
    v_mul_f32 v35, v35, v203
    v_mul_f32 v38, v38, v202
    v_mfma_f32_16x16x32_bf16 v[116:119], v[244:247], a[88:91], v[116:119]
    ds_read_b64_tr_b16 a[116:117], v187 offset:16640
    ds_read_b64_tr_b16 a[118:119], v187 offset:24832
    v_mul_f32 v39, v39, v203
    v_mfma_f32_16x16x32_bf16 v[116:119], v[252:255], a[92:95], v[116:119]
    v_mul_f32 v42, v42, v202
    v_mul_f32 v43, v43, v203
    v_mul_f32 v46, v46, v202
    v_mfma_f32_16x16x32_bf16 v[56:59], v[160:163], a[96:99], v[56:59]
    ds_read_b64_tr_b16 a[120:121], v187 offset:33024
    ds_read_b64_tr_b16 a[122:123], v187 offset:41216
    v_mul_f32 v47, v47, v203
    s_waitcnt lgkmcnt(7)
    v_mfma_f32_16x16x32_bf16 v[56:59], v[168:171], a[100:103], v[56:59]
    v_cvt_pk_bf16_f32 v132, v34, v38
    v_cvt_pk_bf16_f32 v133, v42, v46
    ds_write_b64 v227, v[132:133] offset:128
    v_mfma_f32_16x16x32_bf16 v[56:59], v[240:243], a[104:107], v[56:59]
    ds_read_b64_tr_b16 a[124:125], v187 offset:49408
    ds_read_b64_tr_b16 a[126:127], v187 offset:57600
    v_cvt_pk_bf16_f32 v134, v35, v39
    v_mfma_f32_16x16x32_bf16 v[56:59], v[248:251], a[108:111], v[56:59]
    v_cvt_pk_bf16_f32 v135, v43, v47
    ds_write_b64 v228, v[134:135] offset:128
    ds_read_b64_tr_b16 v[144:145], v229
    v_mfma_f32_16x16x32_bf16 v[120:123], v[164:167], a[96:99], v[120:123]
    ds_read_b64_tr_b16 v[146:147], v230 offset:256
    ds_read_b64_tr_b16 v[148:149], v229 offset:1024
    ds_read_b64_tr_b16 v[150:151], v230 offset:1280
    v_mfma_f32_16x16x32_bf16 v[120:123], v[172:175], a[100:103], v[120:123]
    v_mul_f32 v96, v96, v204
    v_mul_f32 v97, v97, v205
    v_mul_f32 v100, v100, v204
    v_mfma_f32_16x16x32_bf16 v[120:123], v[244:247], a[104:107], v[120:123]
    v_mul_f32 v101, v101, v205
    v_mul_f32 v104, v104, v204
    v_mul_f32 v105, v105, v205
    v_mfma_f32_16x16x32_bf16 v[120:123], v[252:255], a[108:111], v[120:123]
    v_mul_f32 v108, v108, v204
    v_mul_f32 v109, v109, v205
    v_cvt_pk_bf16_f32 v136, v96, v100
    s_waitcnt lgkmcnt(5)
    v_mfma_f32_16x16x32_bf16 v[60:63], v[160:163], a[112:115], v[60:63]
    v_cvt_pk_bf16_f32 v137, v104, v108
    s_waitcnt lgkmcnt(2)
    buffer_store_dwordx4 v[144:147], v231, s[36:39], s84 offen offset:256 nt
    v_mfma_f32_16x16x32_bf16 v[60:63], v[168:171], a[116:119], v[60:63]
    s_waitcnt lgkmcnt(0)
    buffer_store_dwordx4 v[148:151], v231, s[36:39], s85 offen offset:256 nt
    ds_write_b64 v227, v[136:137] offset:2048
    v_mfma_f32_16x16x32_bf16 v[60:63], v[240:243], a[120:123], v[60:63]
    v_cvt_pk_bf16_f32 v138, v97, v101
    v_cvt_pk_bf16_f32 v139, v105, v109
    ds_write_b64 v228, v[138:139] offset:2048
    v_mfma_f32_16x16x32_bf16 v[60:63], v[248:251], a[124:127], v[60:63]
    v_mul_f32 v98, v98, v206
    v_mul_f32 v99, v99, v207
    v_mul_f32 v102, v102, v206
    v_mfma_f32_16x16x32_bf16 v[124:127], v[164:167], a[112:115], v[124:127]
    v_mul_f32 v103, v103, v207
    v_mul_f32 v106, v106, v206
    v_mul_f32 v107, v107, v207
    v_mfma_f32_16x16x32_bf16 v[124:127], v[172:175], a[116:119], v[124:127]
    v_mul_f32 v110, v110, v206
    v_mul_f32 v111, v111, v207
    v_cvt_pk_bf16_f32 v140, v98, v102
    v_mfma_f32_16x16x32_bf16 v[124:127], v[244:247], a[120:123], v[124:127]
    v_cvt_pk_bf16_f32 v141, v106, v110
    ds_write_b64 v227, v[140:141] offset:2176
    v_cvt_pk_bf16_f32 v142, v99, v103
    v_mfma_f32_16x16x32_bf16 v[124:127], v[252:255], a[124:127], v[124:127]
    v_cvt_pk_bf16_f32 v143, v107, v111
    ds_write_b64 v228, v[142:143] offset:2176
    ds_read_b64_tr_b16 v[152:153], v229 offset:2048
    ds_read_b64_tr_b16 v[154:155], v230 offset:2304
    ds_read_b64_tr_b16 v[156:157], v229 offset:3072
    ds_read_b64_tr_b16 v[158:159], v230 offset:3328
    s_waitcnt lgkmcnt(2)
    buffer_store_dwordx4 v[152:155], v231, s[36:39], s86 offen offset:256 nt
    s_waitcnt lgkmcnt(0)
    buffer_store_dwordx4 v[156:159], v231, s[36:39], s87 offen offset:256 nt
    s_nop 7
    v_pk_mul_f32 v[48:49], v[48:49], v[200:201]
    v_pk_mul_f32 v[52:53], v[52:53], v[200:201]
    v_pk_mul_f32 v[56:57], v[56:57], v[200:201]
    v_pk_mul_f32 v[60:61], v[60:61], v[200:201]
    v_cvt_pk_bf16_f32 v128, v48, v52
    v_cvt_pk_bf16_f32 v129, v56, v60
    ds_write_b64 v227, v[128:129] offset:4096
    v_cvt_pk_bf16_f32 v130, v49, v53
    v_cvt_pk_bf16_f32 v131, v57, v61
    ds_write_b64 v228, v[130:131] offset:4096
    v_pk_mul_f32 v[50:51], v[50:51], v[202:203]
    v_pk_mul_f32 v[54:55], v[54:55], v[202:203]
    v_pk_mul_f32 v[58:59], v[58:59], v[202:203]
    v_pk_mul_f32 v[62:63], v[62:63], v[202:203]
    v_cvt_pk_bf16_f32 v132, v50, v54
    v_cvt_pk_bf16_f32 v133, v58, v62
    ds_write_b64 v227, v[132:133] offset:4224
    v_cvt_pk_bf16_f32 v134, v51, v55
    v_cvt_pk_bf16_f32 v135, v59, v63
    ds_write_b64 v228, v[134:135] offset:4224
    ds_read_b64_tr_b16 v[144:145], v229 offset:4096
    ds_read_b64_tr_b16 v[146:147], v230 offset:4352
    ds_read_b64_tr_b16 v[148:149], v229 offset:5120
    ds_read_b64_tr_b16 v[150:151], v230 offset:5376
    v_pk_mul_f32 v[112:113], v[112:113], v[204:205]
    v_pk_mul_f32 v[116:117], v[116:117], v[204:205]
    v_pk_mul_f32 v[120:121], v[120:121], v[204:205]
    v_pk_mul_f32 v[124:125], v[124:125], v[204:205]
    v_cvt_pk_bf16_f32 v136, v112, v116
    v_cvt_pk_bf16_f32 v137, v120, v124
    ds_write_b64 v227, v[136:137] offset:6144
    v_cvt_pk_bf16_f32 v138, v113, v117
    v_cvt_pk_bf16_f32 v139, v121, v125
    ds_write_b64 v228, v[138:139] offset:6144
    s_waitcnt lgkmcnt(4)
    buffer_store_dwordx4 v[144:147], v231, s[36:39], s84 offen offset:384 nt
    s_waitcnt lgkmcnt(2)
    buffer_store_dwordx4 v[148:151], v231, s[36:39], s85 offen offset:384 nt
    v_pk_mul_f32 v[114:115], v[114:115], v[206:207]
    v_pk_mul_f32 v[118:119], v[118:119], v[206:207]
    v_pk_mul_f32 v[122:123], v[122:123], v[206:207]
    v_pk_mul_f32 v[126:127], v[126:127], v[206:207]
    v_cvt_pk_bf16_f32 v140, v114, v118
    v_cvt_pk_bf16_f32 v141, v122, v126
    ds_write_b64 v227, v[140:141] offset:6272
    v_cvt_pk_bf16_f32 v142, v115, v119
    v_cvt_pk_bf16_f32 v143, v123, v127
    ds_write_b64 v228, v[142:143] offset:6272
    ds_read_b64_tr_b16 v[152:153], v229 offset:6144
    ds_read_b64_tr_b16 v[154:155], v230 offset:6400
    ds_read_b64_tr_b16 v[156:157], v229 offset:7168
    ds_read_b64_tr_b16 v[158:159], v230 offset:7424
    s_waitcnt lgkmcnt(2)
    buffer_store_dwordx4 v[152:155], v231, s[36:39], s86 offen offset:384 nt
    s_waitcnt lgkmcnt(0)
    buffer_store_dwordx4 v[156:159], v231, s[36:39], s87 offen offset:384 nt
    s_endpgm
    .p2align 6
L_fin1:
    v_readlane_b32 s51, v196, s46
    s_waitcnt vmcnt(8) lgkmcnt(0)
    s_barrier
    ds_read_b128 a[64:67], v176 offset:49152
    ds_read_b128 a[68:71], v177 offset:49152
    ds_read_b128 a[72:75], v178 offset:49152
    ds_read_b128 a[76:79], v179 offset:49152
    ds_read_b128 a[80:83], v176 offset:49408
    ds_read_b128 a[84:87], v177 offset:49408
    ds_read_b128 a[88:91], v178 offset:49408
    ds_read_b128 a[92:95], v179 offset:49408
    v_exp_f32 v208, v128
    v_exp_f32 v209, v129
    v_exp_f32 v210, v130
    v_cvt_pk_bf16_f32 v160, v208, v209
    s_waitcnt lgkmcnt(7)
    v_mfma_f32_16x16x32_bf16 v[144:147], a[64:67], a[0:3], v[232:235]
    ds_read_b128 a[96:99], v176 offset:57344
    ds_read_b128 a[100:103], v177 offset:57344
    s_waitcnt lgkmcnt(8)
    v_mfma_f32_16x16x32_bf16 v[144:147], a[68:71], a[4:7], v[144:147]
    ds_read_b128 a[104:107], v178 offset:57344
    ds_read_b128 a[108:111], v179 offset:57344
    s_waitcnt lgkmcnt(9)
    v_mfma_f32_16x16x32_bf16 v[144:147], a[72:75], a[8:11], v[144:147]
    ds_read_b128 a[112:115], v176 offset:57600
    ds_read_b128 a[116:119], v177 offset:57600
    s_waitcnt lgkmcnt(10)
    v_mfma_f32_16x16x32_bf16 v[144:147], a[76:79], a[12:15], v[144:147]
    ds_read_b128 a[120:123], v178 offset:57600
    ds_read_b128 a[124:127], v179 offset:57600
    s_waitcnt lgkmcnt(8)
    v_mfma_f32_16x16x32_bf16 v[144:147], a[80:83], a[16:19], v[144:147]
    s_mov_b32 m0, s64
    s_nop 0
    v_mfma_f32_16x16x32_bf16 v[144:147], a[84:87], a[20:23], v[144:147]
    buffer_load_dwordx4 v192, s[28:31], s51 offen lds
    v_mfma_f32_16x16x32_bf16 v[144:147], a[88:91], a[24:27], v[144:147]
    v_exp_f32 v211, v131
    v_mfma_f32_16x16x32_bf16 v[144:147], a[92:95], a[28:31], v[144:147]
    v_exp_f32 v212, v136
    v_cvt_pk_bf16_f32 v161, v210, v211
    v_mfma_f32_16x16x32_bf16 v[148:151], a[64:67], a[32:35], v[236:239]
    v_exp_f32 v213, v137
    v_mfma_f32_16x16x32_bf16 v[148:151], a[68:71], a[36:39], v[148:151]
    buffer_load_dwordx4 v193, s[28:31], s51 offen offset:1024 lds
    v_mfma_f32_16x16x32_bf16 v[148:151], a[72:75], a[40:43], v[148:151]
    v_exp_f32 v214, v138
    v_cvt_pk_bf16_f32 v162, v212, v213
    v_mfma_f32_16x16x32_bf16 v[148:151], a[76:79], a[44:47], v[148:151]
    v_exp_f32 v215, v139
    v_mfma_f32_16x16x32_bf16 v[148:151], a[80:83], a[48:51], v[148:151]
    v_exp_f32 v208, v132
    v_cvt_pk_bf16_f32 v163, v214, v215
    v_mfma_f32_16x16x32_bf16 v[148:151], a[84:87], a[52:55], v[148:151]
    buffer_load_dwordx4 v194, s[28:31], s51 offen offset:2048 lds
    v_or3_b32 v197, v160, v161, v162
    v_mfma_f32_16x16x32_bf16 v[148:151], a[88:91], a[56:59], v[148:151]
    v_exp_f32 v209, v133
    v_mfma_f32_16x16x32_bf16 v[148:151], a[92:95], a[60:63], v[148:151]
    v_exp_f32 v210, v134
    v_cvt_pk_bf16_f32 v164, v208, v209
    s_waitcnt lgkmcnt(0)
    v_mfma_f32_16x16x32_bf16 v[152:155], a[96:99], a[0:3], v[232:235]
    v_exp_f32 v211, v135
    v_mfma_f32_16x16x32_bf16 v[152:155], a[100:103], a[4:7], v[152:155]
    ds_read_b128 a[64:67], v176
    ds_read_b128 a[68:71], v177
    buffer_load_dwordx4 v195, s[28:31], s51 offen offset:3072 lds
    v_mfma_f32_16x16x32_bf16 v[152:155], a[104:107], a[8:11], v[152:155]
    ds_read_b128 a[72:75], v178
    ds_read_b128 a[76:79], v179
    v_mfma_f32_16x16x32_bf16 v[152:155], a[108:111], a[12:15], v[152:155]
    ds_read_b128 a[80:83], v176 offset:256
    ds_read_b128 a[84:87], v177 offset:256
    v_mfma_f32_16x16x32_bf16 v[152:155], a[112:115], a[16:19], v[152:155]
    ds_read_b128 a[88:91], v178 offset:256
    ds_read_b128 a[92:95], v179 offset:256
    v_mfma_f32_16x16x32_bf16 v[152:155], a[116:119], a[20:23], v[152:155]
    v_exp_f32 v212, v140
    v_cvt_pk_bf16_f32 v165, v210, v211
    v_mfma_f32_16x16x32_bf16 v[152:155], a[120:123], a[24:27], v[152:155]
    v_or3_b32 v197, v197, v163, v164
    v_exp_f32 v213, v141
    v_mfma_f32_16x16x32_bf16 v[152:155], a[124:127], a[28:31], v[152:155]
    v_exp_f32 v214, v142
    v_cvt_pk_bf16_f32 v166, v212, v213
    v_mfma_f32_16x16x32_bf16 v[156:159], a[96:99], a[32:35], v[236:239]
    v_exp_f32 v215, v143
    v_or3_b32 v197, v197, v165, v166
    v_mfma_f32_16x16x32_bf16 v[156:159], a[100:103], a[36:39], v[156:159]
    v_cvt_pk_bf16_f32 v167, v214, v215
    v_or_b32 v197, v197, v167
    v_and_b32 v197, s48, v197
    v_mfma_f32_16x16x32_bf16 v[156:159], a[104:107], a[40:43], v[156:159]
    v_cmp_ne_u32 vcc, 0, v197
    v_mfma_f32_16x16x32_bf16 v[156:159], a[108:111], a[44:47], v[156:159]
    v_mfma_f32_16x16x32_bf16 v[156:159], a[112:115], a[48:51], v[156:159]
    v_mfma_f32_16x16x32_bf16 v[156:159], a[116:119], a[52:55], v[156:159]
    v_mfma_f32_16x16x32_bf16 v[156:159], a[120:123], a[56:59], v[156:159]
    v_mfma_f32_16x16x32_bf16 v[156:159], a[124:127], a[60:63], v[156:159]
    s_add_u32 s54, s46, -1
    s_cmp_lt_u32 s54, s45
    s_cbranch_scc1 L_fok1_1
    v_mov_b32 v160, 0
    v_mov_b32 v161, 0
    v_mov_b32 v162, 0
    v_mov_b32 v163, 0
    v_mov_b32 v164, 0
    v_mov_b32 v165, 0
    v_mov_b32 v166, 0
    v_mov_b32 v167, 0
    s_branch L_fback1_1
L_fok1_1:
    s_cbranch_vccnz L_frare1_1
L_fback1_1:
    s_waitcnt lgkmcnt(0)
    v_mfma_f32_16x16x32_bf16 v[128:131], a[64:67], a[0:3], v[232:235]
    ds_read_b128 a[96:99], v176 offset:8192
    ds_read_b128 a[100:103], v177 offset:8192
    s_lshl_b32 s56, s49, 13
    v_mfma_f32_16x16x32_bf16 v[128:131], a[68:71], a[4:7], v[128:131]
    ds_read_b128 a[104:107], v178 offset:8192
    ds_read_b128 a[108:111], v179 offset:8192
    s_add_u32 s56, s56, 131072
    v_mfma_f32_16x16x32_bf16 v[128:131], a[72:75], a[8:11], v[128:131]
    ds_read_b128 a[112:115], v176 offset:8448
    ds_read_b128 a[116:119], v177 offset:8448
    v_and_b32 v227, 3, v216
    v_mfma_f32_16x16x32_bf16 v[128:131], a[76:79], a[12:15], v[128:131]
    ds_read_b128 a[120:123], v178 offset:8448
    ds_read_b128 a[124:127], v179 offset:8448
    v_bfe_u32 v198, v216, 3, 1
    v_mfma_f32_16x16x32_bf16 v[128:131], a[80:83], a[16:19], v[128:131]
    v_exp_f32 v208, v144
    v_lshl_add_u32 v227, v198, 2, v227
    v_mfma_f32_16x16x32_bf16 v[128:131], a[84:87], a[20:23], v[128:131]
    v_exp_f32 v209, v145
    v_lshrrev_b32 v198, 4, v216
    v_mfma_f32_16x16x32_bf16 v[128:131], a[88:91], a[24:27], v[128:131]
    v_exp_f32 v210, v146
    v_cvt_pk_bf16_f32 v240, v208, v209
    v_mfma_f32_16x16x32_bf16 v[128:131], a[92:95], a[28:31], v[128:131]
    v_exp_f32 v211, v147
    v_lshl_add_u32 v227, v198, 6, v227
    v_mfma_f32_16x16x32_bf16 v[132:135], a[64:67], a[32:35], v[236:239]
    v_exp_f32 v212, v152
    v_cvt_pk_bf16_f32 v241, v210, v211
    v_mfma_f32_16x16x32_bf16 v[132:135], a[68:71], a[36:39], v[132:135]
    v_exp_f32 v213, v153
    v_bfe_u32 v198, v216, 2, 1
    v_mfma_f32_16x16x32_bf16 v[132:135], a[72:75], a[40:43], v[132:135]
    v_exp_f32 v214, v154
    v_cvt_pk_bf16_f32 v242, v212, v213
    v_mfma_f32_16x16x32_bf16 v[132:135], a[76:79], a[44:47], v[132:135]
    v_exp_f32 v215, v155
    v_lshl_add_u32 v227, v198, 5, v227
    v_mfma_f32_16x16x32_bf16 v[132:135], a[80:83], a[48:51], v[132:135]
    v_exp_f32 v208, v148
    v_cvt_pk_bf16_f32 v243, v214, v215
    v_mfma_f32_16x16x32_bf16 v[132:135], a[84:87], a[52:55], v[132:135]
    v_or3_b32 v197, v240, v241, v242
    v_exp_f32 v209, v149
    v_mfma_f32_16x16x32_bf16 v[132:135], a[88:91], a[56:59], v[132:135]
    v_exp_f32 v210, v150
    v_cvt_pk_bf16_f32 v244, v208, v209
    v_mfma_f32_16x16x32_bf16 v[132:135], a[92:95], a[60:63], v[132:135]
    v_exp_f32 v211, v151
    v_lshl_add_u32 v227, v198, 3, v227
    s_waitcnt lgkmcnt(0)
    v_mfma_f32_16x16x32_bf16 v[136:139], a[96:99], a[0:3], v[232:235]
    v_exp_f32 v212, v156
    v_cvt_pk_bf16_f32 v245, v210, v211
    v_mfma_f32_16x16x32_bf16 v[136:139], a[100:103], a[4:7], v[136:139]
    v_or3_b32 v197, v197, v243, v244
    v_exp_f32 v213, v157
    v_mfma_f32_16x16x32_bf16 v[136:139], a[104:107], a[8:11], v[136:139]
    v_exp_f32 v214, v158
    v_cvt_pk_bf16_f32 v246, v212, v213
    v_mfma_f32_16x16x32_bf16 v[136:139], a[108:111], a[12:15], v[136:139]
    v_exp_f32 v215, v159
    v_or3_b32 v197, v197, v245, v246
    v_mfma_f32_16x16x32_bf16 v[136:139], a[112:115], a[16:19], v[136:139]
    v_cvt_pk_bf16_f32 v247, v214, v215
    v_or_b32 v197, v197, v247
    v_and_b32 v197, s48, v197
    v_mfma_f32_16x16x32_bf16 v[136:139], a[116:119], a[20:23], v[136:139]
    v_cmp_ne_u32 vcc, 0, v197
    v_xor_b32 v228, 8, v227
    v_lshl_add_u32 v227, v227, 3, s56
    v_mfma_f32_16x16x32_bf16 v[136:139], a[120:123], a[24:27], v[136:139]
    v_lshl_add_u32 v228, v228, 3, s56
    v_bfe_u32 v229, v216, 2, 2
    v_and_b32 v198, 3, v216
    v_mfma_f32_16x16x32_bf16 v[136:139], a[124:127], a[28:31], v[136:139]
    v_lshl_add_u32 v229, v198, 2, v229
    v_bfe_u32 v198, v216, 4, 1
    v_lshl_add_u32 v229, v198, 4, v229
    v_mfma_f32_16x16x32_bf16 v[140:143], a[96:99], a[32:35], v[236:239]
    v_bfe_u32 v198, v216, 5, 1
    v_lshl_add_u32 v229, v198, 6, v229
    v_xor_b32 v230, 8, v229
    v_mfma_f32_16x16x32_bf16 v[140:143], a[100:103], a[36:39], v[140:143]
    v_lshl_add_u32 v229, v229, 3, s56
    v_lshl_add_u32 v230, v230, 3, s56
    v_lshrrev_b32 v198, 3, v216
    v_mfma_f32_16x16x32_bf16 v[140:143], a[104:107], a[40:43], v[140:143]
    v_lshlrev_b32 v198, 9, v198
    v_and_b32 v199, 7, v216
    v_lshl_add_u32 v231, v199, 4, v198
    v_mfma_f32_16x16x32_bf16 v[140:143], a[108:111], a[44:47], v[140:143]
    s_add_u32 s84, s58, 0
    s_add_u32 s85, s58, 4096
    s_add_u32 s86, s58, 8192
    v_mfma_f32_16x16x32_bf16 v[140:143], a[112:115], a[48:51], v[140:143]
    s_add_u32 s87, s58, 12288
    v_mfma_f32_16x16x32_bf16 v[140:143], a[116:119], a[52:55], v[140:143]
    v_mfma_f32_16x16x32_bf16 v[140:143], a[120:123], a[56:59], v[140:143]
    v_mfma_f32_16x16x32_bf16 v[140:143], a[124:127], a[60:63], v[140:143]
    s_mov_b32 s54, s46
    s_cmp_lt_u32 s54, s45
    s_cbranch_scc1 L_fok1_2
    v_mov_b32 v240, 0
    v_mov_b32 v241, 0
    v_mov_b32 v242, 0
    v_mov_b32 v243, 0
    v_mov_b32 v244, 0
    v_mov_b32 v245, 0
    v_mov_b32 v246, 0
    v_mov_b32 v247, 0
    s_branch L_fback1_2
L_fok1_2:
    s_cbranch_vccnz L_frare1_2
L_fback1_2:
    s_waitcnt vmcnt(0)
    s_barrier
    ds_read_b64_tr_b16 a[64:65], v180 offset:16384
    ds_read_b64_tr_b16 a[66:67], v180 offset:24576
    ds_read_b64_tr_b16 a[68:69], v180 offset:32768
    ds_read_b64_tr_b16 a[70:71], v180 offset:40960
    ds_read_b64_tr_b16 a[72:73], v180 offset:49152
    ds_read_b64_tr_b16 a[74:75], v180 offset:57344
    ds_read_b64_tr_b16 a[76:77], v180
    ds_read_b64_tr_b16 a[78:79], v180 offset:8192
    ds_read_b64_tr_b16 a[80:81], v181 offset:16384
    ds_read_b64_tr_b16 a[82:83], v181 offset:24576
    ds_read_b64_tr_b16 a[84:85], v181 offset:32768
    ds_read_b64_tr_b16 a[86:87], v181 offset:40960
    v_mfma_f32_16x16x32_bf16 v[200:203], v[168:171], a[128:131], v[200:203]
    v_mfma_f32_16x16x32_bf16 v[200:203], v[160:163], a[128:131], v[200:203]
    v_exp_f32 v208, v128
    v_exp_f32 v209, v129
    v_mfma_f32_16x16x32_bf16 v[200:203], v[240:243], a[128:131], v[200:203]
    v_exp_f32 v210, v130
    v_cvt_pk_bf16_f32 v248, v208, v209
    v_mfma_f32_16x16x32_bf16 v[204:207], v[172:175], a[128:131], v[204:207]
    v_exp_f32 v211, v131
    v_exp_f32 v212, v136
    v_mfma_f32_16x16x32_bf16 v[204:207], v[164:167], a[128:131], v[204:207]
    v_cvt_pk_bf16_f32 v249, v210, v211
    v_exp_f32 v213, v137
    v_mfma_f32_16x16x32_bf16 v[204:207], v[244:247], a[128:131], v[204:207]
    v_exp_f32 v214, v138
    v_cvt_pk_bf16_f32 v250, v212, v213
    v_exp_f32 v215, v139
    v_exp_f32 v208, v132
    v_cvt_pk_bf16_f32 v251, v214, v215
    v_or3_b32 v197, v248, v249, v250
    v_exp_f32 v209, v133
    v_exp_f32 v210, v134
    v_cvt_pk_bf16_f32 v252, v208, v209
    v_exp_f32 v211, v135
    v_exp_f32 v212, v140
    v_cvt_pk_bf16_f32 v253, v210, v211
    v_or3_b32 v197, v197, v251, v252
    v_exp_f32 v213, v141
    v_exp_f32 v214, v142
    v_cvt_pk_bf16_f32 v254, v212, v213
    v_exp_f32 v215, v143
    v_or3_b32 v197, v197, v253, v254
    v_cvt_pk_bf16_f32 v255, v214, v215
    v_or_b32 v197, v197, v255
    v_and_b32 v197, s48, v197
    v_cmp_ne_u32 vcc, 0, v197
    s_add_u32 s54, s46, 1
    s_cmp_lt_u32 s54, s45
    s_cbranch_scc1 L_fok1_3
    v_mov_b32 v248, 0
    v_mov_b32 v249, 0
    v_mov_b32 v250, 0
    v_mov_b32 v251, 0
    v_mov_b32 v252, 0
    v_mov_b32 v253, 0
    v_mov_b32 v254, 0
    v_mov_b32 v255, 0
    s_branch L_fback1_3
L_fok1_3:
    s_cbranch_vccnz L_frare1_3
L_fback1_3:
    s_nop 7
    v_mfma_f32_16x16x32_bf16 v[200:203], v[248:251], a[128:131], v[200:203]
    v_mfma_f32_16x16x32_bf16 v[204:207], v[252:255], a[128:131], v[204:207]
    s_waitcnt lgkmcnt(0)
    v_mfma_f32_16x16x32_bf16 v[0:3], v[168:171], a[64:67], v[0:3]
    ds_read_b64_tr_b16 a[88:89], v181 offset:49152
    ds_read_b64_tr_b16 a[90:91], v181 offset:57344
    v_mfma_f32_16x16x32_bf16 v[0:3], v[160:163], a[68:71], v[0:3]
    v_mfma_f32_16x16x32_bf16 v[0:3], v[240:243], a[72:75], v[0:3]
    ds_read_b64_tr_b16 a[92:93], v181
    ds_read_b64_tr_b16 a[94:95], v181 offset:8192
    v_mfma_f32_16x16x32_bf16 v[0:3], v[248:251], a[76:79], v[0:3]
    v_mfma_f32_16x16x32_bf16 v[64:67], v[172:175], a[64:67], v[64:67]
    ds_read_b64_tr_b16 a[96:97], v182 offset:16384
    ds_read_b64_tr_b16 a[98:99], v182 offset:24576
    v_mfma_f32_16x16x32_bf16 v[64:67], v[164:167], a[68:71], v[64:67]
    v_rcp_f32 v200, v200
    v_mfma_f32_16x16x32_bf16 v[64:67], v[244:247], a[72:75], v[64:67]
    ds_read_b64_tr_b16 a[100:101], v182 offset:32768
    ds_read_b64_tr_b16 a[102:103], v182 offset:40960
    v_mfma_f32_16x16x32_bf16 v[64:67], v[252:255], a[76:79], v[64:67]
    v_rcp_f32 v201, v201
    v_mfma_f32_16x16x32_bf16 v[4:7], v[168:171], a[80:83], v[4:7]
    ds_read_b64_tr_b16 a[104:105], v182 offset:49152
    ds_read_b64_tr_b16 a[106:107], v182 offset:57344
    v_mfma_f32_16x16x32_bf16 v[4:7], v[160:163], a[84:87], v[4:7]
    v_rcp_f32 v202, v202
    s_waitcnt lgkmcnt(8)
    v_mfma_f32_16x16x32_bf16 v[4:7], v[240:243], a[88:91], v[4:7]
    ds_read_b64_tr_b16 a[108:109], v182
    ds_read_b64_tr_b16 a[110:111], v182 offset:8192
    s_waitcnt lgkmcnt(8)
    v_mfma_f32_16x16x32_bf16 v[4:7], v[248:251], a[92:95], v[4:7]
    v_rcp_f32 v203, v203
    v_mfma_f32_16x16x32_bf16 v[68:71], v[172:175], a[80:83], v[68:71]
    ds_read_b64_tr_b16 a[112:113], v183 offset:16384
    ds_read_b64_tr_b16 a[114:115], v183 offset:24576
    v_mfma_f32_16x16x32_bf16 v[68:71], v[164:167], a[84:87], v[68:71]
    v_rcp_f32 v204, v204
    v_mfma_f32_16x16x32_bf16 v[68:71], v[244:247], a[88:91], v[68:71]
    ds_read_b64_tr_b16 a[116:117], v183 offset:32768
    ds_read_b64_tr_b16 a[118:119], v183 offset:40960
    v_mfma_f32_16x16x32_bf16 v[68:71], v[252:255], a[92:95], v[68:71]
    v_rcp_f32 v205, v205
    s_waitcnt lgkmcnt(7)
    v_mfma_f32_16x16x32_bf16 v[8:11], v[168:171], a[96:99], v[8:11]
    ds_read_b64_tr_b16 a[120:121], v183 offset:49152
    ds_read_b64_tr_b16 a[122:123], v183 offset:57344
    v_mfma_f32_16x16x32_bf16 v[8:11], v[160:163], a[100:103], v[8:11]
    v_rcp_f32 v206, v206
    s_waitcnt lgkmcnt(7)
    v_mfma_f32_16x16x32_bf16 v[8:11], v[240:243], a[104:107], v[8:11]
    ds_read_b64_tr_b16 a[124:125], v183
    ds_read_b64_tr_b16 a[126:127], v183 offset:8192
    s_waitcnt lgkmcnt(8)
    v_mfma_f32_16x16x32_bf16 v[8:11], v[248:251], a[108:111], v[8:11]
    v_rcp_f32 v207, v207
    v_mfma_f32_16x16x32_bf16 v[72:75], v[172:175], a[96:99], v[72:75]
    ds_read_b64_tr_b16 a[64:65], v184 offset:16384
    ds_read_b64_tr_b16 a[66:67], v184 offset:24576
    v_mfma_f32_16x16x32_bf16 v[72:75], v[164:167], a[100:103], v[72:75]
    v_mfma_f32_16x16x32_bf16 v[72:75], v[244:247], a[104:107], v[72:75]
    ds_read_b64_tr_b16 a[68:69], v184 offset:32768
    ds_read_b64_tr_b16 a[70:71], v184 offset:40960
    v_mfma_f32_16x16x32_bf16 v[72:75], v[252:255], a[108:111], v[72:75]
    s_waitcnt lgkmcnt(8)
    v_mfma_f32_16x16x32_bf16 v[12:15], v[168:171], a[112:115], v[12:15]
    ds_read_b64_tr_b16 a[72:73], v184 offset:49152
    ds_read_b64_tr_b16 a[74:75], v184 offset:57344
    v_mfma_f32_16x16x32_bf16 v[12:15], v[160:163], a[116:119], v[12:15]
    s_waitcnt lgkmcnt(8)
    v_mfma_f32_16x16x32_bf16 v[12:15], v[240:243], a[120:123], v[12:15]
    ds_read_b64_tr_b16 a[76:77], v184
    ds_read_b64_tr_b16 a[78:79], v184 offset:8192
    s_waitcnt lgkmcnt(8)
    v_mfma_f32_16x16x32_bf16 v[12:15], v[248:251], a[124:127], v[12:15]
    v_mfma_f32_16x16x32_bf16 v[76:79], v[172:175], a[112:115], v[76:79]
    ds_read_b64_tr_b16 a[80:81], v185 offset:16384
    ds_read_b64_tr_b16 a[82:83], v185 offset:24576
    v_mfma_f32_16x16x32_bf16 v[76:79], v[164:167], a[116:119], v[76:79]
    v_mfma_f32_16x16x32_bf16 v[76:79], v[244:247], a[120:123], v[76:79]
    ds_read_b64_tr_b16 a[84:85], v185 offset:32768
    ds_read_b64_tr_b16 a[86:87], v185 offset:40960
    v_mfma_f32_16x16x32_bf16 v[76:79], v[252:255], a[124:127], v[76:79]
    s_waitcnt lgkmcnt(8)
    v_mfma_f32_16x16x32_bf16 v[16:19], v[168:171], a[64:67], v[16:19]
    ds_read_b64_tr_b16 a[88:89], v185 offset:49152
    ds_read_b64_tr_b16 a[90:91], v185 offset:57344
    v_mfma_f32_16x16x32_bf16 v[16:19], v[160:163], a[68:71], v[16:19]
    s_waitcnt lgkmcnt(8)
    v_mfma_f32_16x16x32_bf16 v[16:19], v[240:243], a[72:75], v[16:19]
    ds_read_b64_tr_b16 a[92:93], v185
    ds_read_b64_tr_b16 a[94:95], v185 offset:8192
    s_waitcnt lgkmcnt(8)
    v_mfma_f32_16x16x32_bf16 v[16:19], v[248:251], a[76:79], v[16:19]
    v_mul_f32 v0, v0, v200
    v_mul_f32 v1, v1, v201
    v_mul_f32 v4, v4, v200
    v_mfma_f32_16x16x32_bf16 v[80:83], v[172:175], a[64:67], v[80:83]
    ds_read_b64_tr_b16 a[96:97], v186 offset:16384
    ds_read_b64_tr_b16 a[98:99], v186 offset:24576
    v_mul_f32 v5, v5, v201
    v_mfma_f32_16x16x32_bf16 v[80:83], v[164:167], a[68:71], v[80:83]
    v_mul_f32 v8, v8, v200
    v_mul_f32 v9, v9, v201
    v_mul_f32 v12, v12, v200
    v_mfma_f32_16x16x32_bf16 v[80:83], v[244:247], a[72:75], v[80:83]
    ds_read_b64_tr_b16 a[100:101], v186 offset:32768
    ds_read_b64_tr_b16 a[102:103], v186 offset:40960
    v_mul_f32 v13, v13, v201
    v_mfma_f32_16x16x32_bf16 v[80:83], v[252:255], a[76:79], v[80:83]
    v_cvt_pk_bf16_f32 v128, v0, v4
    v_cvt_pk_bf16_f32 v129, v8, v12
    ds_write_b64 v227, v[128:129]
    s_waitcnt lgkmcnt(5)
    v_mfma_f32_16x16x32_bf16 v[20:23], v[168:171], a[80:83], v[20:23]
    ds_read_b64_tr_b16 a[104:105], v186 offset:49152
    ds_read_b64_tr_b16 a[106:107], v186 offset:57344
    v_cvt_pk_bf16_f32 v130, v1, v5
    v_mfma_f32_16x16x32_bf16 v[20:23], v[160:163], a[84:87], v[20:23]
    v_cvt_pk_bf16_f32 v131, v9, v13
    ds_write_b64 v228, v[130:131]
    v_mul_f32 v2, v2, v202
    v_mfma_f32_16x16x32_bf16 v[20:23], v[240:243], a[88:91], v[20:23]
    ds_read_b64_tr_b16 a[108:109], v186
    ds_read_b64_tr_b16 a[110:111], v186 offset:8192
    v_mul_f32 v3, v3, v203
    v_mfma_f32_16x16x32_bf16 v[20:23], v[248:251], a[92:95], v[20:23]
    v_mul_f32 v6, v6, v202
    v_mul_f32 v7, v7, v203
    v_mul_f32 v10, v10, v202
    v_mfma_f32_16x16x32_bf16 v[84:87], v[172:175], a[80:83], v[84:87]
    ds_read_b64_tr_b16 a[112:113], v187 offset:16384
    ds_read_b64_tr_b16 a[114:115], v187 offset:24576
    v_mul_f32 v11, v11, v203
    v_mfma_f32_16x16x32_bf16 v[84:87], v[164:167], a[84:87], v[84:87]
    v_mul_f32 v14, v14, v202
    v_mul_f32 v15, v15, v203
    v_cvt_pk_bf16_f32 v132, v2, v6
    v_mfma_f32_16x16x32_bf16 v[84:87], v[244:247], a[88:91], v[84:87]
    ds_read_b64_tr_b16 a[116:117], v187 offset:32768
    ds_read_b64_tr_b16 a[118:119], v187 offset:40960
    v_cvt_pk_bf16_f32 v133, v10, v14
    v_mfma_f32_16x16x32_bf16 v[84:87], v[252:255], a[92:95], v[84:87]
    ds_write_b64 v227, v[132:133] offset:128
    v_cvt_pk_bf16_f32 v134, v3, v7
    v_cvt_pk_bf16_f32 v135, v11, v15
    s_waitcnt lgkmcnt(5)
    v_mfma_f32_16x16x32_bf16 v[24:27], v[168:171], a[96:99], v[24:27]
    ds_read_b64_tr_b16 a[120:121], v187 offset:49152
    ds_read_b64_tr_b16 a[122:123], v187 offset:57344
    ds_write_b64 v228, v[134:135] offset:128
    v_mfma_f32_16x16x32_bf16 v[24:27], v[160:163], a[100:103], v[24:27]
    ds_read_b64_tr_b16 v[144:145], v229
    ds_read_b64_tr_b16 v[146:147], v230 offset:256
    ds_read_b64_tr_b16 v[148:149], v229 offset:1024
    v_mfma_f32_16x16x32_bf16 v[24:27], v[240:243], a[104:107], v[24:27]
    ds_read_b64_tr_b16 a[124:125], v187
    ds_read_b64_tr_b16 a[126:127], v187 offset:8192
    ds_read_b64_tr_b16 v[150:151], v230 offset:1280
    v_mfma_f32_16x16x32_bf16 v[24:27], v[248:251], a[108:111], v[24:27]
    v_mul_f32 v64, v64, v204
    v_mul_f32 v65, v65, v205
    v_mul_f32 v68, v68, v204
    v_mfma_f32_16x16x32_bf16 v[88:91], v[172:175], a[96:99], v[88:91]
    ds_read_b64_tr_b16 a[64:65], v180 offset:16640
    s_waitcnt lgkmcnt(10)
    ds_read_b64_tr_b16 a[66:67], v180 offset:24832
    v_mul_f32 v69, v69, v205
    v_mfma_f32_16x16x32_bf16 v[88:91], v[164:167], a[100:103], v[88:91]
    v_mul_f32 v72, v72, v204
    v_mul_f32 v73, v73, v205
    v_mul_f32 v76, v76, v204
    v_mfma_f32_16x16x32_bf16 v[88:91], v[244:247], a[104:107], v[88:91]
    ds_read_b64_tr_b16 a[68:69], v180 offset:33024
    ds_read_b64_tr_b16 a[70:71], v180 offset:41216
    v_mul_f32 v77, v77, v205
    v_mfma_f32_16x16x32_bf16 v[88:91], v[252:255], a[108:111], v[88:91]
    v_cvt_pk_bf16_f32 v136, v64, v68
    v_cvt_pk_bf16_f32 v137, v72, v76
    v_mfma_f32_16x16x32_bf16 v[28:31], v[168:171], a[112:115], v[28:31]
    ds_read_b64_tr_b16 a[72:73], v180 offset:49408
    ds_read_b64_tr_b16 a[74:75], v180 offset:57600
    v_mfma_f32_16x16x32_bf16 v[28:31], v[160:163], a[116:119], v[28:31]
    s_waitcnt lgkmcnt(6)
    buffer_store_dwordx4 v[144:147], v231, s[36:39], s84 offen nt
    v_mfma_f32_16x16x32_bf16 v[28:31], v[240:243], a[120:123], v[28:31]
    ds_read_b64_tr_b16 a[76:77], v180 offset:256
    ds_read_b64_tr_b16 a[78:79], v180 offset:8448
    v_mfma_f32_16x16x32_bf16 v[28:31], v[248:251], a[124:127], v[28:31]
    buffer_store_dwordx4 v[148:151], v231, s[36:39], s85 offen nt
    ds_write_b64 v227, v[136:137] offset:2048
    v_mfma_f32_16x16x32_bf16 v[92:95], v[172:175], a[112:115], v[92:95]
    ds_read_b64_tr_b16 a[80:81], v181 offset:16640
    ds_read_b64_tr_b16 a[82:83], v181 offset:24832
    v_cvt_pk_bf16_f32 v138, v65, v69
    v_mfma_f32_16x16x32_bf16 v[92:95], v[164:167], a[116:119], v[92:95]
    v_cvt_pk_bf16_f32 v139, v73, v77
    ds_write_b64 v228, v[138:139] offset:2048
    v_mul_f32 v66, v66, v206
    v_mfma_f32_16x16x32_bf16 v[92:95], v[244:247], a[120:123], v[92:95]
    ds_read_b64_tr_b16 a[84:85], v181 offset:33024
    ds_read_b64_tr_b16 a[86:87], v181 offset:41216
    v_mul_f32 v67, v67, v207
    v_mfma_f32_16x16x32_bf16 v[92:95], v[252:255], a[124:127], v[92:95]
    v_mul_f32 v70, v70, v206
    v_mul_f32 v71, v71, v207
    v_mul_f32 v74, v74, v206
    v_mul_f32 v75, v75, v207
    v_mul_f32 v78, v78, v206
    v_mul_f32 v79, v79, v207
    v_cvt_pk_bf16_f32 v140, v66, v70
    v_cvt_pk_bf16_f32 v141, v74, v78
    ds_write_b64 v227, v[140:141] offset:2176
    v_cvt_pk_bf16_f32 v142, v67, v71
    v_cvt_pk_bf16_f32 v143, v75, v79
    s_waitcnt lgkmcnt(4)
    ds_write_b64 v228, v[142:143] offset:2176
    ds_read_b64_tr_b16 v[152:153], v229 offset:2048
    ds_read_b64_tr_b16 v[154:155], v230 offset:2304
    ds_read_b64_tr_b16 v[156:157], v229 offset:3072
    ds_read_b64_tr_b16 v[158:159], v230 offset:3328
    v_mfma_f32_16x16x32_bf16 v[32:35], v[168:171], a[64:67], v[32:35]
    ds_read_b64_tr_b16 a[88:89], v181 offset:49408
    ds_read_b64_tr_b16 a[90:91], v181 offset:57600
    v_mfma_f32_16x16x32_bf16 v[32:35], v[160:163], a[68:71], v[32:35]
    v_mfma_f32_16x16x32_bf16 v[32:35], v[240:243], a[72:75], v[32:35]
    ds_read_b64_tr_b16 a[92:93], v181 offset:256
    ds_read_b64_tr_b16 a[94:95], v181 offset:8448
    v_mfma_f32_16x16x32_bf16 v[32:35], v[248:251], a[76:79], v[32:35]
    s_waitcnt lgkmcnt(6)
    buffer_store_dwordx4 v[152:155], v231, s[36:39], s86 offen nt
    v_mfma_f32_16x16x32_bf16 v[96:99], v[172:175], a[64:67], v[96:99]
    ds_read_b64_tr_b16 a[96:97], v182 offset:16640
    ds_read_b64_tr_b16 a[98:99], v182 offset:24832
    v_mfma_f32_16x16x32_bf16 v[96:99], v[164:167], a[68:71], v[96:99]
    s_waitcnt lgkmcnt(6)
    buffer_store_dwordx4 v[156:159], v231, s[36:39], s87 offen nt
    v_mul_f32 v16, v16, v200
    v_mfma_f32_16x16x32_bf16 v[96:99], v[244:247], a[72:75], v[96:99]
    ds_read_b64_tr_b16 a[100:101], v182 offset:33024
    ds_read_b64_tr_b16 a[102:103], v182 offset:41216
    v_mul_f32 v17, v17, v201
    v_mfma_f32_16x16x32_bf16 v[96:99], v[252:255], a[76:79], v[96:99]
    v_mul_f32 v20, v20, v200
    v_mul_f32 v21, v21, v201
    v_mul_f32 v24, v24, v200
    v_mfma_f32_16x16x32_bf16 v[36:39], v[168:171], a[80:83], v[36:39]
    ds_read_b64_tr_b16 a[104:105], v182 offset:49408
    ds_read_b64_tr_b16 a[106:107], v182 offset:57600
    v_mul_f32 v25, v25, v201
    v_mfma_f32_16x16x32_bf16 v[36:39], v[160:163], a[84:87], v[36:39]
    v_mul_f32 v28, v28, v200
    v_mul_f32 v29, v29, v201
    v_cvt_pk_bf16_f32 v128, v16, v20
    s_waitcnt lgkmcnt(4)
    v_mfma_f32_16x16x32_bf16 v[36:39], v[240:243], a[88:91], v[36:39]
    ds_read_b64_tr_b16 a[108:109], v182 offset:256
    ds_read_b64_tr_b16 a[110:111], v182 offset:8448
    v_cvt_pk_bf16_f32 v129, v24, v28
    v_mfma_f32_16x16x32_bf16 v[36:39], v[248:251], a[92:95], v[36:39]
    ds_write_b64 v227, v[128:129] offset:4096
    v_cvt_pk_bf16_f32 v130, v17, v21
    v_cvt_pk_bf16_f32 v131, v25, v29
    v_mfma_f32_16x16x32_bf16 v[100:103], v[172:175], a[80:83], v[100:103]
    ds_read_b64_tr_b16 a[112:113], v183 offset:16640
    ds_read_b64_tr_b16 a[114:115], v183 offset:24832
    ds_write_b64 v228, v[130:131] offset:4096
    v_mfma_f32_16x16x32_bf16 v[100:103], v[164:167], a[84:87], v[100:103]
    v_mul_f32 v18, v18, v202
    v_mul_f32 v19, v19, v203
    v_mul_f32 v22, v22, v202
    v_mfma_f32_16x16x32_bf16 v[100:103], v[244:247], a[88:91], v[100:103]
    ds_read_b64_tr_b16 a[116:117], v183 offset:33024
    ds_read_b64_tr_b16 a[118:119], v183 offset:41216
    v_mul_f32 v23, v23, v203
    v_mfma_f32_16x16x32_bf16 v[100:103], v[252:255], a[92:95], v[100:103]
    v_mul_f32 v26, v26, v202
    v_mul_f32 v27, v27, v203
    v_mul_f32 v30, v30, v202
    v_mfma_f32_16x16x32_bf16 v[40:43], v[168:171], a[96:99], v[40:43]
    ds_read_b64_tr_b16 a[120:121], v183 offset:49408
    ds_read_b64_tr_b16 a[122:123], v183 offset:57600
    v_mul_f32 v31, v31, v203
    s_waitcnt lgkmcnt(7)
    v_mfma_f32_16x16x32_bf16 v[40:43], v[160:163], a[100:103], v[40:43]
    v_cvt_pk_bf16_f32 v132, v18, v22
    v_cvt_pk_bf16_f32 v133, v26, v30
    ds_write_b64 v227, v[132:133] offset:4224
    v_mfma_f32_16x16x32_bf16 v[40:43], v[240:243], a[104:107], v[40:43]
    ds_read_b64_tr_b16 a[124:125], v183 offset:256
    ds_read_b64_tr_b16 a[126:127], v183 offset:8448
    v_cvt_pk_bf16_f32 v134, v19, v23
    v_mfma_f32_16x16x32_bf16 v[40:43], v[248:251], a[108:111], v[40:43]
    v_cvt_pk_bf16_f32 v135, v27, v31
    ds_write_b64 v228, v[134:135] offset:4224
    ds_read_b64_tr_b16 v[144:145], v229 offset:4096
    v_mfma_f32_16x16x32_bf16 v[104:107], v[172:175], a[96:99], v[104:107]
    ds_read_b64_tr_b16 a[64:65], v184 offset:16640
    ds_read_b64_tr_b16 a[66:67], v184 offset:24832
    ds_read_b64_tr_b16 v[146:147], v230 offset:4352
    v_mfma_f32_16x16x32_bf16 v[104:107], v[164:167], a[100:103], v[104:107]
    s_waitcnt lgkmcnt(9)
    ds_read_b64_tr_b16 v[148:149], v229 offset:5120
    ds_read_b64_tr_b16 v[150:151], v230 offset:5376
    v_mul_f32 v80, v80, v204
    v_mfma_f32_16x16x32_bf16 v[104:107], v[244:247], a[104:107], v[104:107]
    ds_read_b64_tr_b16 a[68:69], v184 offset:33024
    ds_read_b64_tr_b16 a[70:71], v184 offset:41216
    v_mul_f32 v81, v81, v205
    v_mfma_f32_16x16x32_bf16 v[104:107], v[252:255], a[108:111], v[104:107]
    v_mul_f32 v84, v84, v204
    v_mul_f32 v85, v85, v205
    v_mul_f32 v88, v88, v204
    v_mfma_f32_16x16x32_bf16 v[44:47], v[168:171], a[112:115], v[44:47]
    ds_read_b64_tr_b16 a[72:73], v184 offset:49408
    ds_read_b64_tr_b16 a[74:75], v184 offset:57600
    v_mul_f32 v89, v89, v205
    v_mfma_f32_16x16x32_bf16 v[44:47], v[160:163], a[116:119], v[44:47]
    v_mul_f32 v92, v92, v204
    v_mul_f32 v93, v93, v205
    v_cvt_pk_bf16_f32 v136, v80, v84
    s_waitcnt lgkmcnt(6)
    v_mfma_f32_16x16x32_bf16 v[44:47], v[240:243], a[120:123], v[44:47]
    ds_read_b64_tr_b16 a[76:77], v184 offset:256
    ds_read_b64_tr_b16 a[78:79], v184 offset:8448
    v_cvt_pk_bf16_f32 v137, v88, v92
    v_mfma_f32_16x16x32_bf16 v[44:47], v[248:251], a[124:127], v[44:47]
    buffer_store_dwordx4 v[144:147], v231, s[36:39], s84 offen offset:128 nt
    v_mfma_f32_16x16x32_bf16 v[108:111], v[172:175], a[112:115], v[108:111]
    ds_read_b64_tr_b16 a[80:81], v185 offset:16640
    ds_read_b64_tr_b16 a[82:83], v185 offset:24832
    v_mfma_f32_16x16x32_bf16 v[108:111], v[164:167], a[116:119], v[108:111]
    s_waitcnt lgkmcnt(6)
    buffer_store_dwordx4 v[148:151], v231, s[36:39], s85 offen offset:128 nt
    ds_write_b64 v227, v[136:137] offset:6144
    v_mfma_f32_16x16x32_bf16 v[108:111], v[244:247], a[120:123], v[108:111]
    ds_read_b64_tr_b16 a[84:85], v185 offset:33024
    ds_read_b64_tr_b16 a[86:87], v185 offset:41216
    v_cvt_pk_bf16_f32 v138, v81, v85
    v_mfma_f32_16x16x32_bf16 v[108:111], v[252:255], a[124:127], v[108:111]
    v_cvt_pk_bf16_f32 v139, v89, v93
    ds_write_b64 v228, v[138:139] offset:6144
    v_mul_f32 v82, v82, v206
    v_mul_f32 v83, v83, v207
    v_mul_f32 v86, v86, v206
    v_mul_f32 v87, v87, v207
    v_mul_f32 v90, v90, v206
    v_mul_f32 v91, v91, v207
    v_mul_f32 v94, v94, v206
    v_mul_f32 v95, v95, v207
    v_cvt_pk_bf16_f32 v140, v82, v86
    v_cvt_pk_bf16_f32 v141, v90, v94
    ds_write_b64 v227, v[140:141] offset:6272
    v_cvt_pk_bf16_f32 v142, v83, v87
    v_cvt_pk_bf16_f32 v143, v91, v95
    ds_write_b64 v228, v[142:143] offset:6272
    ds_read_b64_tr_b16 v[152:153], v229 offset:6144
    ds_read_b64_tr_b16 v[154:155], v230 offset:6400
    ds_read_b64_tr_b16 v[156:157], v229 offset:7168
    s_waitcnt lgkmcnt(6)
    ds_read_b64_tr_b16 v[158:159], v230 offset:7424
    v_mfma_f32_16x16x32_bf16 v[48:51], v[168:171], a[64:67], v[48:51]
    ds_read_b64_tr_b16 a[88:89], v185 offset:49408
    ds_read_b64_tr_b16 a[90:91], v185 offset:57600
    v_mfma_f32_16x16x32_bf16 v[48:51], v[160:163], a[68:71], v[48:51]
    v_mfma_f32_16x16x32_bf16 v[48:51], v[240:243], a[72:75], v[48:51]
    ds_read_b64_tr_b16 a[92:93], v185 offset:256
    ds_read_b64_tr_b16 a[94:95], v185 offset:8448
    v_mfma_f32_16x16x32_bf16 v[48:51], v[248:251], a[76:79], v[48:51]
    s_waitcnt lgkmcnt(6)
    buffer_store_dwordx4 v[152:155], v231, s[36:39], s86 offen offset:128 nt
    v_mfma_f32_16x16x32_bf16 v[112:115], v[172:175], a[64:67], v[112:115]
    ds_read_b64_tr_b16 a[96:97], v186 offset:16640
    ds_read_b64_tr_b16 a[98:99], v186 offset:24832
    v_mfma_f32_16x16x32_bf16 v[112:115], v[164:167], a[68:71], v[112:115]
    s_waitcnt lgkmcnt(6)
    buffer_store_dwordx4 v[156:159], v231, s[36:39], s87 offen offset:128 nt
    v_mul_f32 v32, v32, v200
    v_mfma_f32_16x16x32_bf16 v[112:115], v[244:247], a[72:75], v[112:115]
    ds_read_b64_tr_b16 a[100:101], v186 offset:33024
    ds_read_b64_tr_b16 a[102:103], v186 offset:41216
    v_mul_f32 v33, v33, v201
    v_mfma_f32_16x16x32_bf16 v[112:115], v[252:255], a[76:79], v[112:115]
    v_mul_f32 v36, v36, v200
    v_mul_f32 v37, v37, v201
    v_mul_f32 v40, v40, v200
    v_mfma_f32_16x16x32_bf16 v[52:55], v[168:171], a[80:83], v[52:55]
    ds_read_b64_tr_b16 a[104:105], v186 offset:49408
    ds_read_b64_tr_b16 a[106:107], v186 offset:57600
    v_mul_f32 v41, v41, v201
    v_mfma_f32_16x16x32_bf16 v[52:55], v[160:163], a[84:87], v[52:55]
    v_mul_f32 v44, v44, v200
    v_mul_f32 v45, v45, v201
    v_cvt_pk_bf16_f32 v128, v32, v36
    s_waitcnt lgkmcnt(4)
    v_mfma_f32_16x16x32_bf16 v[52:55], v[240:243], a[88:91], v[52:55]
    ds_read_b64_tr_b16 a[108:109], v186 offset:256
    ds_read_b64_tr_b16 a[110:111], v186 offset:8448
    v_cvt_pk_bf16_f32 v129, v40, v44
    v_mfma_f32_16x16x32_bf16 v[52:55], v[248:251], a[92:95], v[52:55]
    ds_write_b64 v227, v[128:129]
    v_cvt_pk_bf16_f32 v130, v33, v37
    v_cvt_pk_bf16_f32 v131, v41, v45
    v_mfma_f32_16x16x32_bf16 v[116:119], v[172:175], a[80:83], v[116:119]
    ds_read_b64_tr_b16 a[112:113], v187 offset:16640
    ds_read_b64_tr_b16 a[114:115], v187 offset:24832
    ds_write_b64 v228, v[130:131]
    v_mfma_f32_16x16x32_bf16 v[116:119], v[164:167], a[84:87], v[116:119]
    v_mul_f32 v34, v34, v202
    v_mul_f32 v35, v35, v203
    v_mul_f32 v38, v38, v202
    v_mfma_f32_16x16x32_bf16 v[116:119], v[244:247], a[88:91], v[116:119]
    ds_read_b64_tr_b16 a[116:117], v187 offset:33024
    ds_read_b64_tr_b16 a[118:119], v187 offset:41216
    v_mul_f32 v39, v39, v203
    v_mfma_f32_16x16x32_bf16 v[116:119], v[252:255], a[92:95], v[116:119]
    v_mul_f32 v42, v42, v202
    v_mul_f32 v43, v43, v203
    v_mul_f32 v46, v46, v202
    v_mfma_f32_16x16x32_bf16 v[56:59], v[168:171], a[96:99], v[56:59]
    ds_read_b64_tr_b16 a[120:121], v187 offset:49408
    ds_read_b64_tr_b16 a[122:123], v187 offset:57600
    v_mul_f32 v47, v47, v203
    s_waitcnt lgkmcnt(7)
    v_mfma_f32_16x16x32_bf16 v[56:59], v[160:163], a[100:103], v[56:59]
    v_cvt_pk_bf16_f32 v132, v34, v38
    v_cvt_pk_bf16_f32 v133, v42, v46
    ds_write_b64 v227, v[132:133] offset:128
    v_mfma_f32_16x16x32_bf16 v[56:59], v[240:243], a[104:107], v[56:59]
    ds_read_b64_tr_b16 a[124:125], v187 offset:256
    ds_read_b64_tr_b16 a[126:127], v187 offset:8448
    v_cvt_pk_bf16_f32 v134, v35, v39
    v_mfma_f32_16x16x32_bf16 v[56:59], v[248:251], a[108:111], v[56:59]
    v_cvt_pk_bf16_f32 v135, v43, v47
    ds_write_b64 v228, v[134:135] offset:128
    ds_read_b64_tr_b16 v[144:145], v229
    v_mfma_f32_16x16x32_bf16 v[120:123], v[172:175], a[96:99], v[120:123]
    ds_read_b64_tr_b16 v[146:147], v230 offset:256
    ds_read_b64_tr_b16 v[148:149], v229 offset:1024
    ds_read_b64_tr_b16 v[150:151], v230 offset:1280
    v_mfma_f32_16x16x32_bf16 v[120:123], v[164:167], a[100:103], v[120:123]
    v_mul_f32 v96, v96, v204
    v_mul_f32 v97, v97, v205
    v_mul_f32 v100, v100, v204
    v_mfma_f32_16x16x32_bf16 v[120:123], v[244:247], a[104:107], v[120:123]
    v_mul_f32 v101, v101, v205
    v_mul_f32 v104, v104, v204
    v_mul_f32 v105, v105, v205
    v_mfma_f32_16x16x32_bf16 v[120:123], v[252:255], a[108:111], v[120:123]
    v_mul_f32 v108, v108, v204
    v_mul_f32 v109, v109, v205
    v_cvt_pk_bf16_f32 v136, v96, v100
    s_waitcnt lgkmcnt(5)
    v_mfma_f32_16x16x32_bf16 v[60:63], v[168:171], a[112:115], v[60:63]
    v_cvt_pk_bf16_f32 v137, v104, v108
    s_waitcnt lgkmcnt(2)
    buffer_store_dwordx4 v[144:147], v231, s[36:39], s84 offen offset:256 nt
    v_mfma_f32_16x16x32_bf16 v[60:63], v[160:163], a[116:119], v[60:63]
    s_waitcnt lgkmcnt(0)
    buffer_store_dwordx4 v[148:151], v231, s[36:39], s85 offen offset:256 nt
    ds_write_b64 v227, v[136:137] offset:2048
    v_mfma_f32_16x16x32_bf16 v[60:63], v[240:243], a[120:123], v[60:63]
    v_cvt_pk_bf16_f32 v138, v97, v101
    v_cvt_pk_bf16_f32 v139, v105, v109
    ds_write_b64 v228, v[138:139] offset:2048
    v_mfma_f32_16x16x32_bf16 v[60:63], v[248:251], a[124:127], v[60:63]
    v_mul_f32 v98, v98, v206
    v_mul_f32 v99, v99, v207
    v_mul_f32 v102, v102, v206
    v_mfma_f32_16x16x32_bf16 v[124:127], v[172:175], a[112:115], v[124:127]
    v_mul_f32 v103, v103, v207
    v_mul_f32 v106, v106, v206
    v_mul_f32 v107, v107, v207
    v_mfma_f32_16x16x32_bf16 v[124:127], v[164:167], a[116:119], v[124:127]
    v_mul_f32 v110, v110, v206
    v_mul_f32 v111, v111, v207
    v_cvt_pk_bf16_f32 v140, v98, v102
    v_mfma_f32_16x16x32_bf16 v[124:127], v[244:247], a[120:123], v[124:127]
    v_cvt_pk_bf16_f32 v141, v106, v110
    ds_write_b64 v227, v[140:141] offset:2176
    v_cvt_pk_bf16_f32 v142, v99, v103
    v_mfma_f32_16x16x32_bf16 v[124:127], v[252:255], a[124:127], v[124:127]
    v_cvt_pk_bf16_f32 v143, v107, v111
    ds_write_b64 v228, v[142:143] offset:2176
    ds_read_b64_tr_b16 v[152:153], v229 offset:2048
    ds_read_b64_tr_b16 v[154:155], v230 offset:2304
    ds_read_b64_tr_b16 v[156:157], v229 offset:3072
    ds_read_b64_tr_b16 v[158:159], v230 offset:3328
    s_waitcnt lgkmcnt(2)
    buffer_store_dwordx4 v[152:155], v231, s[36:39], s86 offen offset:256 nt
    s_waitcnt lgkmcnt(0)
    buffer_store_dwordx4 v[156:159], v231, s[36:39], s87 offen offset:256 nt
    s_nop 7
    v_pk_mul_f32 v[48:49], v[48:49], v[200:201]
    v_pk_mul_f32 v[52:53], v[52:53], v[200:201]
    v_pk_mul_f32 v[56:57], v[56:57], v[200:201]
    v_pk_mul_f32 v[60:61], v[60:61], v[200:201]
    v_cvt_pk_bf16_f32 v128, v48, v52
    v_cvt_pk_bf16_f32 v129, v56, v60
    ds_write_b64 v227, v[128:129] offset:4096
    v_cvt_pk_bf16_f32 v130, v49, v53
    v_cvt_pk_bf16_f32 v131, v57, v61
    ds_write_b64 v228, v[130:131] offset:4096
    v_pk_mul_f32 v[50:51], v[50:51], v[202:203]
    v_pk_mul_f32 v[54:55], v[54:55], v[202:203]
    v_pk_mul_f32 v[58:59], v[58:59], v[202:203]
    v_pk_mul_f32 v[62:63], v[62:63], v[202:203]
    v_cvt_pk_bf16_f32 v132, v50, v54
    v_cvt_pk_bf16_f32 v133, v58, v62
    ds_write_b64 v227, v[132:133] offset:4224
    v_cvt_pk_bf16_f32 v134, v51, v55
    v_cvt_pk_bf16_f32 v135, v59, v63
    ds_write_b64 v228, v[134:135] offset:4224
    ds_read_b64_tr_b16 v[144:145], v229 offset:4096
    ds_read_b64_tr_b16 v[146:147], v230 offset:4352
    ds_read_b64_tr_b16 v[148:149], v229 offset:5120
    ds_read_b64_tr_b16 v[150:151], v230 offset:5376
    v_pk_mul_f32 v[112:113], v[112:113], v[204:205]
    v_pk_mul_f32 v[116:117], v[116:117], v[204:205]
    v_pk_mul_f32 v[120:121], v[120:121], v[204:205]
    v_pk_mul_f32 v[124:125], v[124:125], v[204:205]
    v_cvt_pk_bf16_f32 v136, v112, v116
    v_cvt_pk_bf16_f32 v137, v120, v124
    ds_write_b64 v227, v[136:137] offset:6144
    v_cvt_pk_bf16_f32 v138, v113, v117
    v_cvt_pk_bf16_f32 v139, v121, v125
    ds_write_b64 v228, v[138:139] offset:6144
    s_waitcnt lgkmcnt(4)
    buffer_store_dwordx4 v[144:147], v231, s[36:39], s84 offen offset:384 nt
    s_waitcnt lgkmcnt(2)
    buffer_store_dwordx4 v[148:151], v231, s[36:39], s85 offen offset:384 nt
    v_pk_mul_f32 v[114:115], v[114:115], v[206:207]
    v_pk_mul_f32 v[118:119], v[118:119], v[206:207]
    v_pk_mul_f32 v[122:123], v[122:123], v[206:207]
    v_pk_mul_f32 v[126:127], v[126:127], v[206:207]
    v_cvt_pk_bf16_f32 v140, v114, v118
    v_cvt_pk_bf16_f32 v141, v122, v126
    ds_write_b64 v227, v[140:141] offset:6272
    v_cvt_pk_bf16_f32 v142, v115, v119
    v_cvt_pk_bf16_f32 v143, v123, v127
    ds_write_b64 v228, v[142:143] offset:6272
    ds_read_b64_tr_b16 v[152:153], v229 offset:6144
    ds_read_b64_tr_b16 v[154:155], v230 offset:6400
    ds_read_b64_tr_b16 v[156:157], v229 offset:7168
    ds_read_b64_tr_b16 v[158:159], v230 offset:7424
    s_waitcnt lgkmcnt(2)
    buffer_store_dwordx4 v[152:155], v231, s[36:39], s86 offen offset:384 nt
    s_waitcnt lgkmcnt(0)
    buffer_store_dwordx4 v[156:159], v231, s[36:39], s87 offen offset:384 nt
    s_endpgm
    .p2align 6
L_fin2:
    v_readlane_b32 s51, v196, s46
    s_waitcnt vmcnt(8) lgkmcnt(0)
    s_barrier
    ds_read_b128 a[64:67], v176
    ds_read_b128 a[68:71], v177
    ds_read_b128 a[72:75], v178
    ds_read_b128 a[76:79], v179
    ds_read_b128 a[80:83], v176 offset:256
    ds_read_b128 a[84:87], v177 offset:256
    ds_read_b128 a[88:91], v178 offset:256
    ds_read_b128 a[92:95], v179 offset:256
    v_exp_f32 v208, v144
    v_exp_f32 v209, v145
    v_exp_f32 v210, v146
    v_cvt_pk_bf16_f32 v168, v208, v209
    s_waitcnt lgkmcnt(7)
    v_mfma_f32_16x16x32_bf16 v[128:131], a[64:67], a[0:3], v[232:235]
    ds_read_b128 a[96:99], v176 offset:8192
    ds_read_b128 a[100:103], v177 offset:8192
    s_waitcnt lgkmcnt(8)
    v_mfma_f32_16x16x32_bf16 v[128:131], a[68:71], a[4:7], v[128:131]
    ds_read_b128 a[104:107], v178 offset:8192
    ds_read_b128 a[108:111], v179 offset:8192
    s_waitcnt lgkmcnt(9)
    v_mfma_f32_16x16x32_bf16 v[128:131], a[72:75], a[8:11], v[128:131]
    ds_read_b128 a[112:115], v176 offset:8448
    ds_read_b128 a[116:119], v177 offset:8448
    s_waitcnt lgkmcnt(10)
    v_mfma_f32_16x16x32_bf16 v[128:131], a[76:79], a[12:15], v[128:131]
    ds_read_b128 a[120:123], v178 offset:8448
    ds_read_b128 a[124:127], v179 offset:8448
    s_waitcnt lgkmcnt(8)
    v_mfma_f32_16x16x32_bf16 v[128:131], a[80:83], a[16:19], v[128:131]
    s_mov_b32 m0, s65
    s_nop 0
    v_mfma_f32_16x16x32_bf16 v[128:131], a[84:87], a[20:23], v[128:131]
    buffer_load_dwordx4 v192, s[28:31], s51 offen lds
    v_mfma_f32_16x16x32_bf16 v[128:131], a[88:91], a[24:27], v[128:131]
    v_exp_f32 v211, v147
    v_mfma_f32_16x16x32_bf16 v[128:131], a[92:95], a[28:31], v[128:131]
    v_exp_f32 v212, v152
    v_cvt_pk_bf16_f32 v169, v210, v211
    v_mfma_f32_16x16x32_bf16 v[132:135], a[64:67], a[32:35], v[236:239]
    v_exp_f32 v213, v153
    v_mfma_f32_16x16x32_bf16 v[132:135], a[68:71], a[36:39], v[132:135]
    buffer_load_dwordx4 v193, s[28:31], s51 offen offset:1024 lds
    v_mfma_f32_16x16x32_bf16 v[132:135], a[72:75], a[40:43], v[132:135]
    v_exp_f32 v214, v154
    v_cvt_pk_bf16_f32 v170, v212, v213
    v_mfma_f32_16x16x32_bf16 v[132:135], a[76:79], a[44:47], v[132:135]
    v_exp_f32 v215, v155
    v_mfma_f32_16x16x32_bf16 v[132:135], a[80:83], a[48:51], v[132:135]
    v_exp_f32 v208, v148
    v_cvt_pk_bf16_f32 v171, v214, v215
    v_mfma_f32_16x16x32_bf16 v[132:135], a[84:87], a[52:55], v[132:135]
    buffer_load_dwordx4 v194, s[28:31], s51 offen offset:2048 lds
    v_or3_b32 v197, v168, v169, v170
    v_mfma_f32_16x16x32_bf16 v[132:135], a[88:91], a[56:59], v[132:135]
    v_exp_f32 v209, v149
    v_mfma_f32_16x16x32_bf16 v[132:135], a[92:95], a[60:63], v[132:135]
    v_exp_f32 v210, v150
    v_cvt_pk_bf16_f32 v172, v208, v209
    s_waitcnt lgkmcnt(0)
    v_mfma_f32_16x16x32_bf16 v[136:139], a[96:99], a[0:3], v[232:235]
    v_exp_f32 v211, v151
    v_mfma_f32_16x16x32_bf16 v[136:139], a[100:103], a[4:7], v[136:139]
    ds_read_b128 a[64:67], v176 offset:16384
    ds_read_b128 a[68:71], v177 offset:16384
    buffer_load_dwordx4 v195, s[28:31], s51 offen offset:3072 lds
    v_mfma_f32_16x16x32_bf16 v[136:139], a[104:107], a[8:11], v[136:139]
    ds_read_b128 a[72:75], v178 offset:16384
    ds_read_b128 a[76:79], v179 offset:16384
    v_mfma_f32_16x16x32_bf16 v[136:139], a[108:111], a[12:15], v[136:139]
    ds_read_b128 a[80:83], v176 offset:16640
    ds_read_b128 a[84:87], v177 offset:16640
    v_mfma_f32_16x16x32_bf16 v[136:139], a[112:115], a[16:19], v[136:139]
    ds_read_b128 a[88:91], v178 offset:16640
    ds_read_b128 a[92:95], v179 offset:16640
    v_mfma_f32_16x16x32_bf16 v[136:139], a[116:119], a[20:23], v[136:139]
    v_exp_f32 v212, v156
    v_cvt_pk_bf16_f32 v173, v210, v211
    v_mfma_f32_16x16x32_bf16 v[136:139], a[120:123], a[24:27], v[136:139]
    v_or3_b32 v197, v197, v171, v172
    v_exp_f32 v213, v157
    v_mfma_f32_16x16x32_bf16 v[136:139], a[124:127], a[28:31], v[136:139]
    v_exp_f32 v214, v158
    v_cvt_pk_bf16_f32 v174, v212, v213
    v_mfma_f32_16x16x32_bf16 v[140:143], a[96:99], a[32:35], v[236:239]
    v_exp_f32 v215, v159
    v_or3_b32 v197, v197, v173, v174
    v_mfma_f32_16x16x32_bf16 v[140:143], a[100:103], a[36:39], v[140:143]
    v_cvt_pk_bf16_f32 v175, v214, v215
    v_or_b32 v197, v197, v175
    v_and_b32 v197, s48, v197
    v_mfma_f32_16x16x32_bf16 v[140:143], a[104:107], a[40:43], v[140:143]
    v_cmp_ne_u32 vcc, 0, v197
    v_mfma_f32_16x16x32_bf16 v[140:143], a[108:111], a[44:47], v[140:143]
    v_mfma_f32_16x16x32_bf16 v[140:143], a[112:115], a[48:51], v[140:143]
    v_mfma_f32_16x16x32_bf16 v[140:143], a[116:119], a[52:55], v[140:143]
    v_mfma_f32_16x16x32_bf16 v[140:143], a[120:123], a[56:59], v[140:143]
    v_mfma_f32_16x16x32_bf16 v[140:143], a[124:127], a[60:63], v[140:143]
    s_add_u32 s54, s46, -1
    s_cmp_lt_u32 s54, s45
    s_cbranch_scc1 L_fok2_1
    v_mov_b32 v168, 0
    v_mov_b32 v169, 0
    v_mov_b32 v170, 0
    v_mov_b32 v171, 0
    v_mov_b32 v172, 0
    v_mov_b32 v173, 0
    v_mov_b32 v174, 0
    v_mov_b32 v175, 0
    s_branch L_fback2_1
L_fok2_1:
    s_cbranch_vccnz L_frare2_1
L_fback2_1:
    s_waitcnt lgkmcnt(0)
    v_mfma_f32_16x16x32_bf16 v[144:147], a[64:67], a[0:3], v[232:235]
    ds_read_b128 a[96:99], v176 offset:24576
    ds_read_b128 a[100:103], v177 offset:24576
    s_lshl_b32 s56, s49, 13
    v_mfma_f32_16x16x32_bf16 v[144:147], a[68:71], a[4:7], v[144:147]
    ds_read_b128 a[104:107], v178 offset:24576
    ds_read_b128 a[108:111], v179 offset:24576
    s_add_u32 s56, s56, 131072
    v_mfma_f32_16x16x32_bf16 v[144:147], a[72:75], a[8:11], v[144:147]
    ds_read_b128 a[112:115], v176 offset:24832
    ds_read_b128 a[116:119], v177 offset:24832
    v_and_b32 v227, 3, v216
    v_mfma_f32_16x16x32_bf16 v[144:147], a[76:79], a[12:15], v[144:147]
    ds_read_b128 a[120:123], v178 offset:24832
    ds_read_b128 a[124:127], v179 offset:24832
    v_bfe_u32 v198, v216, 3, 1
    v_mfma_f32_16x16x32_bf16 v[144:147], a[80:83], a[16:19], v[144:147]
    v_exp_f32 v208, v128
    v_lshl_add_u32 v227, v198, 2, v227
    v_mfma_f32_16x16x32_bf16 v[144:147], a[84:87], a[20:23], v[144:147]
    v_exp_f32 v209, v129
    v_lshrrev_b32 v198, 4, v216
    v_mfma_f32_16x16x32_bf16 v[144:147], a[88:91], a[24:27], v[144:147]
    v_exp_f32 v210, v130
    v_cvt_pk_bf16_f32 v240, v208, v209
    v_mfma_f32_16x16x32_bf16 v[144:147], a[92:95], a[28:31], v[144:147]
    v_exp_f32 v211, v131
    v_lshl_add_u32 v227, v198, 6, v227
    v_mfma_f32_16x16x32_bf16 v[148:151], a[64:67], a[32:35], v[236:239]
    v_exp_f32 v212, v136
    v_cvt_pk_bf16_f32 v241, v210, v211
    v_mfma_f32_16x16x32_bf16 v[148:151], a[68:71], a[36:39], v[148:151]
    v_exp_f32 v213, v137
    v_bfe_u32 v198, v216, 2, 1
    v_mfma_f32_16x16x32_bf16 v[148:151], a[72:75], a[40:43], v[148:151]
    v_exp_f32 v214, v138
    v_cvt_pk_bf16_f32 v242, v212, v213
    v_mfma_f32_16x16x32_bf16 v[148:151], a[76:79], a[44:47], v[148:151]
    v_exp_f32 v215, v139
    v_lshl_add_u32 v227, v198, 5, v227
    v_mfma_f32_16x16x32_bf16 v[148:151], a[80:83], a[48:51], v[148:151]
    v_exp_f32 v208, v132
    v_cvt_pk_bf16_f32 v243, v214, v215
    v_mfma_f32_16x16x32_bf16 v[148:151], a[84:87], a[52:55], v[148:151]
    v_or3_b32 v197, v240, v241, v242
    v_exp_f32 v209, v133
    v_mfma_f32_16x16x32_bf16 v[148:151], a[88:91], a[56:59], v[148:151]
    v_exp_f32 v210, v134
    v_cvt_pk_bf16_f32 v244, v208, v209
    v_mfma_f32_16x16x32_bf16 v[148:151], a[92:95], a[60:63], v[148:151]
    v_exp_f32 v211, v135
    v_lshl_add_u32 v227, v198, 3, v227
    s_waitcnt lgkmcnt(0)
    v_mfma_f32_16x16x32_bf16 v[152:155], a[96:99], a[0:3], v[232:235]
    v_exp_f32 v212, v140
    v_cvt_pk_bf16_f32 v245, v210, v211
    v_mfma_f32_16x16x32_bf16 v[152:155], a[100:103], a[4:7], v[152:155]
    v_or3_b32 v197, v197, v243, v244
    v_exp_f32 v213, v141
    v_mfma_f32_16x16x32_bf16 v[152:155], a[104:107], a[8:11], v[152:155]
    v_exp_f32 v214, v142
    v_cvt_pk_bf16_f32 v246, v212, v213
    v_mfma_f32_16x16x32_bf16 v[152:155], a[108:111], a[12:15], v[152:155]
    v_exp_f32 v215, v143
    v_or3_b32 v197, v197, v245, v246
    v_mfma_f32_16x16x32_bf16 v[152:155], a[112:115], a[16:19], v[152:155]
    v_cvt_pk_bf16_f32 v247, v214, v215
    v_or_b32 v197, v197, v247
    v_and_b32 v197, s48, v197
    v_mfma_f32_16x16x32_bf16 v[152:155], a[116:119], a[20:23], v[152:155]
    v_cmp_ne_u32 vcc, 0, v197
    v_xor_b32 v228, 8, v227
    v_lshl_add_u32 v227, v227, 3, s56
    v_mfma_f32_16x16x32_bf16 v[152:155], a[120:123], a[24:27], v[152:155]
    v_lshl_add_u32 v228, v228, 3, s56
    v_bfe_u32 v229, v216, 2, 2
    v_and_b32 v198, 3, v216
    v_mfma_f32_16x16x32_bf16 v[152:155], a[124:127], a[28:31], v[152:155]
    v_lshl_add_u32 v229, v198, 2, v229
    v_bfe_u32 v198, v216, 4, 1
    v_lshl_add_u32 v229, v198, 4, v229
    v_mfma_f32_16x16x32_bf16 v[156:159], a[96:99], a[32:35], v[236:239]
    v_bfe_u32 v198, v216, 5, 1
    v_lshl_add_u32 v229, v198, 6, v229
    v_xor_b32 v230, 8, v229
    v_mfma_f32_16x16x32_bf16 v[156:159], a[100:103], a[36:39], v[156:159]
    v_lshl_add_u32 v229, v229, 3, s56
    v_lshl_add_u32 v230, v230, 3, s56
    v_lshrrev_b32 v198, 3, v216
    v_mfma_f32_16x16x32_bf16 v[156:159], a[104:107], a[40:43], v[156:159]
    v_lshlrev_b32 v198, 9, v198
    v_and_b32 v199, 7, v216
    v_lshl_add_u32 v231, v199, 4, v198
    v_mfma_f32_16x16x32_bf16 v[156:159], a[108:111], a[44:47], v[156:159]
    s_add_u32 s84, s58, 0
    s_add_u32 s85, s58, 4096
    s_add_u32 s86, s58, 8192
    v_mfma_f32_16x16x32_bf16 v[156:159], a[112:115], a[48:51], v[156:159]
    s_add_u32 s87, s58, 12288
    v_mfma_f32_16x16x32_bf16 v[156:159], a[116:119], a[52:55], v[156:159]
    v_mfma_f32_16x16x32_bf16 v[156:159], a[120:123], a[56:59], v[156:159]
    v_mfma_f32_16x16x32_bf16 v[156:159], a[124:127], a[60:63], v[156:159]
    s_mov_b32 s54, s46
    s_cmp_lt_u32 s54, s45
    s_cbranch_scc1 L_fok2_2
    v_mov_b32 v240, 0
    v_mov_b32 v241, 0
    v_mov_b32 v242, 0
    v_mov_b32 v243, 0
    v_mov_b32 v244, 0
    v_mov_b32 v245, 0
    v_mov_b32 v246, 0
    v_mov_b32 v247, 0
    s_branch L_fback2_2
L_fok2_2:
    s_cbranch_vccnz L_frare2_2
L_fback2_2:
    s_waitcnt vmcnt(0)
    s_barrier
    ds_read_b64_tr_b16 a[64:65], v180 offset:32768
    ds_read_b64_tr_b16 a[66:67], v180 offset:40960
    ds_read_b64_tr_b16 a[68:69], v180 offset:49152
    ds_read_b64_tr_b16 a[70:71], v180 offset:57344
    ds_read_b64_tr_b16 a[72:73], v180
    ds_read_b64_tr_b16 a[74:75], v180 offset:8192
    ds_read_b64_tr_b16 a[76:77], v180 offset:16384
    ds_read_b64_tr_b16 a[78:79], v180 offset:24576
    ds_read_b64_tr_b16 a[80:81], v181 offset:32768
    ds_read_b64_tr_b16 a[82:83], v181 offset:40960
    ds_read_b64_tr_b16 a[84:85], v181 offset:49152
    ds_read_b64_tr_b16 a[86:87], v181 offset:57344
    v_mfma_f32_16x16x32_bf16 v[200:203], v[160:163], a[128:131], v[200:203]
    v_mfma_f32_16x16x32_bf16 v[200:203], v[168:171], a[128:131], v[200:203]
    v_exp_f32 v208, v144
    v_exp_f32 v209, v145
    v_mfma_f32_16x16x32_bf16 v[200:203], v[240:243], a[128:131], v[200:203]
    v_exp_f32 v210, v146
    v_cvt_pk_bf16_f32 v248, v208, v209
    v_mfma_f32_16x16x32_bf16 v[204:207], v[164:167], a[128:131], v[204:207]
    v_exp_f32 v211, v147
    v_exp_f32 v212, v152
    v_mfma_f32_16x16x32_bf16 v[204:207], v[172:175], a[128:131], v[204:207]
    v_cvt_pk_bf16_f32 v249, v210, v211
    v_exp_f32 v213, v153
    v_mfma_f32_16x16x32_bf16 v[204:207], v[244:247], a[128:131], v[204:207]
    v_exp_f32 v214, v154
    v_cvt_pk_bf16_f32 v250, v212, v213
    v_exp_f32 v215, v155
    v_exp_f32 v208, v148
    v_cvt_pk_bf16_f32 v251, v214, v215
    v_or3_b32 v197, v248, v249, v250
    v_exp_f32 v209, v149
    v_exp_f32 v210, v150
    v_cvt_pk_bf16_f32 v252, v208, v209
    v_exp_f32 v211, v151
    v_exp_f32 v212, v156
    v_cvt_pk_bf16_f32 v253, v210, v211
    v_or3_b32 v197, v197, v251, v252
    v_exp_f32 v213, v157
    v_exp_f32 v214, v158
    v_cvt_pk_bf16_f32 v254, v212, v213
    v_exp_f32 v215, v159
    v_or3_b32 v197, v197, v253, v254
    v_cvt_pk_bf16_f32 v255, v214, v215
    v_or_b32 v197, v197, v255
    v_and_b32 v197, s48, v197
    v_cmp_ne_u32 vcc, 0, v197
    s_add_u32 s54, s46, 1
    s_cmp_lt_u32 s54, s45
    s_cbranch_scc1 L_fok2_3
    v_mov_b32 v248, 0
    v_mov_b32 v249, 0
    v_mov_b32 v250, 0
    v_mov_b32 v251, 0
    v_mov_b32 v252, 0
    v_mov_b32 v253, 0
    v_mov_b32 v254, 0
    v_mov_b32 v255, 0
    s_branch L_fback2_3
L_fok2_3:
    s_cbranch_vccnz L_frare2_3
L_fback2_3:
    s_nop 7
    v_mfma_f32_16x16x32_bf16 v[200:203], v[248:251], a[128:131], v[200:203]
    v_mfma_f32_16x16x32_bf16 v[204:207], v[252:255], a[128:131], v[204:207]
    s_waitcnt lgkmcnt(0)
    v_mfma_f32_16x16x32_bf16 v[0:3], v[160:163], a[64:67], v[0:3]
    ds_read_b64_tr_b16 a[88:89], v181
    ds_read_b64_tr_b16 a[90:91], v181 offset:8192
    v_mfma_f32_16x16x32_bf16 v[0:3], v[168:171], a[68:71], v[0:3]
    v_mfma_f32_16x16x32_bf16 v[0:3], v[240:243], a[72:75], v[0:3]
    ds_read_b64_tr_b16 a[92:93], v181 offset:16384
    ds_read_b64_tr_b16 a[94:95], v181 offset:24576
    v_mfma_f32_16x16x32_bf16 v[0:3], v[248:251], a[76:79], v[0:3]
    v_mfma_f32_16x16x32_bf16 v[64:67], v[164:167], a[64:67], v[64:67]
    ds_read_b64_tr_b16 a[96:97], v182 offset:32768
    ds_read_b64_tr_b16 a[98:99], v182 offset:40960
    v_mfma_f32_16x16x32_bf16 v[64:67], v[172:175], a[68:71], v[64:67]
    v_rcp_f32 v200, v200
    v_mfma_f32_16x16x32_bf16 v[64:67], v[244:247], a[72:75], v[64:67]
    ds_read_b64_tr_b16 a[100:101], v182 offset:49152
    ds_read_b64_tr_b16 a[102:103], v182 offset:57344
    v_mfma_f32_16x16x32_bf16 v[64:67], v[252:255], a[76:79], v[64:67]
    v_rcp_f32 v201, v201
    v_mfma_f32_16x16x32_bf16 v[4:7], v[160:163], a[80:83], v[4:7]
    ds_read_b64_tr_b16 a[104:105], v182
    ds_read_b64_tr_b16 a[106:107], v182 offset:8192
    v_mfma_f32_16x16x32_bf16 v[4:7], v[168:171], a[84:87], v[4:7]
    v_rcp_f32 v202, v202
    s_waitcnt lgkmcnt(8)
    v_mfma_f32_16x16x32_bf16 v[4:7], v[240:243], a[88:91], v[4:7]
    ds_read_b64_tr_b16 a[108:109], v182 offset:16384
    ds_read_b64_tr_b16 a[110:111], v182 offset:24576
    s_waitcnt lgkmcnt(8)
    v_mfma_f32_16x16x32_bf16 v[4:7], v[248:251], a[92:95], v[4:7]
    v_rcp_f32 v203, v203
    v_mfma_f32_16x16x32_bf16 v[68:71], v[164:167], a[80:83], v[68:71]
    ds_read_b64_tr_b16 a[112:113], v183 offset:32768
    ds_read_b64_tr_b16 a[114:115], v183 offset:40960
    v_mfma_f32_16x16x32_bf16 v[68:71], v[172:175], a[84:87], v[68:71]
    v_rcp_f32 v204, v204
    v_mfma_f32_16x16x32_bf16 v[68:71], v[244:247], a[88:91], v[68:71]
    ds_read_b64_tr_b16 a[116:117], v183 offset:49152
    ds_read_b64_tr_b16 a[118:119], v183 offset:57344
    v_mfma_f32_16x16x32_bf16 v[68:71], v[252:255], a[92:95], v[68:71]
    v_rcp_f32 v205, v205
    s_waitcnt lgkmcnt(7)
    v_mfma_f32_16x16x32_bf16 v[8:11], v[160:163], a[96:99], v[8:11]
    ds_read_b64_tr_b16 a[120:121], v183
    ds_read_b64_tr_b16 a[122:123], v183 offset:8192
    v_mfma_f32_16x16x32_bf16 v[8:11], v[168:171], a[100:103], v[8:11]
    v_rcp_f32 v206, v206
    s_waitcnt lgkmcnt(7)
    v_mfma_f32_16x16x32_bf16 v[8:11], v[240:243], a[104:107], v[8:11]
    ds_read_b64_tr_b16 a[124:125], v183 offset:16384
    ds_read_b64_tr_b16 a[126:127], v183 offset:24576
    s_waitcnt lgkmcnt(8)
    v_mfma_f32_16x16x32_bf16 v[8:11], v[248:251], a[108:111], v[8:11]
    v_rcp_f32 v207, v207
    v_mfma_f32_16x16x32_bf16 v[72:75], v[164:167], a[96:99], v[72:75]
    ds_read_b64_tr_b16 a[64:65], v184 offset:32768
    ds_read_b64_tr_b16 a[66:67], v184 offset:40960
    v_mfma_f32_16x16x32_bf16 v[72:75], v[172:175], a[100:103], v[72:75]
    v_mfma_f32_16x16x32_bf16 v[72:75], v[244:247], a[104:107], v[72:75]
    ds_read_b64_tr_b16 a[68:69], v184 offset:49152
    ds_read_b64_tr_b16 a[70:71], v184 offset:57344
    v_mfma_f32_16x16x32_bf16 v[72:75], v[252:255], a[108:111], v[72:75]
    s_waitcnt lgkmcnt(8)
    v_mfma_f32_16x16x32_bf16 v[12:15], v[160:163], a[112:115], v[12:15]
    ds_read_b64_tr_b16 a[72:73], v184
    ds_read_b64_tr_b16 a[74:75], v184 offset:8192
    v_mfma_f32_16x16x32_bf16 v[12:15], v[168:171], a[116:119], v[12:15]
    s_waitcnt lgkmcnt(8)
    v_mfma_f32_16x16x32_bf16 v[12:15], v[240:243], a[120:123], v[12:15]
    ds_read_b64_tr_b16 a[76:77], v184 offset:16384
    ds_read_b64_tr_b16 a[78:79], v184 offset:24576
    s_waitcnt lgkmcnt(8)
    v_mfma_f32_16x16x32_bf16 v[12:15], v[248:251], a[124:127], v[12:15]
    v_mfma_f32_16x16x32_bf16 v[76:79], v[164:167], a[112:115], v[76:79]
    ds_read_b64_tr_b16 a[80:81], v185 offset:32768
    ds_read_b64_tr_b16 a[82:83], v185 offset:40960
    v_mfma_f32_16x16x32_bf16 v[76:79], v[172:175], a[116:119], v[76:79]
    v_mfma_f32_16x16x32_bf16 v[76:79], v[244:247], a[120:123], v[76:79]
    ds_read_b64_tr_b16 a[84:85], v185 offset:49152
    ds_read_b64_tr_b16 a[86:87], v185 offset:57344
    v_mfma_f32_16x16x32_bf16 v[76:79], v[252:255], a[124:127], v[76:79]
    s_waitcnt lgkmcnt(8)
    v_mfma_f32_16x16x32_bf16 v[16:19], v[160:163], a[64:67], v[16:19]
    ds_read_b64_tr_b16 a[88:89], v185
    ds_read_b64_tr_b16 a[90:91], v185 offset:8192
    v_mfma_f32_16x16x32_bf16 v[16:19], v[168:171], a[68:71], v[16:19]
    s_waitcnt lgkmcnt(8)
    v_mfma_f32_16x16x32_bf16 v[16:19], v[240:243], a[72:75], v[16:19]
    ds_read_b64_tr_b16 a[92:93], v185 offset:16384
    ds_read_b64_tr_b16 a[94:95], v185 offset:24576
    s_waitcnt lgkmcnt(8)
    v_mfma_f32_16x16x32_bf16 v[16:19], v[248:251], a[76:79], v[16:19]
    v_mul_f32 v0, v0, v200
    v_mul_f32 v1, v1, v201
    v_mul_f32 v4, v4, v200
    v_mfma_f32_16x16x32_bf16 v[80:83], v[164:167], a[64:67], v[80:83]
    ds_read_b64_tr_b16 a[96:97], v186 offset:32768
    ds_read_b64_tr_b16 a[98:99], v186 offset:40960
    v_mul_f32 v5, v5, v201
    v_mfma_f32_16x16x32_bf16 v[80:83], v[172:175], a[68:71], v[80:83]
    v_mul_f32 v8, v8, v200
    v_mul_f32 v9, v9, v201
    v_mul_f32 v12, v12, v200
    v_mfma_f32_16x16x32_bf16 v[80:83], v[244:247], a[72:75], v[80:83]
    ds_read_b64_tr_b16 a[100:101], v186 offset:49152
    ds_read_b64_tr_b16 a[102:103], v186 offset:57344
    v_mul_f32 v13, v13, v201
    v_mfma_f32_16x16x32_bf16 v[80:83], v[252:255], a[76:79], v[80:83]
    v_cvt_pk_bf16_f32 v128, v0, v4
    v_cvt_pk_bf16_f32 v129, v8, v12
    ds_write_b64 v227, v[128:129]
    s_waitcnt lgkmcnt(5)
    v_mfma_f32_16x16x32_bf16 v[20:23], v[160:163], a[80:83], v[20:23]
    ds_read_b64_tr_b16 a[104:105], v186
    ds_read_b64_tr_b16 a[106:107], v186 offset:8192
    v_cvt_pk_bf16_f32 v130, v1, v5
    v_mfma_f32_16x16x32_bf16 v[20:23], v[168:171], a[84:87], v[20:23]
    v_cvt_pk_bf16_f32 v131, v9, v13
    ds_write_b64 v228, v[130:131]
    v_mul_f32 v2, v2, v202
    v_mfma_f32_16x16x32_bf16 v[20:23], v[240:243], a[88:91], v[20:23]
    ds_read_b64_tr_b16 a[108:109], v186 offset:16384
    ds_read_b64_tr_b16 a[110:111], v186 offset:24576
    v_mul_f32 v3, v3, v203
    v_mfma_f32_16x16x32_bf16 v[20:23], v[248:251], a[92:95], v[20:23]
    v_mul_f32 v6, v6, v202
    v_mul_f32 v7, v7, v203
    v_mul_f32 v10, v10, v202
    v_mfma_f32_16x16x32_bf16 v[84:87], v[164:167], a[80:83], v[84:87]
    ds_read_b64_tr_b16 a[112:113], v187 offset:32768
    ds_read_b64_tr_b16 a[114:115], v187 offset:40960
    v_mul_f32 v11, v11, v203
    v_mfma_f32_16x16x32_bf16 v[84:87], v[172:175], a[84:87], v[84:87]
    v_mul_f32 v14, v14, v202
    v_mul_f32 v15, v15, v203
    v_cvt_pk_bf16_f32 v132, v2, v6
    v_mfma_f32_16x16x32_bf16 v[84:87], v[244:247], a[88:91], v[84:87]
    ds_read_b64_tr_b16 a[116:117], v187 offset:49152
    ds_read_b64_tr_b16 a[118:119], v187 offset:57344
    v_cvt_pk_bf16_f32 v133, v10, v14
    v_mfma_f32_16x16x32_bf16 v[84:87], v[252:255], a[92:95], v[84:87]
    ds_write_b64 v227, v[132:133] offset:128
    v_cvt_pk_bf16_f32 v134, v3, v7
    v_cvt_pk_bf16_f32 v135, v11, v15
    s_waitcnt lgkmcnt(5)
    v_mfma_f32_16x16x32_bf16 v[24:27], v[160:163], a[96:99], v[24:27]
    ds_read_b64_tr_b16 a[120:121], v187
    ds_read_b64_tr_b16 a[122:123], v187 offset:8192
    ds_write_b64 v228, v[134:135] offset:128
    v_mfma_f32_16x16x32_bf16 v[24:27], v[168:171], a[100:103], v[24:27]
    ds_read_b64_tr_b16 v[144:145], v229
    ds_read_b64_tr_b16 v[146:147], v230 offset:256
    ds_read_b64_tr_b16 v[148:149], v229 offset:1024
    v_mfma_f32_16x16x32_bf16 v[24:27], v[240:243], a[104:107], v[24:27]
    ds_read_b64_tr_b16 a[124:125], v187 offset:16384
    ds_read_b64_tr_b16 a[126:127], v187 offset:24576
    ds_read_b64_tr_b16 v[150:151], v230 offset:1280
    v_mfma_f32_16x16x32_bf16 v[24:27], v[248:251], a[108:111], v[24:27]
    v_mul_f32 v64, v64, v204
    v_mul_f32 v65, v65, v205
    v_mul_f32 v68, v68, v204
    v_mfma_f32_16x16x32_bf16 v[88:91], v[164:167], a[96:99], v[88:91]
    ds_read_b64_tr_b16 a[64:65], v180 offset:33024
    s_waitcnt lgkmcnt(10)
    ds_read_b64_tr_b16 a[66:67], v180 offset:41216
    v_mul_f32 v69, v69, v205
    v_mfma_f32_16x16x32_bf16 v[88:91], v[172:175], a[100:103], v[88:91]
    v_mul_f32 v72, v72, v204
    v_mul_f32 v73, v73, v205
    v_mul_f32 v76, v76, v204
    v_mfma_f32_16x16x32_bf16 v[88:91], v[244:247], a[104:107], v[88:91]
    ds_read_b64_tr_b16 a[68:69], v180 offset:49408
    ds_read_b64_tr_b16 a[70:71], v180 offset:57600
    v_mul_f32 v77, v77, v205
    v_mfma_f32_16x16x32_bf16 v[88:91], v[252:255], a[108:111], v[88:91]
    v_cvt_pk_bf16_f32 v136, v64, v68
    v_cvt_pk_bf16_f32 v137, v72, v76
    v_mfma_f32_16x16x32_bf16 v[28:31], v[160:163], a[112:115], v[28:31]
    ds_read_b64_tr_b16 a[72:73], v180 offset:256
    ds_read_b64_tr_b16 a[74:75], v180 offset:8448
    v_mfma_f32_16x16x32_bf16 v[28:31], v[168:171], a[116:119], v[28:31]
    s_waitcnt lgkmcnt(6)
    buffer_store_dwordx4 v[144:147], v231, s[36:39], s84 offen nt
    v_mfma_f32_16x16x32_bf16 v[28:31], v[240:243], a[120:123], v[28:31]
    ds_read_b64_tr_b16 a[76:77], v180 offset:16640
    ds_read_b64_tr_b16 a[78:79], v180 offset:24832
    v_mfma_f32_16x16x32_bf16 v[28:31], v[248:251], a[124:127], v[28:31]
    buffer_store_dwordx4 v[148:151], v231, s[36:39], s85 offen nt
    ds_write_b64 v227, v[136:137] offset:2048
    v_mfma_f32_16x16x32_bf16 v[92:95], v[164:167], a[112:115], v[92:95]
    ds_read_b64_tr_b16 a[80:81], v181 offset:33024
    ds_read_b64_tr_b16 a[82:83], v181 offset:41216
    v_cvt_pk_bf16_f32 v138, v65, v69
    v_mfma_f32_16x16x32_bf16 v[92:95], v[172:175], a[116:119], v[92:95]
    v_cvt_pk_bf16_f32 v139, v73, v77
    ds_write_b64 v228, v[138:139] offset:2048
    v_mul_f32 v66, v66, v206
    v_mfma_f32_16x16x32_bf16 v[92:95], v[244:247], a[120:123], v[92:95]
    ds_read_b64_tr_b16 a[84:85], v181 offset:49408
    ds_read_b64_tr_b16 a[86:87], v181 offset:57600
    v_mul_f32 v67, v67, v207
    v_mfma_f32_16x16x32_bf16 v[92:95], v[252:255], a[124:127], v[92:95]
    v_mul_f32 v70, v70, v206
    v_mul_f32 v71, v71, v207
    v_mul_f32 v74, v74, v206
    v_mul_f32 v75, v75, v207
    v_mul_f32 v78, v78, v206
    v_mul_f32 v79, v79, v207
    v_cvt_pk_bf16_f32 v140, v66, v70
    v_cvt_pk_bf16_f32 v141, v74, v78
    ds_write_b64 v227, v[140:141] offset:2176
    v_cvt_pk_bf16_f32 v142, v67, v71
    v_cvt_pk_bf16_f32 v143, v75, v79
    s_waitcnt lgkmcnt(4)
    ds_write_b64 v228, v[142:143] offset:2176
    ds_read_b64_tr_b16 v[152:153], v229 offset:2048
    ds_read_b64_tr_b16 v[154:155], v230 offset:2304
    ds_read_b64_tr_b16 v[156:157], v229 offset:3072
    ds_read_b64_tr_b16 v[158:159], v230 offset:3328
    v_mfma_f32_16x16x32_bf16 v[32:35], v[160:163], a[64:67], v[32:35]
    ds_read_b64_tr_b16 a[88:89], v181 offset:256
    ds_read_b64_tr_b16 a[90:91], v181 offset:8448
    v_mfma_f32_16x16x32_bf16 v[32:35], v[168:171], a[68:71], v[32:35]
    v_mfma_f32_16x16x32_bf16 v[32:35], v[240:243], a[72:75], v[32:35]
    ds_read_b64_tr_b16 a[92:93], v181 offset:16640
    ds_read_b64_tr_b16 a[94:95], v181 offset:24832
    v_mfma_f32_16x16x32_bf16 v[32:35], v[248:251], a[76:79], v[32:35]
    s_waitcnt lgkmcnt(6)
    buffer_store_dwordx4 v[152:155], v231, s[36:39], s86 offen nt
    v_mfma_f32_16x16x32_bf16 v[96:99], v[164:167], a[64:67], v[96:99]
    ds_read_b64_tr_b16 a[96:97], v182 offset:33024
    ds_read_b64_tr_b16 a[98:99], v182 offset:41216
    v_mfma_f32_16x16x32_bf16 v[96:99], v[172:175], a[68:71], v[96:99]
    s_waitcnt lgkmcnt(6)
    buffer_store_dwordx4 v[156:159], v231, s[36:39], s87 offen nt
    v_mul_f32 v16, v16, v200
    v_mfma_f32_16x16x32_bf16 v[96:99], v[244:247], a[72:75], v[96:99]
    ds_read_b64_tr_b16 a[100:101], v182 offset:49408
    ds_read_b64_tr_b16 a[102:103], v182 offset:57600
    v_mul_f32 v17, v17, v201
    v_mfma_f32_16x16x32_bf16 v[96:99], v[252:255], a[76:79], v[96:99]
    v_mul_f32 v20, v20, v200
    v_mul_f32 v21, v21, v201
    v_mul_f32 v24, v24, v200
    v_mfma_f32_16x16x32_bf16 v[36:39], v[160:163], a[80:83], v[36:39]
    ds_read_b64_tr_b16 a[104:105], v182 offset:256
    ds_read_b64_tr_b16 a[106:107], v182 offset:8448
    v_mul_f32 v25, v25, v201
    v_mfma_f32_16x16x32_bf16 v[36:39], v[168:171], a[84:87], v[36:39]
    v_mul_f32 v28, v28, v200
    v_mul_f32 v29, v29, v201
    v_cvt_pk_bf16_f32 v128, v16, v20
    s_waitcnt lgkmcnt(4)
    v_mfma_f32_16x16x32_bf16 v[36:39], v[240:243], a[88:91], v[36:39]
    ds_read_b64_tr_b16 a[108:109], v182 offset:16640
    ds_read_b64_tr_b16 a[110:111], v182 offset:24832
    v_cvt_pk_bf16_f32 v129, v24, v28
    v_mfma_f32_16x16x32_bf16 v[36:39], v[248:251], a[92:95], v[36:39]
    ds_write_b64 v227, v[128:129] offset:4096
    v_cvt_pk_bf16_f32 v130, v17, v21
    v_cvt_pk_bf16_f32 v131, v25, v29
    v_mfma_f32_16x16x32_bf16 v[100:103], v[164:167], a[80:83], v[100:103]
    ds_read_b64_tr_b16 a[112:113], v183 offset:33024
    ds_read_b64_tr_b16 a[114:115], v183 offset:41216
    ds_write_b64 v228, v[130:131] offset:4096
    v_mfma_f32_16x16x32_bf16 v[100:103], v[172:175], a[84:87], v[100:103]
    v_mul_f32 v18, v18, v202
    v_mul_f32 v19, v19, v203
    v_mul_f32 v22, v22, v202
    v_mfma_f32_16x16x32_bf16 v[100:103], v[244:247], a[88:91], v[100:103]
    ds_read_b64_tr_b16 a[116:117], v183 offset:49408
    ds_read_b64_tr_b16 a[118:119], v183 offset:57600
    v_mul_f32 v23, v23, v203
    v_mfma_f32_16x16x32_bf16 v[100:103], v[252:255], a[92:95], v[100:103]
    v_mul_f32 v26, v26, v202
    v_mul_f32 v27, v27, v203
    v_mul_f32 v30, v30, v202
    v_mfma_f32_16x16x32_bf16 v[40:43], v[160:163], a[96:99], v[40:43]
    ds_read_b64_tr_b16 a[120:121], v183 offset:256
    ds_read_b64_tr_b16 a[122:123], v183 offset:8448
    v_mul_f32 v31, v31, v203
    s_waitcnt lgkmcnt(7)
    v_mfma_f32_16x16x32_bf16 v[40:43], v[168:171], a[100:103], v[40:43]
    v_cvt_pk_bf16_f32 v132, v18, v22
    v_cvt_pk_bf16_f32 v133, v26, v30
    ds_write_b64 v227, v[132:133] offset:4224
    v_mfma_f32_16x16x32_bf16 v[40:43], v[240:243], a[104:107], v[40:43]
    ds_read_b64_tr_b16 a[124:125], v183 offset:16640
    ds_read_b64_tr_b16 a[126:127], v183 offset:24832
    v_cvt_pk_bf16_f32 v134, v19, v23
    v_mfma_f32_16x16x32_bf16 v[40:43], v[248:251], a[108:111], v[40:43]
    v_cvt_pk_bf16_f32 v135, v27, v31
    ds_write_b64 v228, v[134:135] offset:4224
    ds_read_b64_tr_b16 v[144:145], v229 offset:4096
    v_mfma_f32_16x16x32_bf16 v[104:107], v[164:167], a[96:99], v[104:107]
    ds_read_b64_tr_b16 a[64:65], v184 offset:33024
    ds_read_b64_tr_b16 a[66:67], v184 offset:41216
    ds_read_b64_tr_b16 v[146:147], v230 offset:4352
    v_mfma_f32_16x16x32_bf16 v[104:107], v[172:175], a[100:103], v[104:107]
    s_waitcnt lgkmcnt(9)
    ds_read_b64_tr_b16 v[148:149], v229 offset:5120
    ds_read_b64_tr_b16 v[150:151], v230 offset:5376
    v_mul_f32 v80, v80, v204
    v_mfma_f32_16x16x32_bf16 v[104:107], v[244:247], a[104:107], v[104:107]
    ds_read_b64_tr_b16 a[68:69], v184 offset:49408
    ds_read_b64_tr_b16 a[70:71], v184 offset:57600
    v_mul_f32 v81, v81, v205
    v_mfma_f32_16x16x32_bf16 v[104:107], v[252:255], a[108:111], v[104:107]
    v_mul_f32 v84, v84, v204
    v_mul_f32 v85, v85, v205
    v_mul_f32 v88, v88, v204
    v_mfma_f32_16x16x32_bf16 v[44:47], v[160:163], a[112:115], v[44:47]
    ds_read_b64_tr_b16 a[72:73], v184 offset:256
    ds_read_b64_tr_b16 a[74:75], v184 offset:8448
    v_mul_f32 v89, v89, v205
    v_mfma_f32_16x16x32_bf16 v[44:47], v[168:171], a[116:119], v[44:47]
    v_mul_f32 v92, v92, v204
    v_mul_f32 v93, v93, v205
    v_cvt_pk_bf16_f32 v136, v80, v84
    s_waitcnt lgkmcnt(6)
    v_mfma_f32_16x16x32_bf16 v[44:47], v[240:243], a[120:123], v[44:47]
    ds_read_b64_tr_b16 a[76:77], v184 offset:16640
    ds_read_b64_tr_b16 a[78:79], v184 offset:24832
    v_cvt_pk_bf16_f32 v137, v88, v92
    v_mfma_f32_16x16x32_bf16 v[44:47], v[248:251], a[124:127], v[44:47]
    buffer_store_dwordx4 v[144:147], v231, s[36:39], s84 offen offset:128 nt
    v_mfma_f32_16x16x32_bf16 v[108:111], v[164:167], a[112:115], v[108:111]
    ds_read_b64_tr_b16 a[80:81], v185 offset:33024
    ds_read_b64_tr_b16 a[82:83], v185 offset:41216
    v_mfma_f32_16x16x32_bf16 v[108:111], v[172:175], a[116:119], v[108:111]
    s_waitcnt lgkmcnt(6)
    buffer_store_dwordx4 v[148:151], v231, s[36:39], s85 offen offset:128 nt
    ds_write_b64 v227, v[136:137] offset:6144
    v_mfma_f32_16x16x32_bf16 v[108:111], v[244:247], a[120:123], v[108:111]
    ds_read_b64_tr_b16 a[84:85], v185 offset:49408
    ds_read_b64_tr_b16 a[86:87], v185 offset:57600
    v_cvt_pk_bf16_f32 v138, v81, v85
    v_mfma_f32_16x16x32_bf16 v[108:111], v[252:255], a[124:127], v[108:111]
    v_cvt_pk_bf16_f32 v139, v89, v93
    ds_write_b64 v228, v[138:139] offset:6144
    v_mul_f32 v82, v82, v206
    v_mul_f32 v83, v83, v207
    v_mul_f32 v86, v86, v206
    v_mul_f32 v87, v87, v207
    v_mul_f32 v90, v90, v206
    v_mul_f32 v91, v91, v207
    v_mul_f32 v94, v94, v206
    v_mul_f32 v95, v95, v207
    v_cvt_pk_bf16_f32 v140, v82, v86
    v_cvt_pk_bf16_f32 v141, v90, v94
    ds_write_b64 v227, v[140:141] offset:6272
    v_cvt_pk_bf16_f32 v142, v83, v87
    v_cvt_pk_bf16_f32 v143, v91, v95
    ds_write_b64 v228, v[142:143] offset:6272
    ds_read_b64_tr_b16 v[152:153], v229 offset:6144
    ds_read_b64_tr_b16 v[154:155], v230 offset:6400
    ds_read_b64_tr_b16 v[156:157], v229 offset:7168
    s_waitcnt lgkmcnt(6)
    ds_read_b64_tr_b16 v[158:159], v230 offset:7424
    v_mfma_f32_16x16x32_bf16 v[48:51], v[160:163], a[64:67], v[48:51]
    ds_read_b64_tr_b16 a[88:89], v185 offset:256
    ds_read_b64_tr_b16 a[90:91], v185 offset:8448
    v_mfma_f32_16x16x32_bf16 v[48:51], v[168:171], a[68:71], v[48:51]
    v_mfma_f32_16x16x32_bf16 v[48:51], v[240:243], a[72:75], v[48:51]
    ds_read_b64_tr_b16 a[92:93], v185 offset:16640
    ds_read_b64_tr_b16 a[94:95], v185 offset:24832
    v_mfma_f32_16x16x32_bf16 v[48:51], v[248:251], a[76:79], v[48:51]
    s_waitcnt lgkmcnt(6)
    buffer_store_dwordx4 v[152:155], v231, s[36:39], s86 offen offset:128 nt
    v_mfma_f32_16x16x32_bf16 v[112:115], v[164:167], a[64:67], v[112:115]
    ds_read_b64_tr_b16 a[96:97], v186 offset:33024
    ds_read_b64_tr_b16 a[98:99], v186 offset:41216
    v_mfma_f32_16x16x32_bf16 v[112:115], v[172:175], a[68:71], v[112:115]
    s_waitcnt lgkmcnt(6)
    buffer_store_dwordx4 v[156:159], v231, s[36:39], s87 offen offset:128 nt
    v_mul_f32 v32, v32, v200
    v_mfma_f32_16x16x32_bf16 v[112:115], v[244:247], a[72:75], v[112:115]
    ds_read_b64_tr_b16 a[100:101], v186 offset:49408
    ds_read_b64_tr_b16 a[102:103], v186 offset:57600
    v_mul_f32 v33, v33, v201
    v_mfma_f32_16x16x32_bf16 v[112:115], v[252:255], a[76:79], v[112:115]
    v_mul_f32 v36, v36, v200
    v_mul_f32 v37, v37, v201
    v_mul_f32 v40, v40, v200
    v_mfma_f32_16x16x32_bf16 v[52:55], v[160:163], a[80:83], v[52:55]
    ds_read_b64_tr_b16 a[104:105], v186 offset:256
    ds_read_b64_tr_b16 a[106:107], v186 offset:8448
    v_mul_f32 v41, v41, v201
    v_mfma_f32_16x16x32_bf16 v[52:55], v[168:171], a[84:87], v[52:55]
    v_mul_f32 v44, v44, v200
    v_mul_f32 v45, v45, v201
    v_cvt_pk_bf16_f32 v128, v32, v36
    s_waitcnt lgkmcnt(4)
    v_mfma_f32_16x16x32_bf16 v[52:55], v[240:243], a[88:91], v[52:55]
    ds_read_b64_tr_b16 a[108:109], v186 offset:16640
    ds_read_b64_tr_b16 a[110:111], v186 offset:24832
    v_cvt_pk_bf16_f32 v129, v40, v44
    v_mfma_f32_16x16x32_bf16 v[52:55], v[248:251], a[92:95], v[52:55]
    ds_write_b64 v227, v[128:129]
    v_cvt_pk_bf16_f32 v130, v33, v37
    v_cvt_pk_bf16_f32 v131, v41, v45
    v_mfma_f32_16x16x32_bf16 v[116:119], v[164:167], a[80:83], v[116:119]
    ds_read_b64_tr_b16 a[112:113], v187 offset:33024
    ds_read_b64_tr_b16 a[114:115], v187 offset:41216
    ds_write_b64 v228, v[130:131]
    v_mfma_f32_16x16x32_bf16 v[116:119], v[172:175], a[84:87], v[116:119]
    v_mul_f32 v34, v34, v202
    v_mul_f32 v35, v35, v203
    v_mul_f32 v38, v38, v202
    v_mfma_f32_16x16x32_bf16 v[116:119], v[244:247], a[88:91], v[116:119]
    ds_read_b64_tr_b16 a[116:117], v187 offset:49408
    ds_read_b64_tr_b16 a[118:119], v187 offset:57600
    v_mul_f32 v39, v39, v203
    v_mfma_f32_16x16x32_bf16 v[116:119], v[252:255], a[92:95], v[116:119]
    v_mul_f32 v42, v42, v202
    v_mul_f32 v43, v43, v203
    v_mul_f32 v46, v46, v202
    v_mfma_f32_16x16x32_bf16 v[56:59], v[160:163], a[96:99], v[56:59]
    ds_read_b64_tr_b16 a[120:121], v187 offset:256
    ds_read_b64_tr_b16 a[122:123], v187 offset:8448
    v_mul_f32 v47, v47, v203
    s_waitcnt lgkmcnt(7)
    v_mfma_f32_16x16x32_bf16 v[56:59], v[168:171], a[100:103], v[56:59]
    v_cvt_pk_bf16_f32 v132, v34, v38
    v_cvt_pk_bf16_f32 v133, v42, v46
    ds_write_b64 v227, v[132:133] offset:128
    v_mfma_f32_16x16x32_bf16 v[56:59], v[240:243], a[104:107], v[56:59]
    ds_read_b64_tr_b16 a[124:125], v187 offset:16640
    ds_read_b64_tr_b16 a[126:127], v187 offset:24832
    v_cvt_pk_bf16_f32 v134, v35, v39
    v_mfma_f32_16x16x32_bf16 v[56:59], v[248:251], a[108:111], v[56:59]
    v_cvt_pk_bf16_f32 v135, v43, v47
    ds_write_b64 v228, v[134:135] offset:128
    ds_read_b64_tr_b16 v[144:145], v229
    v_mfma_f32_16x16x32_bf16 v[120:123], v[164:167], a[96:99], v[120:123]
    ds_read_b64_tr_b16 v[146:147], v230 offset:256
    ds_read_b64_tr_b16 v[148:149], v229 offset:1024
    ds_read_b64_tr_b16 v[150:151], v230 offset:1280
    v_mfma_f32_16x16x32_bf16 v[120:123], v[172:175], a[100:103], v[120:123]
    v_mul_f32 v96, v96, v204
    v_mul_f32 v97, v97, v205
    v_mul_f32 v100, v100, v204
    v_mfma_f32_16x16x32_bf16 v[120:123], v[244:247], a[104:107], v[120:123]
    v_mul_f32 v101, v101, v205
    v_mul_f32 v104, v104, v204
    v_mul_f32 v105, v105, v205
    v_mfma_f32_16x16x32_bf16 v[120:123], v[252:255], a[108:111], v[120:123]
    v_mul_f32 v108, v108, v204
    v_mul_f32 v109, v109, v205
    v_cvt_pk_bf16_f32 v136, v96, v100
    s_waitcnt lgkmcnt(5)
    v_mfma_f32_16x16x32_bf16 v[60:63], v[160:163], a[112:115], v[60:63]
    v_cvt_pk_bf16_f32 v137, v104, v108
    s_waitcnt lgkmcnt(2)
    buffer_store_dwordx4 v[144:147], v231, s[36:39], s84 offen offset:256 nt
    v_mfma_f32_16x16x32_bf16 v[60:63], v[168:171], a[116:119], v[60:63]
    s_waitcnt lgkmcnt(0)
    buffer_store_dwordx4 v[148:151], v231, s[36:39], s85 offen offset:256 nt
    ds_write_b64 v227, v[136:137] offset:2048
    v_mfma_f32_16x16x32_bf16 v[60:63], v[240:243], a[120:123], v[60:63]
    v_cvt_pk_bf16_f32 v138, v97, v101
    v_cvt_pk_bf16_f32 v139, v105, v109
    ds_write_b64 v228, v[138:139] offset:2048
    v_mfma_f32_16x16x32_bf16 v[60:63], v[248:251], a[124:127], v[60:63]
    v_mul_f32 v98, v98, v206
    v_mul_f32 v99, v99, v207
    v_mul_f32 v102, v102, v206
    v_mfma_f32_16x16x32_bf16 v[124:127], v[164:167], a[112:115], v[124:127]
    v_mul_f32 v103, v103, v207
    v_mul_f32 v106, v106, v206
    v_mul_f32 v107, v107, v207
    v_mfma_f32_16x16x32_bf16 v[124:127], v[172:175], a[116:119], v[124:127]
    v_mul_f32 v110, v110, v206
    v_mul_f32 v111, v111, v207
    v_cvt_pk_bf16_f32 v140, v98, v102
    v_mfma_f32_16x16x32_bf16 v[124:127], v[244:247], a[120:123], v[124:127]
    v_cvt_pk_bf16_f32 v141, v106, v110
    ds_write_b64 v227, v[140:141] offset:2176
    v_cvt_pk_bf16_f32 v142, v99, v103
    v_mfma_f32_16x16x32_bf16 v[124:127], v[252:255], a[124:127], v[124:127]
    v_cvt_pk_bf16_f32 v143, v107, v111
    ds_write_b64 v228, v[142:143] offset:2176
    ds_read_b64_tr_b16 v[152:153], v229 offset:2048
    ds_read_b64_tr_b16 v[154:155], v230 offset:2304
    ds_read_b64_tr_b16 v[156:157], v229 offset:3072
    ds_read_b64_tr_b16 v[158:159], v230 offset:3328
    s_waitcnt lgkmcnt(2)
    buffer_store_dwordx4 v[152:155], v231, s[36:39], s86 offen offset:256 nt
    s_waitcnt lgkmcnt(0)
    buffer_store_dwordx4 v[156:159], v231, s[36:39], s87 offen offset:256 nt
    s_nop 7
    v_pk_mul_f32 v[48:49], v[48:49], v[200:201]
    v_pk_mul_f32 v[52:53], v[52:53], v[200:201]
    v_pk_mul_f32 v[56:57], v[56:57], v[200:201]
    v_pk_mul_f32 v[60:61], v[60:61], v[200:201]
    v_cvt_pk_bf16_f32 v128, v48, v52
    v_cvt_pk_bf16_f32 v129, v56, v60
    ds_write_b64 v227, v[128:129] offset:4096
    v_cvt_pk_bf16_f32 v130, v49, v53
    v_cvt_pk_bf16_f32 v131, v57, v61
    ds_write_b64 v228, v[130:131] offset:4096
    v_pk_mul_f32 v[50:51], v[50:51], v[202:203]
    v_pk_mul_f32 v[54:55], v[54:55], v[202:203]
    v_pk_mul_f32 v[58:59], v[58:59], v[202:203]
    v_pk_mul_f32 v[62:63], v[62:63], v[202:203]
    v_cvt_pk_bf16_f32 v132, v50, v54
    v_cvt_pk_bf16_f32 v133, v58, v62
    ds_write_b64 v227, v[132:133] offset:4224
    v_cvt_pk_bf16_f32 v134, v51, v55
    v_cvt_pk_bf16_f32 v135, v59, v63
    ds_write_b64 v228, v[134:135] offset:4224
    ds_read_b64_tr_b16 v[144:145], v229 offset:4096
    ds_read_b64_tr_b16 v[146:147], v230 offset:4352
    ds_read_b64_tr_b16 v[148:149], v229 offset:5120
    ds_read_b64_tr_b16 v[150:151], v230 offset:5376
    v_pk_mul_f32 v[112:113], v[112:113], v[204:205]
    v_pk_mul_f32 v[116:117], v[116:117], v[204:205]
    v_pk_mul_f32 v[120:121], v[120:121], v[204:205]
    v_pk_mul_f32 v[124:125], v[124:125], v[204:205]
    v_cvt_pk_bf16_f32 v136, v112, v116
    v_cvt_pk_bf16_f32 v137, v120, v124
    ds_write_b64 v227, v[136:137] offset:6144
    v_cvt_pk_bf16_f32 v138, v113, v117
    v_cvt_pk_bf16_f32 v139, v121, v125
    ds_write_b64 v228, v[138:139] offset:6144
    s_waitcnt lgkmcnt(4)
    buffer_store_dwordx4 v[144:147], v231, s[36:39], s84 offen offset:384 nt
    s_waitcnt lgkmcnt(2)
    buffer_store_dwordx4 v[148:151], v231, s[36:39], s85 offen offset:384 nt
    v_pk_mul_f32 v[114:115], v[114:115], v[206:207]
    v_pk_mul_f32 v[118:119], v[118:119], v[206:207]
    v_pk_mul_f32 v[122:123], v[122:123], v[206:207]
    v_pk_mul_f32 v[126:127], v[126:127], v[206:207]
    v_cvt_pk_bf16_f32 v140, v114, v118
    v_cvt_pk_bf16_f32 v141, v122, v126
    ds_write_b64 v227, v[140:141] offset:6272
    v_cvt_pk_bf16_f32 v142, v115, v119
    v_cvt_pk_bf16_f32 v143, v123, v127
    ds_write_b64 v228, v[142:143] offset:6272
    ds_read_b64_tr_b16 v[152:153], v229 offset:6144
    ds_read_b64_tr_b16 v[154:155], v230 offset:6400
    ds_read_b64_tr_b16 v[156:157], v229 offset:7168
    ds_read_b64_tr_b16 v[158:159], v230 offset:7424
    s_waitcnt lgkmcnt(2)
    buffer_store_dwordx4 v[152:155], v231, s[36:39], s86 offen offset:384 nt
    s_waitcnt lgkmcnt(0)
    buffer_store_dwordx4 v[156:159], v231, s[36:39], s87 offen offset:384 nt
    s_endpgm
    .p2align 6
L_fin3:
    v_readlane_b32 s51, v196, s46
    s_waitcnt vmcnt(8) lgkmcnt(0)
    s_barrier
    ds_read_b128 a[64:67], v176 offset:16384
    ds_read_b128 a[68:71], v177 offset:16384
    ds_read_b128 a[72:75], v178 offset:16384
    ds_read_b128 a[76:79], v179 offset:16384
    ds_read_b128 a[80:83], v176 offset:16640
    ds_read_b128 a[84:87], v177 offset:16640
    ds_read_b128 a[88:91], v178 offset:16640
    ds_read_b128 a[92:95], v179 offset:16640
    v_exp_f32 v208, v128
    v_exp_f32 v209, v129
    v_exp_f32 v210, v130
    v_cvt_pk_bf16_f32 v160, v208, v209
    s_waitcnt lgkmcnt(7)
    v_mfma_f32_16x16x32_bf16 v[144:147], a[64:67], a[0:3], v[232:235]
    ds_read_b128 a[96:99], v176 offset:24576
    ds_read_b128 a[100:103], v177 offset:24576
    s_waitcnt lgkmcnt(8)
    v_mfma_f32_16x16x32_bf16 v[144:147], a[68:71], a[4:7], v[144:147]
    ds_read_b128 a[104:107], v178 offset:24576
    ds_read_b128 a[108:111], v179 offset:24576
    s_waitcnt lgkmcnt(9)
    v_mfma_f32_16x16x32_bf16 v[144:147], a[72:75], a[8:11], v[144:147]
    ds_read_b128 a[112:115], v176 offset:24832
    ds_read_b128 a[116:119], v177 offset:24832
    s_waitcnt lgkmcnt(10)
    v_mfma_f32_16x16x32_bf16 v[144:147], a[76:79], a[12:15], v[144:147]
    ds_read_b128 a[120:123], v178 offset:24832
    ds_read_b128 a[124:127], v179 offset:24832
    s_waitcnt lgkmcnt(8)
    v_mfma_f32_16x16x32_bf16 v[144:147], a[80:83], a[16:19], v[144:147]
    s_mov_b32 m0, s66
    s_nop 0
    v_mfma_f32_16x16x32_bf16 v[144:147], a[84:87], a[20:23], v[144:147]
    buffer_load_dwordx4 v192, s[28:31], s51 offen lds
    v_mfma_f32_16x16x32_bf16 v[144:147], a[88:91], a[24:27], v[144:147]
    v_exp_f32 v211, v131
    v_mfma_f32_16x16x32_bf16 v[144:147], a[92:95], a[28:31], v[144:147]
    v_exp_f32 v212, v136
    v_cvt_pk_bf16_f32 v161, v210, v211
    v_mfma_f32_16x16x32_bf16 v[148:151], a[64:67], a[32:35], v[236:239]
    v_exp_f32 v213, v137
    v_mfma_f32_16x16x32_bf16 v[148:151], a[68:71], a[36:39], v[148:151]
    buffer_load_dwordx4 v193, s[28:31], s51 offen offset:1024 lds
    v_mfma_f32_16x16x32_bf16 v[148:151], a[72:75], a[40:43], v[148:151]
    v_exp_f32 v214, v138
    v_cvt_pk_bf16_f32 v162, v212, v213
    v_mfma_f32_16x16x32_bf16 v[148:151], a[76:79], a[44:47], v[148:151]
    v_exp_f32 v215, v139
    v_mfma_f32_16x16x32_bf16 v[148:151], a[80:83], a[48:51], v[148:151]
    v_exp_f32 v208, v132
    v_cvt_pk_bf16_f32 v163, v214, v215
    v_mfma_f32_16x16x32_bf16 v[148:151], a[84:87], a[52:55], v[148:151]
    buffer_load_dwordx4 v194, s[28:31], s51 offen offset:2048 lds
    v_or3_b32 v197, v160, v161, v162
    v_mfma_f32_16x16x32_bf16 v[148:151], a[88:91], a[56:59], v[148:151]
    v_exp_f32 v209, v133
    v_mfma_f32_16x16x32_bf16 v[148:151], a[92:95], a[60:63], v[148:151]
    v_exp_f32 v210, v134
    v_cvt_pk_bf16_f32 v164, v208, v209
    s_waitcnt lgkmcnt(0)
    v_mfma_f32_16x16x32_bf16 v[152:155], a[96:99], a[0:3], v[232:235]
    v_exp_f32 v211, v135
    v_mfma_f32_16x16x32_bf16 v[152:155], a[100:103], a[4:7], v[152:155]
    ds_read_b128 a[64:67], v176 offset:32768
    ds_read_b128 a[68:71], v177 offset:32768
    buffer_load_dwordx4 v195, s[28:31], s51 offen offset:3072 lds
    v_mfma_f32_16x16x32_bf16 v[152:155], a[104:107], a[8:11], v[152:155]
    ds_read_b128 a[72:75], v178 offset:32768
    ds_read_b128 a[76:79], v179 offset:32768
    v_mfma_f32_16x16x32_bf16 v[152:155], a[108:111], a[12:15], v[152:155]
    ds_read_b128 a[80:83], v176 offset:33024
    ds_read_b128 a[84:87], v177 offset:33024
    v_mfma_f32_16x16x32_bf16 v[152:155], a[112:115], a[16:19], v[152:155]
    ds_read_b128 a[88:91], v178 offset:33024
    ds_read_b128 a[92:95], v179 offset:33024
    v_mfma_f32_16x16x32_bf16 v[152:155], a[116:119], a[20:23], v[152:155]
    v_exp_f32 v212, v140
    v_cvt_pk_bf16_f32 v165, v210, v211
    v_mfma_f32_16x16x32_bf16 v[152:155], a[120:123], a[24:27], v[152:155]
    v_or3_b32 v197, v197, v163, v164
    v_exp_f32 v213, v141
    v_mfma_f32_16x16x32_bf16 v[152:155], a[124:127], a[28:31], v[152:155]
    v_exp_f32 v214, v142
    v_cvt_pk_bf16_f32 v166, v212, v213
    v_mfma_f32_16x16x32_bf16 v[156:159], a[96:99], a[32:35], v[236:239]
    v_exp_f32 v215, v143
    v_or3_b32 v197, v197, v165, v166
    v_mfma_f32_16x16x32_bf16 v[156:159], a[100:103], a[36:39], v[156:159]
    v_cvt_pk_bf16_f32 v167, v214, v215
    v_or_b32 v197, v197, v167
    v_and_b32 v197, s48, v197
    v_mfma_f32_16x16x32_bf16 v[156:159], a[104:107], a[40:43], v[156:159]
    v_cmp_ne_u32 vcc, 0, v197
    v_mfma_f32_16x16x32_bf16 v[156:159], a[108:111], a[44:47], v[156:159]
    v_mfma_f32_16x16x32_bf16 v[156:159], a[112:115], a[48:51], v[156:159]
    v_mfma_f32_16x16x32_bf16 v[156:159], a[116:119], a[52:55], v[156:159]
    v_mfma_f32_16x16x32_bf16 v[156:159], a[120:123], a[56:59], v[156:159]
    v_mfma_f32_16x16x32_bf16 v[156:159], a[124:127], a[60:63], v[156:159]
    s_add_u32 s54, s46, -1
    s_cmp_lt_u32 s54, s45
    s_cbranch_scc1 L_fok3_1
    v_mov_b32 v160, 0
    v_mov_b32 v161, 0
    v_mov_b32 v162, 0
    v_mov_b32 v163, 0
    v_mov_b32 v164, 0
    v_mov_b32 v165, 0
    v_mov_b32 v166, 0
    v_mov_b32 v167, 0
    s_branch L_fback3_1
L_fok3_1:
    s_cbranch_vccnz L_frare3_1
L_fback3_1:
    s_waitcnt lgkmcnt(0)
    v_mfma_f32_16x16x32_bf16 v[128:131], a[64:67], a[0:3], v[232:235]
    ds_read_b128 a[96:99], v176 offset:40960
    ds_read_b128 a[100:103], v177 offset:40960
    s_lshl_b32 s56, s49, 13
    v_mfma_f32_16x16x32_bf16 v[128:131], a[68:71], a[4:7], v[128:131]
    ds_read_b128 a[104:107], v178 offset:40960
    ds_read_b128 a[108:111], v179 offset:40960
    s_add_u32 s56, s56, 131072
    v_mfma_f32_16x16x32_bf16 v[128:131], a[72:75], a[8:11], v[128:131]
    ds_read_b128 a[112:115], v176 offset:41216
    ds_read_b128 a[116:119], v177 offset:41216
    v_and_b32 v227, 3, v216
    v_mfma_f32_16x16x32_bf16 v[128:131], a[76:79], a[12:15], v[128:131]
    ds_read_b128 a[120:123], v178 offset:41216
    ds_read_b128 a[124:127], v179 offset:41216
    v_bfe_u32 v198, v216, 3, 1
    v_mfma_f32_16x16x32_bf16 v[128:131], a[80:83], a[16:19], v[128:131]
    v_exp_f32 v208, v144
    v_lshl_add_u32 v227, v198, 2, v227
    v_mfma_f32_16x16x32_bf16 v[128:131], a[84:87], a[20:23], v[128:131]
    v_exp_f32 v209, v145
    v_lshrrev_b32 v198, 4, v216
    v_mfma_f32_16x16x32_bf16 v[128:131], a[88:91], a[24:27], v[128:131]
    v_exp_f32 v210, v146
    v_cvt_pk_bf16_f32 v240, v208, v209
    v_mfma_f32_16x16x32_bf16 v[128:131], a[92:95], a[28:31], v[128:131]
    v_exp_f32 v211, v147
    v_lshl_add_u32 v227, v198, 6, v227
    v_mfma_f32_16x16x32_bf16 v[132:135], a[64:67], a[32:35], v[236:239]
    v_exp_f32 v212, v152
    v_cvt_pk_bf16_f32 v241, v210, v211
    v_mfma_f32_16x16x32_bf16 v[132:135], a[68:71], a[36:39], v[132:135]
    v_exp_f32 v213, v153
    v_bfe_u32 v198, v216, 2, 1
    v_mfma_f32_16x16x32_bf16 v[132:135], a[72:75], a[40:43], v[132:135]
    v_exp_f32 v214, v154
    v_cvt_pk_bf16_f32 v242, v212, v213
    v_mfma_f32_16x16x32_bf16 v[132:135], a[76:79], a[44:47], v[132:135]
    v_exp_f32 v215, v155
    v_lshl_add_u32 v227, v198, 5, v227
    v_mfma_f32_16x16x32_bf16 v[132:135], a[80:83], a[48:51], v[132:135]
    v_exp_f32 v208, v148
    v_cvt_pk_bf16_f32 v243, v214, v215
    v_mfma_f32_16x16x32_bf16 v[132:135], a[84:87], a[52:55], v[132:135]
    v_or3_b32 v197, v240, v241, v242
    v_exp_f32 v209, v149
    v_mfma_f32_16x16x32_bf16 v[132:135], a[88:91], a[56:59], v[132:135]
    v_exp_f32 v210, v150
    v_cvt_pk_bf16_f32 v244, v208, v209
    v_mfma_f32_16x16x32_bf16 v[132:135], a[92:95], a[60:63], v[132:135]
    v_exp_f32 v211, v151
    v_lshl_add_u32 v227, v198, 3, v227
    s_waitcnt lgkmcnt(0)
    v_mfma_f32_16x16x32_bf16 v[136:139], a[96:99], a[0:3], v[232:235]
    v_exp_f32 v212, v156
    v_cvt_pk_bf16_f32 v245, v210, v211
    v_mfma_f32_16x16x32_bf16 v[136:139], a[100:103], a[4:7], v[136:139]
    v_or3_b32 v197, v197, v243, v244
    v_exp_f32 v213, v157
    v_mfma_f32_16x16x32_bf16 v[136:139], a[104:107], a[8:11], v[136:139]
    v_exp_f32 v214, v158
    v_cvt_pk_bf16_f32 v246, v212, v213
    v_mfma_f32_16x16x32_bf16 v[136:139], a[108:111], a[12:15], v[136:139]
    v_exp_f32 v215, v159
    v_or3_b32 v197, v197, v245, v246
    v_mfma_f32_16x16x32_bf16 v[136:139], a[112:115], a[16:19], v[136:139]
    v_cvt_pk_bf16_f32 v247, v214, v215
    v_or_b32 v197, v197, v247
    v_and_b32 v197, s48, v197
    v_mfma_f32_16x16x32_bf16 v[136:139], a[116:119], a[20:23], v[136:139]
    v_cmp_ne_u32 vcc, 0, v197
    v_xor_b32 v228, 8, v227
    v_lshl_add_u32 v227, v227, 3, s56
    v_mfma_f32_16x16x32_bf16 v[136:139], a[120:123], a[24:27], v[136:139]
    v_lshl_add_u32 v228, v228, 3, s56
    v_bfe_u32 v229, v216, 2, 2
    v_and_b32 v198, 3, v216
    v_mfma_f32_16x16x32_bf16 v[136:139], a[124:127], a[28:31], v[136:139]
    v_lshl_add_u32 v229, v198, 2, v229
    v_bfe_u32 v198, v216, 4, 1
    v_lshl_add_u32 v229, v198, 4, v229
    v_mfma_f32_16x16x32_bf16 v[140:143], a[96:99], a[32:35], v[236:239]
    v_bfe_u32 v198, v216, 5, 1
    v_lshl_add_u32 v229, v198, 6, v229
    v_xor_b32 v230, 8, v229
    v_mfma_f32_16x16x32_bf16 v[140:143], a[100:103], a[36:39], v[140:143]
    v_lshl_add_u32 v229, v229, 3, s56
    v_lshl_add_u32 v230, v230, 3, s56
    v_lshrrev_b32 v198, 3, v216
    v_mfma_f32_16x16x32_bf16 v[140:143], a[104:107], a[40:43], v[140:143]
    v_lshlrev_b32 v198, 9, v198
    v_and_b32 v199, 7, v216
    v_lshl_add_u32 v231, v199, 4, v198
    v_mfma_f32_16x16x32_bf16 v[140:143], a[108:111], a[44:47], v[140:143]
    s_add_u32 s84, s58, 0
    s_add_u32 s85, s58, 4096
    s_add_u32 s86, s58, 8192
    v_mfma_f32_16x16x32_bf16 v[140:143], a[112:115], a[48:51], v[140:143]
    s_add_u32 s87, s58, 12288
    v_mfma_f32_16x16x32_bf16 v[140:143], a[116:119], a[52:55], v[140:143]
    v_mfma_f32_16x16x32_bf16 v[140:143], a[120:123], a[56:59], v[140:143]
    v_mfma_f32_16x16x32_bf16 v[140:143], a[124:127], a[60:63], v[140:143]
    s_mov_b32 s54, s46
    s_cmp_lt_u32 s54, s45
    s_cbranch_scc1 L_fok3_2
    v_mov_b32 v240, 0
    v_mov_b32 v241, 0
    v_mov_b32 v242, 0
    v_mov_b32 v243, 0
    v_mov_b32 v244, 0
    v_mov_b32 v245, 0
    v_mov_b32 v246, 0
    v_mov_b32 v247, 0
    s_branch L_fback3_2
L_fok3_2:
    s_cbranch_vccnz L_frare3_2
L_fback3_2:
    s_waitcnt vmcnt(0)
    s_barrier
    ds_read_b64_tr_b16 a[64:65], v180 offset:49152
    ds_read_b64_tr_b16 a[66:67], v180 offset:57344
    ds_read_b64_tr_b16 a[68:69], v180
    ds_read_b64_tr_b16 a[70:71], v180 offset:8192
    ds_read_b64_tr_b16 a[72:73], v180 offset:16384
    ds_read_b64_tr_b16 a[74:75], v180 offset:24576
    ds_read_b64_tr_b16 a[76:77], v180 offset:32768
    ds_read_b64_tr_b16 a[78:79], v180 offset:40960
    ds_read_b64_tr_b16 a[80:81], v181 offset:49152
    ds_read_b64_tr_b16 a[82:83], v181 offset:57344
    ds_read_b64_tr_b16 a[84:85], v181
    ds_read_b64_tr_b16 a[86:87], v181 offset:8192
    v_mfma_f32_16x16x32_bf16 v[200:203], v[168:171], a[128:131], v[200:203]
    v_mfma_f32_16x16x32_bf16 v[200:203], v[160:163], a[128:131], v[200:203]
    v_exp_f32 v208, v128
    v_exp_f32 v209, v129
    v_mfma_f32_16x16x32_bf16 v[200:203], v[240:243], a[128:131], v[200:203]
    v_exp_f32 v210, v130
    v_cvt_pk_bf16_f32 v248, v208, v209
    v_mfma_f32_16x16x32_bf16 v[204:207], v[172:175], a[128:131], v[204:207]
    v_exp_f32 v211, v131
    v_exp_f32 v212, v136
    v_mfma_f32_16x16x32_bf16 v[204:207], v[164:167], a[128:131], v[204:207]
    v_cvt_pk_bf16_f32 v249, v210, v211
    v_exp_f32 v213, v137
    v_mfma_f32_16x16x32_bf16 v[204:207], v[244:247], a[128:131], v[204:207]
    v_exp_f32 v214, v138
    v_cvt_pk_bf16_f32 v250, v212, v213
    v_exp_f32 v215, v139
    v_exp_f32 v208, v132
    v_cvt_pk_bf16_f32 v251, v214, v215
    v_or3_b32 v197, v248, v249, v250
    v_exp_f32 v209, v133
    v_exp_f32 v210, v134
    v_cvt_pk_bf16_f32 v252, v208, v209
    v_exp_f32 v211, v135
    v_exp_f32 v212, v140
    v_cvt_pk_bf16_f32 v253, v210, v211
    v_or3_b32 v197, v197, v251, v252
    v_exp_f32 v213, v141
    v_exp_f32 v214, v142
    v_cvt_pk_bf16_f32 v254, v212, v213
    v_exp_f32 v215, v143
    v_or3_b32 v197, v197, v253, v254
    v_cvt_pk_bf16_f32 v255, v214, v215
    v_or_b32 v197, v197, v255
    v_and_b32 v197, s48, v197
    v_cmp_ne_u32 vcc, 0, v197
    s_add_u32 s54, s46, 1
    s_cmp_lt_u32 s54, s45
    s_cbranch_scc1 L_fok3_3
    v_mov_b32 v248, 0
    v_mov_b32 v249, 0
    v_mov_b32 v250, 0
    v_mov_b32 v251, 0
    v_mov_b32 v252, 0
    v_mov_b32 v253, 0
    v_mov_b32 v254, 0
    v_mov_b32 v255, 0
    s_branch L_fback3_3
L_fok3_3:
    s_cbranch_vccnz L_frare3_3
L_fback3_3:
    s_nop 7
    v_mfma_f32_16x16x32_bf16 v[200:203], v[248:251], a[128:131], v[200:203]
    v_mfma_f32_16x16x32_bf16 v[204:207], v[252:255], a[128:131], v[204:207]
    s_waitcnt lgkmcnt(0)
    v_mfma_f32_16x16x32_bf16 v[0:3], v[168:171], a[64:67], v[0:3]
    ds_read_b64_tr_b16 a[88:89], v181 offset:16384
    ds_read_b64_tr_b16 a[90:91], v181 offset:24576
    v_mfma_f32_16x16x32_bf16 v[0:3], v[160:163], a[68:71], v[0:3]
    v_mfma_f32_16x16x32_bf16 v[0:3], v[240:243], a[72:75], v[0:3]
    ds_read_b64_tr_b16 a[92:93], v181 offset:32768
    ds_read_b64_tr_b16 a[94:95], v181 offset:40960
    v_mfma_f32_16x16x32_bf16 v[0:3], v[248:251], a[76:79], v[0:3]
    v_mfma_f32_16x16x32_bf16 v[64:67], v[172:175], a[64:67], v[64:67]
    ds_read_b64_tr_b16 a[96:97], v182 offset:49152
    ds_read_b64_tr_b16 a[98:99], v182 offset:57344
    v_mfma_f32_16x16x32_bf16 v[64:67], v[164:167], a[68:71], v[64:67]
    v_rcp_f32 v200, v200
    v_mfma_f32_16x16x32_bf16 v[64:67], v[244:247], a[72:75], v[64:67]
    ds_read_b64_tr_b16 a[100:101], v182
    ds_read_b64_tr_b16 a[102:103], v182 offset:8192
    v_mfma_f32_16x16x32_bf16 v[64:67], v[252:255], a[76:79], v[64:67]
    v_rcp_f32 v201, v201
    v_mfma_f32_16x16x32_bf16 v[4:7], v[168:171], a[80:83], v[4:7]
    ds_read_b64_tr_b16 a[104:105], v182 offset:16384
    ds_read_b64_tr_b16 a[106:107], v182 offset:24576
    v_mfma_f32_16x16x32_bf16 v[4:7], v[160:163], a[84:87], v[4:7]
    v_rcp_f32 v202, v202
    s_waitcnt lgkmcnt(8)
    v_mfma_f32_16x16x32_bf16 v[4:7], v[240:243], a[88:91], v[4:7]
    ds_read_b64_tr_b16 a[108:109], v182 offset:32768
    ds_read_b64_tr_b16 a[110:111], v182 offset:40960
    s_waitcnt lgkmcnt(8)
    v_mfma_f32_16x16x32_bf16 v[4:7], v[248:251], a[92:95], v[4:7]
    v_rcp_f32 v203, v203
    v_mfma_f32_16x16x32_bf16 v[68:71], v[172:175], a[80:83], v[68:71]
    ds_read_b64_tr_b16 a[112:113], v183 offset:49152
    ds_read_b64_tr_b16 a[114:115], v183 offset:57344
    v_mfma_f32_16x16x32_bf16 v[68:71], v[164:167], a[84:87], v[68:71]
    v_rcp_f32 v204, v204
    v_mfma_f32_16x16x32_bf16 v[68:71], v[244:247], a[88:91], v[68:71]
    ds_read_b64_tr_b16 a[116:117], v183
    ds_read_b64_tr_b16 a[118:119], v183 offset:8192
    v_mfma_f32_16x16x32_bf16 v[68:71], v[252:255], a[92:95], v[68:71]
    v_rcp_f32 v205, v205
    s_waitcnt lgkmcnt(7)
    v_mfma_f32_16x16x32_bf16 v[8:11], v[168:171], a[96:99], v[8:11]
    ds_read_b64_tr_b16 a[120:121], v183 offset:16384
    ds_read_b64_tr_b16 a[122:123], v183 offset:24576
    v_mfma_f32_16x16x32_bf16 v[8:11], v[160:163], a[100:103], v[8:11]
    v_rcp_f32 v206, v206
    s_waitcnt lgkmcnt(7)
    v_mfma_f32_16x16x32_bf16 v[8:11], v[240:243], a[104:107], v[8:11]
    ds_read_b64_tr_b16 a[124:125], v183 offset:32768
    ds_read_b64_tr_b16 a[126:127], v183 offset:40960
    s_waitcnt lgkmcnt(8)
    v_mfma_f32_16x16x32_bf16 v[8:11], v[248:251], a[108:111], v[8:11]
    v_rcp_f32 v207, v207
    v_mfma_f32_16x16x32_bf16 v[72:75], v[172:175], a[96:99], v[72:75]
    ds_read_b64_tr_b16 a[64:65], v184 offset:49152
    ds_read_b64_tr_b16 a[66:67], v184 offset:57344
    v_mfma_f32_16x16x32_bf16 v[72:75], v[164:167], a[100:103], v[72:75]
    v_mfma_f32_16x16x32_bf16 v[72:75], v[244:247], a[104:107], v[72:75]
    ds_read_b64_tr_b16 a[68:69], v184
    ds_read_b64_tr_b16 a[70:71], v184 offset:8192
    v_mfma_f32_16x16x32_bf16 v[72:75], v[252:255], a[108:111], v[72:75]
    s_waitcnt lgkmcnt(8)
    v_mfma_f32_16x16x32_bf16 v[12:15], v[168:171], a[112:115], v[12:15]
    ds_read_b64_tr_b16 a[72:73], v184 offset:16384
    ds_read_b64_tr_b16 a[74:75], v184 offset:24576
    v_mfma_f32_16x16x32_bf16 v[12:15], v[160:163], a[116:119], v[12:15]
    s_waitcnt lgkmcnt(8)
    v_mfma_f32_16x16x32_bf16 v[12:15], v[240:243], a[120:123], v[12:15]
    ds_read_b64_tr_b16 a[76:77], v184 offset:32768
    ds_read_b64_tr_b16 a[78:79], v184 offset:40960
    s_waitcnt lgkmcnt(8)
    v_mfma_f32_16x16x32_bf16 v[12:15], v[248:251], a[124:127], v[12:15]
    v_mfma_f32_16x16x32_bf16 v[76:79], v[172:175], a[112:115], v[76:79]
    ds_read_b64_tr_b16 a[80:81], v185 offset:49152
    ds_read_b64_tr_b16 a[82:83], v185 offset:57344
    v_mfma_f32_16x16x32_bf16 v[76:79], v[164:167], a[116:119], v[76:79]
    v_mfma_f32_16x16x32_bf16 v[76:79], v[244:247], a[120:123], v[76:79]
    ds_read_b64_tr_b16 a[84:85], v185
    ds_read_b64_tr_b16 a[86:87], v185 offset:8192
    v_mfma_f32_16x16x32_bf16 v[76:79], v[252:255], a[124:127], v[76:79]
    s_waitcnt lgkmcnt(8)
    v_mfma_f32_16x16x32_bf16 v[16:19], v[168:171], a[64:67], v[16:19]
    ds_read_b64_tr_b16 a[88:89], v185 offset:16384
    ds_read_b64_tr_b16 a[90:91], v185 offset:24576
    v_mfma_f32_16x16x32_bf16 v[16:19], v[160:163], a[68:71], v[16:19]
    s_waitcnt lgkmcnt(8)
    v_mfma_f32_16x16x32_bf16 v[16:19], v[240:243], a[72:75], v[16:19]
    ds_read_b64_tr_b16 a[92:93], v185 offset:32768
    ds_read_b64_tr_b16 a[94:95], v185 offset:40960
    s_waitcnt lgkmcnt(8)
    v_mfma_f32_16x16x32_bf16 v[16:19], v[248:251], a[76:79], v[16:19]
    v_mul_f32 v0, v0, v200
    v_mul_f32 v1, v1, v201
    v_mul_f32 v4, v4, v200
    v_mfma_f32_16x16x32_bf16 v[80:83], v[172:175], a[64:67], v[80:83]
    ds_read_b64_tr_b16 a[96:97], v186 offset:49152
    ds_read_b64_tr_b16 a[98:99], v186 offset:57344
    v_mul_f32 v5, v5, v201
    v_mfma_f32_16x16x32_bf16 v[80:83], v[164:167], a[68:71], v[80:83]
    v_mul_f32 v8, v8, v200
    v_mul_f32 v9, v9, v201
    v_mul_f32 v12, v12, v200
    v_mfma_f32_16x16x32_bf16 v[80:83], v[244:247], a[72:75], v[80:83]
    ds_read_b64_tr_b16 a[100:101], v186
    ds_read_b64_tr_b16 a[102:103], v186 offset:8192
    v_mul_f32 v13, v13, v201
    v_mfma_f32_16x16x32_bf16 v[80:83], v[252:255], a[76:79], v[80:83]
    v_cvt_pk_bf16_f32 v128, v0, v4
    v_cvt_pk_bf16_f32 v129, v8, v12
    ds_write_b64 v227, v[128:129]
    s_waitcnt lgkmcnt(5)
    v_mfma_f32_16x16x32_bf16 v[20:23], v[168:171], a[80:83], v[20:23]
    ds_read_b64_tr_b16 a[104:105], v186 offset:16384
    ds_read_b64_tr_b16 a[106:107], v186 offset:24576
    v_cvt_pk_bf16_f32 v130, v1, v5
    v_mfma_f32_16x16x32_bf16 v[20:23], v[160:163], a[84:87], v[20:23]
    v_cvt_pk_bf16_f32 v131, v9, v13
    ds_write_b64 v228, v[130:131]
    v_mul_f32 v2, v2, v202
    v_mfma_f32_16x16x32_bf16 v[20:23], v[240:243], a[88:91], v[20:23]
    ds_read_b64_tr_b16 a[108:109], v186 offset:32768
    ds_read_b64_tr_b16 a[110:111], v186 offset:40960
    v_mul_f32 v3, v3, v203
    v_mfma_f32_16x16x32_bf16 v[20:23], v[248:251], a[92:95], v[20:23]
    v_mul_f32 v6, v6, v202
    v_mul_f32 v7, v7, v203
    v_mul_f32 v10, v10, v202
    v_mfma_f32_16x16x32_bf16 v[84:87], v[172:175], a[80:83], v[84:87]
    ds_read_b64_tr_b16 a[112:113], v187 offset:49152
    ds_read_b64_tr_b16 a[114:115], v187 offset:57344
    v_mul_f32 v11, v11, v203
    v_mfma_f32_16x16x32_bf16 v[84:87], v[164:167], a[84:87], v[84:87]
    v_mul_f32 v14, v14, v202
    v_mul_f32 v15, v15, v203
    v_cvt_pk_bf16_f32 v132, v2, v6
    v_mfma_f32_16x16x32_bf16 v[84:87], v[244:247], a[88:91], v[84:87]
    ds_read_b64_tr_b16 a[116:117], v187
    ds_read_b64_tr_b16 a[118:119], v187 offset:8192
    v_cvt_pk_bf16_f32 v133, v10, v14
    v_mfma_f32_16x16x32_bf16 v[84:87], v[252:255], a[92:95], v[84:87]
    ds_write_b64 v227, v[132:133] offset:128
    v_cvt_pk_bf16_f32 v134, v3, v7
    v_cvt_pk_bf16_f32 v135, v11, v15
    s_waitcnt lgkmcnt(5)
    v_mfma_f32_16x16x32_bf16 v[24:27], v[168:171], a[96:99], v[24:27]
    ds_read_b64_tr_b16 a[120:121], v187 offset:16384
    ds_read_b64_tr_b16 a[122:123], v187 offset:24576
    ds_write_b64 v228, v[134:135] offset:128
    v_mfma_f32_16x16x32_bf16 v[24:27], v[160:163], a[100:103], v[24:27]
    ds_read_b64_tr_b16 v[144:145], v229
    ds_read_b64_tr_b16 v[146:147], v230 offset:256
    ds_read_b64_tr_b16 v[148:149], v229 offset:1024
    v_mfma_f32_16x16x32_bf16 v[24:27], v[240:243], a[104:107], v[24:27]
    ds_read_b64_tr_b16 a[124:125], v187 offset:32768
    ds_read_b64_tr_b16 a[126:127], v187 offset:40960
    ds_read_b64_tr_b16 v[150:151], v230 offset:1280
    v_mfma_f32_16x16x32_bf16 v[24:27], v[248:251], a[108:111], v[24:27]
    v_mul_f32 v64, v64, v204
    v_mul_f32 v65, v65, v205
    v_mul_f32 v68, v68, v204
    v_mfma_f32_16x16x32_bf16 v[88:91], v[172:175], a[96:99], v[88:91]
    ds_read_b64_tr_b16 a[64:65], v180 offset:49408
    s_waitcnt lgkmcnt(10)
    ds_read_b64_tr_b16 a[66:67], v180 offset:57600
    v_mul_f32 v69, v69, v205
    v_mfma_f32_16x16x32_bf16 v[88:91], v[164:167], a[100:103], v[88:91]
    v_mul_f32 v72, v72, v204
    v_mul_f32 v73, v73, v205
    v_mul_f32 v76, v76, v204
    v_mfma_f32_16x16x32_bf16 v[88:91], v[244:247], a[104:107], v[88:91]
    ds_read_b64_tr_b16 a[68:69], v180 offset:256
    ds_read_b64_tr_b16 a[70:71], v180 offset:8448
    v_mul_f32 v77, v77, v205
    v_mfma_f32_16x16x32_bf16 v[88:91], v[252:255], a[108:111], v[88:91]
    v_cvt_pk_bf16_f32 v136, v64, v68
    v_cvt_pk_bf16_f32 v137, v72, v76
    v_mfma_f32_16x16x32_bf16 v[28:31], v[168:171], a[112:115], v[28:31]
    ds_read_b64_tr_b16 a[72:73], v180 offset:16640
    ds_read_b64_tr_b16 a[74:75], v180 offset:24832
    v_mfma_f32_16x16x32_bf16 v[28:31], v[160:163], a[116:119], v[28:31]
    s_waitcnt lgkmcnt(6)
    buffer_store_dwordx4 v[144:147], v231, s[36:39], s84 offen nt
    v_mfma_f32_16x16x32_bf16 v[28:31], v[240:243], a[120:123], v[28:31]
    ds_read_b64_tr_b16 a[76:77], v180 offset:33024
    ds_read_b64_tr_b16 a[78:79], v180 offset:41216
    v_mfma_f32_16x16x32_bf16 v[28:31], v[248:251], a[124:127], v[28:31]
    buffer_store_dwordx4 v[148:151], v231, s[36:39], s85 offen nt
    ds_write_b64 v227, v[136:137] offset:2048
    v_mfma_f32_16x16x32_bf16 v[92:95], v[172:175], a[112:115], v[92:95]
    ds_read_b64_tr_b16 a[80:81], v181 offset:49408
    ds_read_b64_tr_b16 a[82:83], v181 offset:57600
    v_cvt_pk_bf16_f32 v138, v65, v69
    v_mfma_f32_16x16x32_bf16 v[92:95], v[164:167], a[116:119], v[92:95]
    v_cvt_pk_bf16_f32 v139, v73, v77
    ds_write_b64 v228, v[138:139] offset:2048
    v_mul_f32 v66, v66, v206
    v_mfma_f32_16x16x32_bf16 v[92:95], v[244:247], a[120:123], v[92:95]
    ds_read_b64_tr_b16 a[84:85], v181 offset:256
    ds_read_b64_tr_b16 a[86:87], v181 offset:8448
    v_mul_f32 v67, v67, v207
    v_mfma_f32_16x16x32_bf16 v[92:95], v[252:255], a[124:127], v[92:95]
    v_mul_f32 v70, v70, v206
    v_mul_f32 v71, v71, v207
    v_mul_f32 v74, v74, v206
    v_mul_f32 v75, v75, v207
    v_mul_f32 v78, v78, v206
    v_mul_f32 v79, v79, v207
    v_cvt_pk_bf16_f32 v140, v66, v70
    v_cvt_pk_bf16_f32 v141, v74, v78
    ds_write_b64 v227, v[140:141] offset:2176
    v_cvt_pk_bf16_f32 v142, v67, v71
    v_cvt_pk_bf16_f32 v143, v75, v79
    s_waitcnt lgkmcnt(4)
    ds_write_b64 v228, v[142:143] offset:2176
    ds_read_b64_tr_b16 v[152:153], v229 offset:2048
    ds_read_b64_tr_b16 v[154:155], v230 offset:2304
    ds_read_b64_tr_b16 v[156:157], v229 offset:3072
    ds_read_b64_tr_b16 v[158:159], v230 offset:3328
    v_mfma_f32_16x16x32_bf16 v[32:35], v[168:171], a[64:67], v[32:35]
    ds_read_b64_tr_b16 a[88:89], v181 offset:16640
    ds_read_b64_tr_b16 a[90:91], v181 offset:24832
    v_mfma_f32_16x16x32_bf16 v[32:35], v[160:163], a[68:71], v[32:35]
    v_mfma_f32_16x16x32_bf16 v[32:35], v[240:243], a[72:75], v[32:35]
    ds_read_b64_tr_b16 a[92:93], v181 offset:33024
    ds_read_b64_tr_b16 a[94:95], v181 offset:41216
    v_mfma_f32_16x16x32_bf16 v[32:35], v[248:251], a[76:79], v[32:35]
    s_waitcnt lgkmcnt(6)
    buffer_store_dwordx4 v[152:155], v231, s[36:39], s86 offen nt
    v_mfma_f32_16x16x32_bf16 v[96:99], v[172:175], a[64:67], v[96:99]
    ds_read_b64_tr_b16 a[96:97], v182 offset:49408
    ds_read_b64_tr_b16 a[98:99], v182 offset:57600
    v_mfma_f32_16x16x32_bf16 v[96:99], v[164:167], a[68:71], v[96:99]
    s_waitcnt lgkmcnt(6)
    buffer_store_dwordx4 v[156:159], v231, s[36:39], s87 offen nt
    v_mul_f32 v16, v16, v200
    v_mfma_f32_16x16x32_bf16 v[96:99], v[244:247], a[72:75], v[96:99]
    ds_read_b64_tr_b16 a[100:101], v182 offset:256
    ds_read_b64_tr_b16 a[102:103], v182 offset:8448
    v_mul_f32 v17, v17, v201
    v_mfma_f32_16x16x32_bf16 v[96:99], v[252:255], a[76:79], v[96:99]
    v_mul_f32 v20, v20, v200
    v_mul_f32 v21, v21, v201
    v_mul_f32 v24, v24, v200
    v_mfma_f32_16x16x32_bf16 v[36:39], v[168:171], a[80:83], v[36:39]
    ds_read_b64_tr_b16 a[104:105], v182 offset:16640
    ds_read_b64_tr_b16 a[106:107], v182 offset:24832
    v_mul_f32 v25, v25, v201
    v_mfma_f32_16x16x32_bf16 v[36:39], v[160:163], a[84:87], v[36:39]
    v_mul_f32 v28, v28, v200
    v_mul_f32 v29, v29, v201
    v_cvt_pk_bf16_f32 v128, v16, v20
    s_waitcnt lgkmcnt(4)
    v_mfma_f32_16x16x32_bf16 v[36:39], v[240:243], a[88:91], v[36:39]
    ds_read_b64_tr_b16 a[108:109], v182 offset:33024
    ds_read_b64_tr_b16 a[110:111], v182 offset:41216
    v_cvt_pk_bf16_f32 v129, v24, v28
    v_mfma_f32_16x16x32_bf16 v[36:39], v[248:251], a[92:95], v[36:39]
    ds_write_b64 v227, v[128:129] offset:4096
    v_cvt_pk_bf16_f32 v130, v17, v21
    v_cvt_pk_bf16_f32 v131, v25, v29
    v_mfma_f32_16x16x32_bf16 v[100:103], v[172:175], a[80:83], v[100:103]
    ds_read_b64_tr_b16 a[112:113], v183 offset:49408
    ds_read_b64_tr_b16 a[114:115], v183 offset:57600
    ds_write_b64 v228, v[130:131] offset:4096
    v_mfma_f32_16x16x32_bf16 v[100:103], v[164:167], a[84:87], v[100:103]
    v_mul_f32 v18, v18, v202
    v_mul_f32 v19, v19, v203
    v_mul_f32 v22, v22, v202
    v_mfma_f32_16x16x32_bf16 v[100:103], v[244:247], a[88:91], v[100:103]
    ds_read_b64_tr_b16 a[116:117], v183 offset:256
    ds_read_b64_tr_b16 a[118:119], v183 offset:8448
    v_mul_f32 v23, v23, v203
    v_mfma_f32_16x16x32_bf16 v[100:103], v[252:255], a[92:95], v[100:103]
    v_mul_f32 v26, v26, v202
    v_mul_f32 v27, v27, v203
    v_mul_f32 v30, v30, v202
    v_mfma_f32_16x16x32_bf16 v[40:43], v[168:171], a[96:99], v[40:43]
    ds_read_b64_tr_b16 a[120:121], v183 offset:16640
    ds_read_b64_tr_b16 a[122:123], v183 offset:24832
    v_mul_f32 v31, v31, v203
    s_waitcnt lgkmcnt(7)
    v_mfma_f32_16x16x32_bf16 v[40:43], v[160:163], a[100:103], v[40:43]
    v_cvt_pk_bf16_f32 v132, v18, v22
    v_cvt_pk_bf16_f32 v133, v26, v30
    ds_write_b64 v227, v[132:133] offset:4224
    v_mfma_f32_16x16x32_bf16 v[40:43], v[240:243], a[104:107], v[40:43]
    ds_read_b64_tr_b16 a[124:125], v183 offset:33024
    ds_read_b64_tr_b16 a[126:127], v183 offset:41216
    v_cvt_pk_bf16_f32 v134, v19, v23
    v_mfma_f32_16x16x32_bf16 v[40:43], v[248:251], a[108:111], v[40:43]
    v_cvt_pk_bf16_f32 v135, v27, v31
    ds_write_b64 v228, v[134:135] offset:4224
    ds_read_b64_tr_b16 v[144:145], v229 offset:4096
    v_mfma_f32_16x16x32_bf16 v[104:107], v[172:175], a[96:99], v[104:107]
    ds_read_b64_tr_b16 a[64:65], v184 offset:49408
    ds_read_b64_tr_b16 a[66:67], v184 offset:57600
    ds_read_b64_tr_b16 v[146:147], v230 offset:4352
    v_mfma_f32_16x16x32_bf16 v[104:107], v[164:167], a[100:103], v[104:107]
    s_waitcnt lgkmcnt(9)
    ds_read_b64_tr_b16 v[148:149], v229 offset:5120
    ds_read_b64_tr_b16 v[150:151], v230 offset:5376
    v_mul_f32 v80, v80, v204
    v_mfma_f32_16x16x32_bf16 v[104:107], v[244:247], a[104:107], v[104:107]
    ds_read_b64_tr_b16 a[68:69], v184 offset:256
    ds_read_b64_tr_b16 a[70:71], v184 offset:8448
    v_mul_f32 v81, v81, v205
    v_mfma_f32_16x16x32_bf16 v[104:107], v[252:255], a[108:111], v[104:107]
    v_mul_f32 v84, v84, v204
    v_mul_f32 v85, v85, v205
    v_mul_f32 v88, v88, v204
    v_mfma_f32_16x16x32_bf16 v[44:47], v[168:171], a[112:115], v[44:47]
    ds_read_b64_tr_b16 a[72:73], v184 offset:16640
    ds_read_b64_tr_b16 a[74:75], v184 offset:24832
    v_mul_f32 v89, v89, v205
    v_mfma_f32_16x16x32_bf16 v[44:47], v[160:163], a[116:119], v[44:47]
    v_mul_f32 v92, v92, v204
    v_mul_f32 v93, v93, v205
    v_cvt_pk_bf16_f32 v136, v80, v84
    s_waitcnt lgkmcnt(6)
    v_mfma_f32_16x16x32_bf16 v[44:47], v[240:243], a[120:123], v[44:47]
    ds_read_b64_tr_b16 a[76:77], v184 offset:33024
    ds_read_b64_tr_b16 a[78:79], v184 offset:41216
    v_cvt_pk_bf16_f32 v137, v88, v92
    v_mfma_f32_16x16x32_bf16 v[44:47], v[248:251], a[124:127], v[44:47]
    buffer_store_dwordx4 v[144:147], v231, s[36:39], s84 offen offset:128 nt
    v_mfma_f32_16x16x32_bf16 v[108:111], v[172:175], a[112:115], v[108:111]
    ds_read_b64_tr_b16 a[80:81], v185 offset:49408
    ds_read_b64_tr_b16 a[82:83], v185 offset:57600
    v_mfma_f32_16x16x32_bf16 v[108:111], v[164:167], a[116:119], v[108:111]
    s_waitcnt lgkmcnt(6)
    buffer_store_dwordx4 v[148:151], v231, s[36:39], s85 offen offset:128 nt
    ds_write_b64 v227, v[136:137] offset:6144
    v_mfma_f32_16x16x32_bf16 v[108:111], v[244:247], a[120:123], v[108:111]
    ds_read_b64_tr_b16 a[84:85], v185 offset:256
    ds_read_b64_tr_b16 a[86:87], v185 offset:8448
    v_cvt_pk_bf16_f32 v138, v81, v85
    v_mfma_f32_16x16x32_bf16 v[108:111], v[252:255], a[124:127], v[108:111]
    v_cvt_pk_bf16_f32 v139, v89, v93
    ds_write_b64 v228, v[138:139] offset:6144
    v_mul_f32 v82, v82, v206
    v_mul_f32 v83, v83, v207
    v_mul_f32 v86, v86, v206
    v_mul_f32 v87, v87, v207
    v_mul_f32 v90, v90, v206
    v_mul_f32 v91, v91, v207
    v_mul_f32 v94, v94, v206
    v_mul_f32 v95, v95, v207
    v_cvt_pk_bf16_f32 v140, v82, v86
    v_cvt_pk_bf16_f32 v141, v90, v94
    ds_write_b64 v227, v[140:141] offset:6272
    v_cvt_pk_bf16_f32 v142, v83, v87
    v_cvt_pk_bf16_f32 v143, v91, v95
    ds_write_b64 v228, v[142:143] offset:6272
    ds_read_b64_tr_b16 v[152:153], v229 offset:6144
    ds_read_b64_tr_b16 v[154:155], v230 offset:6400
    ds_read_b64_tr_b16 v[156:157], v229 offset:7168
    s_waitcnt lgkmcnt(6)
    ds_read_b64_tr_b16 v[158:159], v230 offset:7424
    v_mfma_f32_16x16x32_bf16 v[48:51], v[168:171], a[64:67], v[48:51]
    ds_read_b64_tr_b16 a[88:89], v185 offset:16640
    ds_read_b64_tr_b16 a[90:91], v185 offset:24832
    v_mfma_f32_16x16x32_bf16 v[48:51], v[160:163], a[68:71], v[48:51]
    v_mfma_f32_16x16x32_bf16 v[48:51], v[240:243], a[72:75], v[48:51]
    ds_read_b64_tr_b16 a[92:93], v185 offset:33024
    ds_read_b64_tr_b16 a[94:95], v185 offset:41216
    v_mfma_f32_16x16x32_bf16 v[48:51], v[248:251], a[76:79], v[48:51]
    s_waitcnt lgkmcnt(6)
    buffer_store_dwordx4 v[152:155], v231, s[36:39], s86 offen offset:128 nt
    v_mfma_f32_16x16x32_bf16 v[112:115], v[172:175], a[64:67], v[112:115]
    ds_read_b64_tr_b16 a[96:97], v186 offset:49408
    ds_read_b64_tr_b16 a[98:99], v186 offset:57600
    v_mfma_f32_16x16x32_bf16 v[112:115], v[164:167], a[68:71], v[112:115]
    s_waitcnt lgkmcnt(6)
    buffer_store_dwordx4 v[156:159], v231, s[36:39], s87 offen offset:128 nt
    v_mul_f32 v32, v32, v200
    v_mfma_f32_16x16x32_bf16 v[112:115], v[244:247], a[72:75], v[112:115]
    ds_read_b64_tr_b16 a[100:101], v186 offset:256
    ds_read_b64_tr_b16 a[102:103], v186 offset:8448
    v_mul_f32 v33, v33, v201
    v_mfma_f32_16x16x32_bf16 v[112:115], v[252:255], a[76:79], v[112:115]
    v_mul_f32 v36, v36, v200
    v_mul_f32 v37, v37, v201
    v_mul_f32 v40, v40, v200
    v_mfma_f32_16x16x32_bf16 v[52:55], v[168:171], a[80:83], v[52:55]
    ds_read_b64_tr_b16 a[104:105], v186 offset:16640
    ds_read_b64_tr_b16 a[106:107], v186 offset:24832
    v_mul_f32 v41, v41, v201
    v_mfma_f32_16x16x32_bf16 v[52:55], v[160:163], a[84:87], v[52:55]
    v_mul_f32 v44, v44, v200
    v_mul_f32 v45, v45, v201
    v_cvt_pk_bf16_f32 v128, v32, v36
    s_waitcnt lgkmcnt(4)
    v_mfma_f32_16x16x32_bf16 v[52:55], v[240:243], a[88:91], v[52:55]
    ds_read_b64_tr_b16 a[108:109], v186 offset:33024
    ds_read_b64_tr_b16 a[110:111], v186 offset:41216
    v_cvt_pk_bf16_f32 v129, v40, v44
    v_mfma_f32_16x16x32_bf16 v[52:55], v[248:251], a[92:95], v[52:55]
    ds_write_b64 v227, v[128:129]
    v_cvt_pk_bf16_f32 v130, v33, v37
    v_cvt_pk_bf16_f32 v131, v41, v45
    v_mfma_f32_16x16x32_bf16 v[116:119], v[172:175], a[80:83], v[116:119]
    ds_read_b64_tr_b16 a[112:113], v187 offset:49408
    ds_read_b64_tr_b16 a[114:115], v187 offset:57600
    ds_write_b64 v228, v[130:131]
    v_mfma_f32_16x16x32_bf16 v[116:119], v[164:167], a[84:87], v[116:119]
    v_mul_f32 v34, v34, v202
    v_mul_f32 v35, v35, v203
    v_mul_f32 v38, v38, v202
    v_mfma_f32_16x16x32_bf16 v[116:119], v[244:247], a[88:91], v[116:119]
    ds_read_b64_tr_b16 a[116:117], v187 offset:256
    ds_read_b64_tr_b16 a[118:119], v187 offset:8448
    v_mul_f32 v39, v39, v203
    v_mfma_f32_16x16x32_bf16 v[116:119], v[252:255], a[92:95], v[116:119]
    v_mul_f32 v42, v42, v202
    v_mul_f32 v43, v43, v203
    v_mul_f32 v46, v46, v202
    v_mfma_f32_16x16x32_bf16 v[56:59], v[168:171], a[96:99], v[56:59]
    ds_read_b64_tr_b16 a[120:121], v187 offset:16640
    ds_read_b64_tr_b16 a[122:123], v187 offset:24832
    v_mul_f32 v47, v47, v203
    s_waitcnt lgkmcnt(7)
    v_mfma_f32_16x16x32_bf16 v[56:59], v[160:163], a[100:103], v[56:59]
    v_cvt_pk_bf16_f32 v132, v34, v38
    v_cvt_pk_bf16_f32 v133, v42, v46
    ds_write_b64 v227, v[132:133] offset:128
    v_mfma_f32_16x16x32_bf16 v[56:59], v[240:243], a[104:107], v[56:59]
    ds_read_b64_tr_b16 a[124:125], v187 offset:33024
    ds_read_b64_tr_b16 a[126:127], v187 offset:41216
    v_cvt_pk_bf16_f32 v134, v35, v39
    v_mfma_f32_16x16x32_bf16 v[56:59], v[248:251], a[108:111], v[56:59]
    v_cvt_pk_bf16_f32 v135, v43, v47
    ds_write_b64 v228, v[134:135] offset:128
    ds_read_b64_tr_b16 v[144:145], v229
    v_mfma_f32_16x16x32_bf16 v[120:123], v[172:175], a[96:99], v[120:123]
    ds_read_b64_tr_b16 v[146:147], v230 offset:256
    ds_read_b64_tr_b16 v[148:149], v229 offset:1024
    ds_read_b64_tr_b16 v[150:151], v230 offset:1280
    v_mfma_f32_16x16x32_bf16 v[120:123], v[164:167], a[100:103], v[120:123]
    v_mul_f32 v96, v96, v204
    v_mul_f32 v97, v97, v205
    v_mul_f32 v100, v100, v204
    v_mfma_f32_16x16x32_bf16 v[120:123], v[244:247], a[104:107], v[120:123]
    v_mul_f32 v101, v101, v205
    v_mul_f32 v104, v104, v204
    v_mul_f32 v105, v105, v205
    v_mfma_f32_16x16x32_bf16 v[120:123], v[252:255], a[108:111], v[120:123]
    v_mul_f32 v108, v108, v204
    v_mul_f32 v109, v109, v205
    v_cvt_pk_bf16_f32 v136, v96, v100
    s_waitcnt lgkmcnt(5)
    v_mfma_f32_16x16x32_bf16 v[60:63], v[168:171], a[112:115], v[60:63]
    v_cvt_pk_bf16_f32 v137, v104, v108
    s_waitcnt lgkmcnt(2)
    buffer_store_dwordx4 v[144:147], v231, s[36:39], s84 offen offset:256 nt
    v_mfma_f32_16x16x32_bf16 v[60:63], v[160:163], a[116:119], v[60:63]
    s_waitcnt lgkmcnt(0)
    buffer_store_dwordx4 v[148:151], v231, s[36:39], s85 offen offset:256 nt
    ds_write_b64 v227, v[136:137] offset:2048
    v_mfma_f32_16x16x32_bf16 v[60:63], v[240:243], a[120:123], v[60:63]
    v_cvt_pk_bf16_f32 v138, v97, v101
    v_cvt_pk_bf16_f32 v139, v105, v109
    ds_write_b64 v228, v[138:139] offset:2048
    v_mfma_f32_16x16x32_bf16 v[60:63], v[248:251], a[124:127], v[60:63]
    v_mul_f32 v98, v98, v206
    v_mul_f32 v99, v99, v207
    v_mul_f32 v102, v102, v206
    v_mfma_f32_16x16x32_bf16 v[124:127], v[172:175], a[112:115], v[124:127]
    v_mul_f32 v103, v103, v207
    v_mul_f32 v106, v106, v206
    v_mul_f32 v107, v107, v207
    v_mfma_f32_16x16x32_bf16 v[124:127], v[164:167], a[116:119], v[124:127]
    v_mul_f32 v110, v110, v206
    v_mul_f32 v111, v111, v207
    v_cvt_pk_bf16_f32 v140, v98, v102
    v_mfma_f32_16x16x32_bf16 v[124:127], v[244:247], a[120:123], v[124:127]
    v_cvt_pk_bf16_f32 v141, v106, v110
    ds_write_b64 v227, v[140:141] offset:2176
    v_cvt_pk_bf16_f32 v142, v99, v103
    v_mfma_f32_16x16x32_bf16 v[124:127], v[252:255], a[124:127], v[124:127]
    v_cvt_pk_bf16_f32 v143, v107, v111
    ds_write_b64 v228, v[142:143] offset:2176
    ds_read_b64_tr_b16 v[152:153], v229 offset:2048
    ds_read_b64_tr_b16 v[154:155], v230 offset:2304
    ds_read_b64_tr_b16 v[156:157], v229 offset:3072
    ds_read_b64_tr_b16 v[158:159], v230 offset:3328
    s_waitcnt lgkmcnt(2)
    buffer_store_dwordx4 v[152:155], v231, s[36:39], s86 offen offset:256 nt
    s_waitcnt lgkmcnt(0)
    buffer_store_dwordx4 v[156:159], v231, s[36:39], s87 offen offset:256 nt
    s_nop 7
    v_pk_mul_f32 v[48:49], v[48:49], v[200:201]
    v_pk_mul_f32 v[52:53], v[52:53], v[200:201]
    v_pk_mul_f32 v[56:57], v[56:57], v[200:201]
    v_pk_mul_f32 v[60:61], v[60:61], v[200:201]
    v_cvt_pk_bf16_f32 v128, v48, v52
    v_cvt_pk_bf16_f32 v129, v56, v60
    ds_write_b64 v227, v[128:129] offset:4096
    v_cvt_pk_bf16_f32 v130, v49, v53
    v_cvt_pk_bf16_f32 v131, v57, v61
    ds_write_b64 v228, v[130:131] offset:4096
    v_pk_mul_f32 v[50:51], v[50:51], v[202:203]
    v_pk_mul_f32 v[54:55], v[54:55], v[202:203]
    v_pk_mul_f32 v[58:59], v[58:59], v[202:203]
    v_pk_mul_f32 v[62:63], v[62:63], v[202:203]
    v_cvt_pk_bf16_f32 v132, v50, v54
    v_cvt_pk_bf16_f32 v133, v58, v62
    ds_write_b64 v227, v[132:133] offset:4224
    v_cvt_pk_bf16_f32 v134, v51, v55
    v_cvt_pk_bf16_f32 v135, v59, v63
    ds_write_b64 v228, v[134:135] offset:4224
    ds_read_b64_tr_b16 v[144:145], v229 offset:4096
    ds_read_b64_tr_b16 v[146:147], v230 offset:4352
    ds_read_b64_tr_b16 v[148:149], v229 offset:5120
    ds_read_b64_tr_b16 v[150:151], v230 offset:5376
    v_pk_mul_f32 v[112:113], v[112:113], v[204:205]
    v_pk_mul_f32 v[116:117], v[116:117], v[204:205]
    v_pk_mul_f32 v[120:121], v[120:121], v[204:205]
    v_pk_mul_f32 v[124:125], v[124:125], v[204:205]
    v_cvt_pk_bf16_f32 v136, v112, v116
    v_cvt_pk_bf16_f32 v137, v120, v124
    ds_write_b64 v227, v[136:137] offset:6144
    v_cvt_pk_bf16_f32 v138, v113, v117
    v_cvt_pk_bf16_f32 v139, v121, v125
    ds_write_b64 v228, v[138:139] offset:6144
    s_waitcnt lgkmcnt(4)
    buffer_store_dwordx4 v[144:147], v231, s[36:39], s84 offen offset:384 nt
    s_waitcnt lgkmcnt(2)
    buffer_store_dwordx4 v[148:151], v231, s[36:39], s85 offen offset:384 nt
    v_pk_mul_f32 v[114:115], v[114:115], v[206:207]
    v_pk_mul_f32 v[118:119], v[118:119], v[206:207]
    v_pk_mul_f32 v[122:123], v[122:123], v[206:207]
    v_pk_mul_f32 v[126:127], v[126:127], v[206:207]
    v_cvt_pk_bf16_f32 v140, v114, v118
    v_cvt_pk_bf16_f32 v141, v122, v126
    ds_write_b64 v227, v[140:141] offset:6272
    v_cvt_pk_bf16_f32 v142, v115, v119
    v_cvt_pk_bf16_f32 v143, v123, v127
    ds_write_b64 v228, v[142:143] offset:6272
    ds_read_b64_tr_b16 v[152:153], v229 offset:6144
    ds_read_b64_tr_b16 v[154:155], v230 offset:6400
    ds_read_b64_tr_b16 v[156:157], v229 offset:7168
    ds_read_b64_tr_b16 v[158:159], v230 offset:7424
    s_waitcnt lgkmcnt(2)
    buffer_store_dwordx4 v[152:155], v231, s[36:39], s86 offen offset:384 nt
    s_waitcnt lgkmcnt(0)
    buffer_store_dwordx4 v[156:159], v231, s[36:39], s87 offen offset:384 nt
    s_endpgm
L_done:
L_end:
    s_endpgm
L_rare0:
    s_nop 7
    v_and_b32 v220, 48, v216
    v_max3_f32 v217, v128, v129, v130
    v_max3_f32 v217, v217, v131, v136
    v_max3_f32 v217, v217, v137, v138
    v_max_f32 v217, v217, v139
    v_mov_b32 v218, v217
    s_nop 1
    v_permlane32_swap_b32 v217, v218
    s_nop 0
    v_max_f32 v217, v217, v218
    v_mov_b32 v218, v217
    s_nop 1
    v_permlane16_swap_b32 v217, v218
    s_nop 0
    v_max_f32 v217, v217, v218
    v_add_f32 v217, 0x41c00000, v217
    v_max_f32 v217, 0, v217
    v_ceil_f32 v217, v217
    v_sub_f32 v219, 0, v217
    v_exp_f32 v219, v219
    v_sub_f32 v232, v232, v217
    v_sub_f32 v233, v233, v217
    v_sub_f32 v234, v234, v217
    v_sub_f32 v235, v235, v217
    v_sub_f32 v128, v128, v217
    v_sub_f32 v129, v129, v217
    v_sub_f32 v130, v130, v217
    v_sub_f32 v131, v131, v217
    v_sub_f32 v136, v136, v217
    v_sub_f32 v137, v137, v217
    v_sub_f32 v138, v138, v217
    v_sub_f32 v139, v139, v217
    v_sub_f32 v144, v144, v217
    v_sub_f32 v145, v145, v217
    v_sub_f32 v146, v146, v217
    v_sub_f32 v147, v147, v217
    v_sub_f32 v152, v152, v217
    v_sub_f32 v153, v153, v217
    v_sub_f32 v154, v154, v217
    v_sub_f32 v155, v155, v217
    ds_bpermute_b32 v221, v220, v219 offset:0
    ds_bpermute_b32 v222, v220, v219 offset:4
    ds_bpermute_b32 v223, v220, v219 offset:8
    ds_bpermute_b32 v224, v220, v219 offset:12
    s_waitcnt lgkmcnt(0)
    v_mul_f32 v200, v200, v221
    v_mul_f32 v201, v201, v222
    v_mul_f32 v202, v202, v223
    v_mul_f32 v203, v203, v224
    v_mul_f32 v0, v0, v221
    v_mul_f32 v1, v1, v222
    v_mul_f32 v2, v2, v223
    v_mul_f32 v3, v3, v224
    v_mul_f32 v4, v4, v221
    v_mul_f32 v5, v5, v222
    v_mul_f32 v6, v6, v223
    v_mul_f32 v7, v7, v224
    v_mul_f32 v8, v8, v221
    v_mul_f32 v9, v9, v222
    v_mul_f32 v10, v10, v223
    v_mul_f32 v11, v11, v224
    v_mul_f32 v12, v12, v221
    v_mul_f32 v13, v13, v222
    v_mul_f32 v14, v14, v223
    v_mul_f32 v15, v15, v224
    v_mul_f32 v16, v16, v221
    v_mul_f32 v17, v17, v222
    v_mul_f32 v18, v18, v223
    v_mul_f32 v19, v19, v224
    v_mul_f32 v20, v20, v221
    v_mul_f32 v21, v21, v222
    v_mul_f32 v22, v22, v223
    v_mul_f32 v23, v23, v224
    v_mul_f32 v24, v24, v221
    v_mul_f32 v25, v25, v222
    v_mul_f32 v26, v26, v223
    v_mul_f32 v27, v27, v224
    v_mul_f32 v28, v28, v221
    v_mul_f32 v29, v29, v222
    v_mul_f32 v30, v30, v223
    v_mul_f32 v31, v31, v224
    v_mul_f32 v32, v32, v221
    v_mul_f32 v33, v33, v222
    v_mul_f32 v34, v34, v223
    v_mul_f32 v35, v35, v224
    v_mul_f32 v36, v36, v221
    v_mul_f32 v37, v37, v222
    v_mul_f32 v38, v38, v223
    v_mul_f32 v39, v39, v224
    v_mul_f32 v40, v40, v221
    v_mul_f32 v41, v41, v222
    v_mul_f32 v42, v42, v223
    v_mul_f32 v43, v43, v224
    v_mul_f32 v44, v44, v221
    v_mul_f32 v45, v45, v222
    v_mul_f32 v46, v46, v223
    v_mul_f32 v47, v47, v224
    v_mul_f32 v48, v48, v221
    v_mul_f32 v49, v49, v222
    v_mul_f32 v50, v50, v223
    v_mul_f32 v51, v51, v224
    v_mul_f32 v52, v52, v221
    v_mul_f32 v53, v53, v222
    v_mul_f32 v54, v54, v223
    v_mul_f32 v55, v55, v224
    v_mul_f32 v56, v56, v221
    v_mul_f32 v57, v57, v222
    v_mul_f32 v58, v58, v223
    v_mul_f32 v59, v59, v224
    v_mul_f32 v60, v60, v221
    v_mul_f32 v61, v61, v222
    v_mul_f32 v62, v62, v223
    v_mul_f32 v63, v63, v224
    v_max3_f32 v217, v132, v133, v134
    v_max3_f32 v217, v217, v135, v140
    v_max3_f32 v217, v217, v141, v142
    v_max_f32 v217, v217, v143
    v_mov_b32 v218, v217
    s_nop 1
    v_permlane32_swap_b32 v217, v218
    s_nop 0
    v_max_f32 v217, v217, v218
    v_mov_b32 v218, v217
    s_nop 1
    v_permlane16_swap_b32 v217, v218
    s_nop 0
    v_max_f32 v217, v217, v218
    v_add_f32 v217, 0x41c00000, v217
    v_max_f32 v217, 0, v217
    v_ceil_f32 v217, v217
    v_sub_f32 v219, 0, v217
    v_exp_f32 v219, v219
    v_sub_f32 v236, v236, v217
    v_sub_f32 v237, v237, v217
    v_sub_f32 v238, v238, v217
    v_sub_f32 v239, v239, v217
    v_sub_f32 v132, v132, v217
    v_sub_f32 v133, v133, v217
    v_sub_f32 v134, v134, v217
    v_sub_f32 v135, v135, v217
    v_sub_f32 v140, v140, v217
    v_sub_f32 v141, v141, v217
    v_sub_f32 v142, v142, v217
    v_sub_f32 v143, v143, v217
    v_sub_f32 v148, v148, v217
    v_sub_f32 v149, v149, v217
    v_sub_f32 v150, v150, v217
    v_sub_f32 v151, v151, v217
    v_sub_f32 v156, v156, v217
    v_sub_f32 v157, v157, v217
    v_sub_f32 v158, v158, v217
    v_sub_f32 v159, v159, v217
    ds_bpermute_b32 v221, v220, v219 offset:0
    ds_bpermute_b32 v222, v220, v219 offset:4
    ds_bpermute_b32 v223, v220, v219 offset:8
    ds_bpermute_b32 v224, v220, v219 offset:12
    s_waitcnt lgkmcnt(0)
    v_mul_f32 v204, v204, v221
    v_mul_f32 v205, v205, v222
    v_mul_f32 v206, v206, v223
    v_mul_f32 v207, v207, v224
    v_mul_f32 v64, v64, v221
    v_mul_f32 v65, v65, v222
    v_mul_f32 v66, v66, v223
    v_mul_f32 v67, v67, v224
    v_mul_f32 v68, v68, v221
    v_mul_f32 v69, v69, v222
    v_mul_f32 v70, v70, v223
    v_mul_f32 v71, v71, v224
    v_mul_f32 v72, v72, v221
    v_mul_f32 v73, v73, v222
    v_mul_f32 v74, v74, v223
    v_mul_f32 v75, v75, v224
    v_mul_f32 v76, v76, v221
    v_mul_f32 v77, v77, v222
    v_mul_f32 v78, v78, v223
    v_mul_f32 v79, v79, v224
    v_mul_f32 v80, v80, v221
    v_mul_f32 v81, v81, v222
    v_mul_f32 v82, v82, v223
    v_mul_f32 v83, v83, v224
    v_mul_f32 v84, v84, v221
    v_mul_f32 v85, v85, v222
    v_mul_f32 v86, v86, v223
    v_mul_f32 v87, v87, v224
    v_mul_f32 v88, v88, v221
    v_mul_f32 v89, v89, v222
    v_mul_f32 v90, v90, v223
    v_mul_f32 v91, v91, v224
    v_mul_f32 v92, v92, v221
    v_mul_f32 v93, v93, v222
    v_mul_f32 v94, v94, v223
    v_mul_f32 v95, v95, v224
    v_mul_f32 v96, v96, v221
    v_mul_f32 v97, v97, v222
    v_mul_f32 v98, v98, v223
    v_mul_f32 v99, v99, v224
    v_mul_f32 v100, v100, v221
    v_mul_f32 v101, v101, v222
    v_mul_f32 v102, v102, v223
    v_mul_f32 v103, v103, v224
    v_mul_f32 v104, v104, v221
    v_mul_f32 v105, v105, v222
    v_mul_f32 v106, v106, v223
    v_mul_f32 v107, v107, v224
    v_mul_f32 v108, v108, v221
    v_mul_f32 v109, v109, v222
    v_mul_f32 v110, v110, v223
    v_mul_f32 v111, v111, v224
    v_mul_f32 v112, v112, v221
    v_mul_f32 v113, v113, v222
    v_mul_f32 v114, v114, v223
    v_mul_f32 v115, v115, v224
    v_mul_f32 v116, v116, v221
    v_mul_f32 v117, v117, v222
    v_mul_f32 v118, v118, v223
    v_mul_f32 v119, v119, v224
    v_mul_f32 v120, v120, v221
    v_mul_f32 v121, v121, v222
    v_mul_f32 v122, v122, v223
    v_mul_f32 v123, v123, v224
    v_mul_f32 v124, v124, v221
    v_mul_f32 v125, v125, v222
    v_mul_f32 v126, v126, v223
    v_mul_f32 v127, v127, v224
    v_exp_f32 v208, v128
    s_nop 0
    v_exp_f32 v209, v129
    s_nop 0
    v_exp_f32 v210, v130
    s_nop 0
    v_cvt_pk_bf16_f32 v160, v208, v209
    v_exp_f32 v211, v131
    s_nop 0
    v_exp_f32 v212, v136
    s_nop 0
    v_cvt_pk_bf16_f32 v161, v210, v211
    v_exp_f32 v213, v137
    s_nop 0
    v_exp_f32 v214, v138
    s_nop 0
    v_cvt_pk_bf16_f32 v162, v212, v213
    v_exp_f32 v215, v139
    s_nop 0
    v_exp_f32 v208, v132
    s_nop 0
    v_cvt_pk_bf16_f32 v163, v214, v215
    v_or3_b32 v197, v160, v161, v162
    v_exp_f32 v209, v133
    s_nop 0
    v_exp_f32 v210, v134
    s_nop 0
    v_cvt_pk_bf16_f32 v164, v208, v209
    v_exp_f32 v211, v135
    s_nop 0
    v_exp_f32 v212, v140
    s_nop 0
    v_cvt_pk_bf16_f32 v165, v210, v211
    v_or3_b32 v197, v197, v163, v164
    v_exp_f32 v213, v141
    s_nop 0
    v_exp_f32 v214, v142
    s_nop 0
    v_cvt_pk_bf16_f32 v166, v212, v213
    v_exp_f32 v215, v143
    s_nop 0
    v_or3_b32 v197, v197, v165, v166
    v_cvt_pk_bf16_f32 v167, v214, v215
    v_or_b32 v197, v197, v167
    v_and_b32 v197, s48, v197
    v_cmp_ne_u32 vcc, 0, v197
    s_nop 1
    s_branch L_back0
L_rare1:
    s_nop 7
    v_and_b32 v220, 48, v216
    v_max3_f32 v217, v144, v145, v146
    v_max3_f32 v217, v217, v147, v152
    v_max3_f32 v217, v217, v153, v154
    v_max_f32 v217, v217, v155
    v_mov_b32 v218, v217
    s_nop 1
    v_permlane32_swap_b32 v217, v218
    s_nop 0
    v_max_f32 v217, v217, v218
    v_mov_b32 v218, v217
    s_nop 1
    v_permlane16_swap_b32 v217, v218
    s_nop 0
    v_max_f32 v217, v217, v218
    v_add_f32 v217, 0x41c00000, v217
    v_max_f32 v217, 0, v217
    v_ceil_f32 v217, v217
    v_sub_f32 v219, 0, v217
    v_exp_f32 v219, v219
    v_sub_f32 v232, v232, v217
    v_sub_f32 v233, v233, v217
    v_sub_f32 v234, v234, v217
    v_sub_f32 v235, v235, v217
    v_sub_f32 v128, v128, v217
    v_sub_f32 v129, v129, v217
    v_sub_f32 v130, v130, v217
    v_sub_f32 v131, v131, v217
    v_sub_f32 v136, v136, v217
    v_sub_f32 v137, v137, v217
    v_sub_f32 v138, v138, v217
    v_sub_f32 v139, v139, v217
    v_sub_f32 v144, v144, v217
    v_sub_f32 v145, v145, v217
    v_sub_f32 v146, v146, v217
    v_sub_f32 v147, v147, v217
    v_sub_f32 v152, v152, v217
    v_sub_f32 v153, v153, v217
    v_sub_f32 v154, v154, v217
    v_sub_f32 v155, v155, v217
    ds_bpermute_b32 v221, v220, v219 offset:0
    ds_bpermute_b32 v222, v220, v219 offset:4
    ds_bpermute_b32 v223, v220, v219 offset:8
    ds_bpermute_b32 v224, v220, v219 offset:12
    s_waitcnt lgkmcnt(0)
    v_mul_f32 v200, v200, v221
    v_mul_f32 v201, v201, v222
    v_mul_f32 v202, v202, v223
    v_mul_f32 v203, v203, v224
    v_mul_f32 v0, v0, v221
    v_mul_f32 v1, v1, v222
    v_mul_f32 v2, v2, v223
    v_mul_f32 v3, v3, v224
    v_mul_f32 v4, v4, v221
    v_mul_f32 v5, v5, v222
    v_mul_f32 v6, v6, v223
    v_mul_f32 v7, v7, v224
    v_mul_f32 v8, v8, v221
    v_mul_f32 v9, v9, v222
    v_mul_f32 v10, v10, v223
    v_mul_f32 v11, v11, v224
    v_mul_f32 v12, v12, v221
    v_mul_f32 v13, v13, v222
    v_mul_f32 v14, v14, v223
    v_mul_f32 v15, v15, v224
    v_mul_f32 v16, v16, v221
    v_mul_f32 v17, v17, v222
    v_mul_f32 v18, v18, v223
    v_mul_f32 v19, v19, v224
    v_mul_f32 v20, v20, v221
    v_mul_f32 v21, v21, v222
    v_mul_f32 v22, v22, v223
    v_mul_f32 v23, v23, v224
    v_mul_f32 v24, v24, v221
    v_mul_f32 v25, v25, v222
    v_mul_f32 v26, v26, v223
    v_mul_f32 v27, v27, v224
    v_mul_f32 v28, v28, v221
    v_mul_f32 v29, v29, v222
    v_mul_f32 v30, v30, v223
    v_mul_f32 v31, v31, v224
    v_mul_f32 v32, v32, v221
    v_mul_f32 v33, v33, v222
    v_mul_f32 v34, v34, v223
    v_mul_f32 v35, v35, v224
    v_mul_f32 v36, v36, v221
    v_mul_f32 v37, v37, v222
    v_mul_f32 v38, v38, v223
    v_mul_f32 v39, v39, v224
    v_mul_f32 v40, v40, v221
    v_mul_f32 v41, v41, v222
    v_mul_f32 v42, v42, v223
    v_mul_f32 v43, v43, v224
    v_mul_f32 v44, v44, v221
    v_mul_f32 v45, v45, v222
    v_mul_f32 v46, v46, v223
    v_mul_f32 v47, v47, v224
    v_mul_f32 v48, v48, v221
    v_mul_f32 v49, v49, v222
    v_mul_f32 v50, v50, v223
    v_mul_f32 v51, v51, v224
    v_mul_f32 v52, v52, v221
    v_mul_f32 v53, v53, v222
    v_mul_f32 v54, v54, v223
    v_mul_f32 v55, v55, v224
    v_mul_f32 v56, v56, v221
    v_mul_f32 v57, v57, v222
    v_mul_f32 v58, v58, v223
    v_mul_f32 v59, v59, v224
    v_mul_f32 v60, v60, v221
    v_mul_f32 v61, v61, v222
    v_mul_f32 v62, v62, v223
    v_mul_f32 v63, v63, v224
    v_max3_f32 v217, v148, v149, v150
    v_max3_f32 v217, v217, v151, v156
    v_max3_f32 v217, v217, v157, v158
    v_max_f32 v217, v217, v159
    v_mov_b32 v218, v217
    s_nop 1
    v_permlane32_swap_b32 v217, v218
    s_nop 0
    v_max_f32 v217, v217, v218
    v_mov_b32 v218, v217
    s_nop 1
    v_permlane16_swap_b32 v217, v218
    s_nop 0
    v_max_f32 v217, v217, v218
    v_add_f32 v217, 0x41c00000, v217
    v_max_f32 v217, 0, v217
    v_ceil_f32 v217, v217
    v_sub_f32 v219, 0, v217
    v_exp_f32 v219, v219
    v_sub_f32 v236, v236, v217
    v_sub_f32 v237, v237, v217
    v_sub_f32 v238, v238, v217
    v_sub_f32 v239, v239, v217
    v_sub_f32 v132, v132, v217
    v_sub_f32 v133, v133, v217
    v_sub_f32 v134, v134, v217
    v_sub_f32 v135, v135, v217
    v_sub_f32 v140, v140, v217
    v_sub_f32 v141, v141, v217
    v_sub_f32 v142, v142, v217
    v_sub_f32 v143, v143, v217
    v_sub_f32 v148, v148, v217
    v_sub_f32 v149, v149, v217
    v_sub_f32 v150, v150, v217
    v_sub_f32 v151, v151, v217
    v_sub_f32 v156, v156, v217
    v_sub_f32 v157, v157, v217
    v_sub_f32 v158, v158, v217
    v_sub_f32 v159, v159, v217
    ds_bpermute_b32 v221, v220, v219 offset:0
    ds_bpermute_b32 v222, v220, v219 offset:4
    ds_bpermute_b32 v223, v220, v219 offset:8
    ds_bpermute_b32 v224, v220, v219 offset:12
    s_waitcnt lgkmcnt(0)
    v_mul_f32 v204, v204, v221
    v_mul_f32 v205, v205, v222
    v_mul_f32 v206, v206, v223
    v_mul_f32 v207, v207, v224
    v_mul_f32 v64, v64, v221
    v_mul_f32 v65, v65, v222
    v_mul_f32 v66, v66, v223
    v_mul_f32 v67, v67, v224
    v_mul_f32 v68, v68, v221
    v_mul_f32 v69, v69, v222
    v_mul_f32 v70, v70, v223
    v_mul_f32 v71, v71, v224
    v_mul_f32 v72, v72, v221
    v_mul_f32 v73, v73, v222
    v_mul_f32 v74, v74, v223
    v_mul_f32 v75, v75, v224
    v_mul_f32 v76, v76, v221
    v_mul_f32 v77, v77, v222
    v_mul_f32 v78, v78, v223
    v_mul_f32 v79, v79, v224
    v_mul_f32 v80, v80, v221
    v_mul_f32 v81, v81, v222
    v_mul_f32 v82, v82, v223
    v_mul_f32 v83, v83, v224
    v_mul_f32 v84, v84, v221
    v_mul_f32 v85, v85, v222
    v_mul_f32 v86, v86, v223
    v_mul_f32 v87, v87, v224
    v_mul_f32 v88, v88, v221
    v_mul_f32 v89, v89, v222
    v_mul_f32 v90, v90, v223
    v_mul_f32 v91, v91, v224
    v_mul_f32 v92, v92, v221
    v_mul_f32 v93, v93, v222
    v_mul_f32 v94, v94, v223
    v_mul_f32 v95, v95, v224
    v_mul_f32 v96, v96, v221
    v_mul_f32 v97, v97, v222
    v_mul_f32 v98, v98, v223
    v_mul_f32 v99, v99, v224
    v_mul_f32 v100, v100, v221
    v_mul_f32 v101, v101, v222
    v_mul_f32 v102, v102, v223
    v_mul_f32 v103, v103, v224
    v_mul_f32 v104, v104, v221
    v_mul_f32 v105, v105, v222
    v_mul_f32 v106, v106, v223
    v_mul_f32 v107, v107, v224
    v_mul_f32 v108, v108, v221
    v_mul_f32 v109, v109, v222
    v_mul_f32 v110, v110, v223
    v_mul_f32 v111, v111, v224
    v_mul_f32 v112, v112, v221
    v_mul_f32 v113, v113, v222
    v_mul_f32 v114, v114, v223
    v_mul_f32 v115, v115, v224
    v_mul_f32 v116, v116, v221
    v_mul_f32 v117, v117, v222
    v_mul_f32 v118, v118, v223
    v_mul_f32 v119, v119, v224
    v_mul_f32 v120, v120, v221
    v_mul_f32 v121, v121, v222
    v_mul_f32 v122, v122, v223
    v_mul_f32 v123, v123, v224
    v_mul_f32 v124, v124, v221
    v_mul_f32 v125, v125, v222
    v_mul_f32 v126, v126, v223
    v_mul_f32 v127, v127, v224
    v_exp_f32 v208, v144
    s_nop 0
    v_exp_f32 v209, v145
    s_nop 0
    v_exp_f32 v210, v146
    s_nop 0
    v_cvt_pk_bf16_f32 v168, v208, v209
    v_exp_f32 v211, v147
    s_nop 0
    v_exp_f32 v212, v152
    s_nop 0
    v_cvt_pk_bf16_f32 v169, v210, v211
    v_exp_f32 v213, v153
    s_nop 0
    v_exp_f32 v214, v154
    s_nop 0
    v_cvt_pk_bf16_f32 v170, v212, v213
    v_exp_f32 v215, v155
    s_nop 0
    v_exp_f32 v208, v148
    s_nop 0
    v_cvt_pk_bf16_f32 v171, v214, v215
    v_or3_b32 v197, v168, v169, v170
    v_exp_f32 v209, v149
    s_nop 0
    v_exp_f32 v210, v150
    s_nop 0
    v_cvt_pk_bf16_f32 v172, v208, v209
    v_exp_f32 v211, v151
    s_nop 0
    v_exp_f32 v212, v156
    s_nop 0
    v_cvt_pk_bf16_f32 v173, v210, v211
    v_or3_b32 v197, v197, v171, v172
    v_exp_f32 v213, v157
    s_nop 0
    v_exp_f32 v214, v158
    s_nop 0
    v_cvt_pk_bf16_f32 v174, v212, v213
    v_exp_f32 v215, v159
    s_nop 0
    v_or3_b32 v197, v197, v173, v174
    v_cvt_pk_bf16_f32 v175, v214, v215
    v_or_b32 v197, v197, v175
    v_and_b32 v197, s48, v197
    v_cmp_ne_u32 vcc, 0, v197
    s_nop 1
    s_branch L_back1
L_rare2:
    s_nop 7
    v_and_b32 v220, 48, v216
    v_max3_f32 v217, v128, v129, v130
    v_max3_f32 v217, v217, v131, v136
    v_max3_f32 v217, v217, v137, v138
    v_max_f32 v217, v217, v139
    v_mov_b32 v218, v217
    s_nop 1
    v_permlane32_swap_b32 v217, v218
    s_nop 0
    v_max_f32 v217, v217, v218
    v_mov_b32 v218, v217
    s_nop 1
    v_permlane16_swap_b32 v217, v218
    s_nop 0
    v_max_f32 v217, v217, v218
    v_add_f32 v217, 0x41c00000, v217
    v_max_f32 v217, 0, v217
    v_ceil_f32 v217, v217
    v_sub_f32 v219, 0, v217
    v_exp_f32 v219, v219
    v_sub_f32 v232, v232, v217
    v_sub_f32 v233, v233, v217
    v_sub_f32 v234, v234, v217
    v_sub_f32 v235, v235, v217
    v_sub_f32 v128, v128, v217
    v_sub_f32 v129, v129, v217
    v_sub_f32 v130, v130, v217
    v_sub_f32 v131, v131, v217
    v_sub_f32 v136, v136, v217
    v_sub_f32 v137, v137, v217
    v_sub_f32 v138, v138, v217
    v_sub_f32 v139, v139, v217
    v_sub_f32 v144, v144, v217
    v_sub_f32 v145, v145, v217
    v_sub_f32 v146, v146, v217
    v_sub_f32 v147, v147, v217
    v_sub_f32 v152, v152, v217
    v_sub_f32 v153, v153, v217
    v_sub_f32 v154, v154, v217
    v_sub_f32 v155, v155, v217
    ds_bpermute_b32 v221, v220, v219 offset:0
    ds_bpermute_b32 v222, v220, v219 offset:4
    ds_bpermute_b32 v223, v220, v219 offset:8
    ds_bpermute_b32 v224, v220, v219 offset:12
    s_waitcnt lgkmcnt(0)
    v_mul_f32 v200, v200, v221
    v_mul_f32 v201, v201, v222
    v_mul_f32 v202, v202, v223
    v_mul_f32 v203, v203, v224
    v_mul_f32 v0, v0, v221
    v_mul_f32 v1, v1, v222
    v_mul_f32 v2, v2, v223
    v_mul_f32 v3, v3, v224
    v_mul_f32 v4, v4, v221
    v_mul_f32 v5, v5, v222
    v_mul_f32 v6, v6, v223
    v_mul_f32 v7, v7, v224
    v_mul_f32 v8, v8, v221
    v_mul_f32 v9, v9, v222
    v_mul_f32 v10, v10, v223
    v_mul_f32 v11, v11, v224
    v_mul_f32 v12, v12, v221
    v_mul_f32 v13, v13, v222
    v_mul_f32 v14, v14, v223
    v_mul_f32 v15, v15, v224
    v_mul_f32 v16, v16, v221
    v_mul_f32 v17, v17, v222
    v_mul_f32 v18, v18, v223
    v_mul_f32 v19, v19, v224
    v_mul_f32 v20, v20, v221
    v_mul_f32 v21, v21, v222
    v_mul_f32 v22, v22, v223
    v_mul_f32 v23, v23, v224
    v_mul_f32 v24, v24, v221
    v_mul_f32 v25, v25, v222
    v_mul_f32 v26, v26, v223
    v_mul_f32 v27, v27, v224
    v_mul_f32 v28, v28, v221
    v_mul_f32 v29, v29, v222
    v_mul_f32 v30, v30, v223
    v_mul_f32 v31, v31, v224
    v_mul_f32 v32, v32, v221
    v_mul_f32 v33, v33, v222
    v_mul_f32 v34, v34, v223
    v_mul_f32 v35, v35, v224
    v_mul_f32 v36, v36, v221
    v_mul_f32 v37, v37, v222
    v_mul_f32 v38, v38, v223
    v_mul_f32 v39, v39, v224
    v_mul_f32 v40, v40, v221
    v_mul_f32 v41, v41, v222
    v_mul_f32 v42, v42, v223
    v_mul_f32 v43, v43, v224
    v_mul_f32 v44, v44, v221
    v_mul_f32 v45, v45, v222
    v_mul_f32 v46, v46, v223
    v_mul_f32 v47, v47, v224
    v_mul_f32 v48, v48, v221
    v_mul_f32 v49, v49, v222
    v_mul_f32 v50, v50, v223
    v_mul_f32 v51, v51, v224
    v_mul_f32 v52, v52, v221
    v_mul_f32 v53, v53, v222
    v_mul_f32 v54, v54, v223
    v_mul_f32 v55, v55, v224
    v_mul_f32 v56, v56, v221
    v_mul_f32 v57, v57, v222
    v_mul_f32 v58, v58, v223
    v_mul_f32 v59, v59, v224
    v_mul_f32 v60, v60, v221
    v_mul_f32 v61, v61, v222
    v_mul_f32 v62, v62, v223
    v_mul_f32 v63, v63, v224
    v_max3_f32 v217, v132, v133, v134
    v_max3_f32 v217, v217, v135, v140
    v_max3_f32 v217, v217, v141, v142
    v_max_f32 v217, v217, v143
    v_mov_b32 v218, v217
    s_nop 1
    v_permlane32_swap_b32 v217, v218
    s_nop 0
    v_max_f32 v217, v217, v218
    v_mov_b32 v218, v217
    s_nop 1
    v_permlane16_swap_b32 v217, v218
    s_nop 0
    v_max_f32 v217, v217, v218
    v_add_f32 v217, 0x41c00000, v217
    v_max_f32 v217, 0, v217
    v_ceil_f32 v217, v217
    v_sub_f32 v219, 0, v217
    v_exp_f32 v219, v219
    v_sub_f32 v236, v236, v217
    v_sub_f32 v237, v237, v217
    v_sub_f32 v238, v238, v217
    v_sub_f32 v239, v239, v217
    v_sub_f32 v132, v132, v217
    v_sub_f32 v133, v133, v217
    v_sub_f32 v134, v134, v217
    v_sub_f32 v135, v135, v217
    v_sub_f32 v140, v140, v217
    v_sub_f32 v141, v141, v217
    v_sub_f32 v142, v142, v217
    v_sub_f32 v143, v143, v217
    v_sub_f32 v148, v148, v217
    v_sub_f32 v149, v149, v217
    v_sub_f32 v150, v150, v217
    v_sub_f32 v151, v151, v217
    v_sub_f32 v156, v156, v217
    v_sub_f32 v157, v157, v217
    v_sub_f32 v158, v158, v217
    v_sub_f32 v159, v159, v217
    ds_bpermute_b32 v221, v220, v219 offset:0
    ds_bpermute_b32 v222, v220, v219 offset:4
    ds_bpermute_b32 v223, v220, v219 offset:8
    ds_bpermute_b32 v224, v220, v219 offset:12
    s_waitcnt lgkmcnt(0)
    v_mul_f32 v204, v204, v221
    v_mul_f32 v205, v205, v222
    v_mul_f32 v206, v206, v223
    v_mul_f32 v207, v207, v224
    v_mul_f32 v64, v64, v221
    v_mul_f32 v65, v65, v222
    v_mul_f32 v66, v66, v223
    v_mul_f32 v67, v67, v224
    v_mul_f32 v68, v68, v221
    v_mul_f32 v69, v69, v222
    v_mul_f32 v70, v70, v223
    v_mul_f32 v71, v71, v224
    v_mul_f32 v72, v72, v221
    v_mul_f32 v73, v73, v222
    v_mul_f32 v74, v74, v223
    v_mul_f32 v75, v75, v224
    v_mul_f32 v76, v76, v221
    v_mul_f32 v77, v77, v222
    v_mul_f32 v78, v78, v223
    v_mul_f32 v79, v79, v224
    v_mul_f32 v80, v80, v221
    v_mul_f32 v81, v81, v222
    v_mul_f32 v82, v82, v223
    v_mul_f32 v83, v83, v224
    v_mul_f32 v84, v84, v221
    v_mul_f32 v85, v85, v222
    v_mul_f32 v86, v86, v223
    v_mul_f32 v87, v87, v224
    v_mul_f32 v88, v88, v221
    v_mul_f32 v89, v89, v222
    v_mul_f32 v90, v90, v223
    v_mul_f32 v91, v91, v224
    v_mul_f32 v92, v92, v221
    v_mul_f32 v93, v93, v222
    v_mul_f32 v94, v94, v223
    v_mul_f32 v95, v95, v224
    v_mul_f32 v96, v96, v221
    v_mul_f32 v97, v97, v222
    v_mul_f32 v98, v98, v223
    v_mul_f32 v99, v99, v224
    v_mul_f32 v100, v100, v221
    v_mul_f32 v101, v101, v222
    v_mul_f32 v102, v102, v223
    v_mul_f32 v103, v103, v224
    v_mul_f32 v104, v104, v221
    v_mul_f32 v105, v105, v222
    v_mul_f32 v106, v106, v223
    v_mul_f32 v107, v107, v224
    v_mul_f32 v108, v108, v221
    v_mul_f32 v109, v109, v222
    v_mul_f32 v110, v110, v223
    v_mul_f32 v111, v111, v224
    v_mul_f32 v112, v112, v221
    v_mul_f32 v113, v113, v222
    v_mul_f32 v114, v114, v223
    v_mul_f32 v115, v115, v224
    v_mul_f32 v116, v116, v221
    v_mul_f32 v117, v117, v222
    v_mul_f32 v118, v118, v223
    v_mul_f32 v119, v119, v224
    v_mul_f32 v120, v120, v221
    v_mul_f32 v121, v121, v222
    v_mul_f32 v122, v122, v223
    v_mul_f32 v123, v123, v224
    v_mul_f32 v124, v124, v221
    v_mul_f32 v125, v125, v222
    v_mul_f32 v126, v126, v223
    v_mul_f32 v127, v127, v224
    v_exp_f32 v208, v128
    s_nop 0
    v_exp_f32 v209, v129
    s_nop 0
    v_exp_f32 v210, v130
    s_nop 0
    v_cvt_pk_bf16_f32 v160, v208, v209
    v_exp_f32 v211, v131
    s_nop 0
    v_exp_f32 v212, v136
    s_nop 0
    v_cvt_pk_bf16_f32 v161, v210, v211
    v_exp_f32 v213, v137
    s_nop 0
    v_exp_f32 v214, v138
    s_nop 0
    v_cvt_pk_bf16_f32 v162, v212, v213
    v_exp_f32 v215, v139
    s_nop 0
    v_exp_f32 v208, v132
    s_nop 0
    v_cvt_pk_bf16_f32 v163, v214, v215
    v_or3_b32 v197, v160, v161, v162
    v_exp_f32 v209, v133
    s_nop 0
    v_exp_f32 v210, v134
    s_nop 0
    v_cvt_pk_bf16_f32 v164, v208, v209
    v_exp_f32 v211, v135
    s_nop 0
    v_exp_f32 v212, v140
    s_nop 0
    v_cvt_pk_bf16_f32 v165, v210, v211
    v_or3_b32 v197, v197, v163, v164
    v_exp_f32 v213, v141
    s_nop 0
    v_exp_f32 v214, v142
    s_nop 0
    v_cvt_pk_bf16_f32 v166, v212, v213
    v_exp_f32 v215, v143
    s_nop 0
    v_or3_b32 v197, v197, v165, v166
    v_cvt_pk_bf16_f32 v167, v214, v215
    v_or_b32 v197, v197, v167
    v_and_b32 v197, s48, v197
    v_cmp_ne_u32 vcc, 0, v197
    s_nop 1
    s_branch L_back2
L_rare3:
    s_nop 7
    v_and_b32 v220, 48, v216
    v_max3_f32 v217, v144, v145, v146
    v_max3_f32 v217, v217, v147, v152
    v_max3_f32 v217, v217, v153, v154
    v_max_f32 v217, v217, v155
    v_mov_b32 v218, v217
    s_nop 1
    v_permlane32_swap_b32 v217, v218
    s_nop 0
    v_max_f32 v217, v217, v218
    v_mov_b32 v218, v217
    s_nop 1
    v_permlane16_swap_b32 v217, v218
    s_nop 0
    v_max_f32 v217, v217, v218
    v_add_f32 v217, 0x41c00000, v217
    v_max_f32 v217, 0, v217
    v_ceil_f32 v217, v217
    v_sub_f32 v219, 0, v217
    v_exp_f32 v219, v219
    v_sub_f32 v232, v232, v217
    v_sub_f32 v233, v233, v217
    v_sub_f32 v234, v234, v217
    v_sub_f32 v235, v235, v217
    v_sub_f32 v128, v128, v217
    v_sub_f32 v129, v129, v217
    v_sub_f32 v130, v130, v217
    v_sub_f32 v131, v131, v217
    v_sub_f32 v136, v136, v217
    v_sub_f32 v137, v137, v217
    v_sub_f32 v138, v138, v217
    v_sub_f32 v139, v139, v217
    v_sub_f32 v144, v144, v217
    v_sub_f32 v145, v145, v217
    v_sub_f32 v146, v146, v217
    v_sub_f32 v147, v147, v217
    v_sub_f32 v152, v152, v217
    v_sub_f32 v153, v153, v217
    v_sub_f32 v154, v154, v217
    v_sub_f32 v155, v155, v217
    ds_bpermute_b32 v221, v220, v219 offset:0
    ds_bpermute_b32 v222, v220, v219 offset:4
    ds_bpermute_b32 v223, v220, v219 offset:8
    ds_bpermute_b32 v224, v220, v219 offset:12
    s_waitcnt lgkmcnt(0)
    v_mul_f32 v200, v200, v221
    v_mul_f32 v201, v201, v222
    v_mul_f32 v202, v202, v223
    v_mul_f32 v203, v203, v224
    v_mul_f32 v0, v0, v221
    v_mul_f32 v1, v1, v222
    v_mul_f32 v2, v2, v223
    v_mul_f32 v3, v3, v224
    v_mul_f32 v4, v4, v221
    v_mul_f32 v5, v5, v222
    v_mul_f32 v6, v6, v223
    v_mul_f32 v7, v7, v224
    v_mul_f32 v8, v8, v221
    v_mul_f32 v9, v9, v222
    v_mul_f32 v10, v10, v223
    v_mul_f32 v11, v11, v224
    v_mul_f32 v12, v12, v221
    v_mul_f32 v13, v13, v222
    v_mul_f32 v14, v14, v223
    v_mul_f32 v15, v15, v224
    v_mul_f32 v16, v16, v221
    v_mul_f32 v17, v17, v222
    v_mul_f32 v18, v18, v223
    v_mul_f32 v19, v19, v224
    v_mul_f32 v20, v20, v221
    v_mul_f32 v21, v21, v222
    v_mul_f32 v22, v22, v223
    v_mul_f32 v23, v23, v224
    v_mul_f32 v24, v24, v221
    v_mul_f32 v25, v25, v222
    v_mul_f32 v26, v26, v223
    v_mul_f32 v27, v27, v224
    v_mul_f32 v28, v28, v221
    v_mul_f32 v29, v29, v222
    v_mul_f32 v30, v30, v223
    v_mul_f32 v31, v31, v224
    v_mul_f32 v32, v32, v221
    v_mul_f32 v33, v33, v222
    v_mul_f32 v34, v34, v223
    v_mul_f32 v35, v35, v224
    v_mul_f32 v36, v36, v221
    v_mul_f32 v37, v37, v222
    v_mul_f32 v38, v38, v223
    v_mul_f32 v39, v39, v224
    v_mul_f32 v40, v40, v221
    v_mul_f32 v41, v41, v222
    v_mul_f32 v42, v42, v223
    v_mul_f32 v43, v43, v224
    v_mul_f32 v44, v44, v221
    v_mul_f32 v45, v45, v222
    v_mul_f32 v46, v46, v223
    v_mul_f32 v47, v47, v224
    v_mul_f32 v48, v48, v221
    v_mul_f32 v49, v49, v222
    v_mul_f32 v50, v50, v223
    v_mul_f32 v51, v51, v224
    v_mul_f32 v52, v52, v221
    v_mul_f32 v53, v53, v222
    v_mul_f32 v54, v54, v223
    v_mul_f32 v55, v55, v224
    v_mul_f32 v56, v56, v221
    v_mul_f32 v57, v57, v222
    v_mul_f32 v58, v58, v223
    v_mul_f32 v59, v59, v224
    v_mul_f32 v60, v60, v221
    v_mul_f32 v61, v61, v222
    v_mul_f32 v62, v62, v223
    v_mul_f32 v63, v63, v224
    v_max3_f32 v217, v148, v149, v150
    v_max3_f32 v217, v217, v151, v156
    v_max3_f32 v217, v217, v157, v158
    v_max_f32 v217, v217, v159
    v_mov_b32 v218, v217
    s_nop 1
    v_permlane32_swap_b32 v217, v218
    s_nop 0
    v_max_f32 v217, v217, v218
    v_mov_b32 v218, v217
    s_nop 1
    v_permlane16_swap_b32 v217, v218
    s_nop 0
    v_max_f32 v217, v217, v218
    v_add_f32 v217, 0x41c00000, v217
    v_max_f32 v217, 0, v217
    v_ceil_f32 v217, v217
    v_sub_f32 v219, 0, v217
    v_exp_f32 v219, v219
    v_sub_f32 v236, v236, v217
    v_sub_f32 v237, v237, v217
    v_sub_f32 v238, v238, v217
    v_sub_f32 v239, v239, v217
    v_sub_f32 v132, v132, v217
    v_sub_f32 v133, v133, v217
    v_sub_f32 v134, v134, v217
    v_sub_f32 v135, v135, v217
    v_sub_f32 v140, v140, v217
    v_sub_f32 v141, v141, v217
    v_sub_f32 v142, v142, v217
    v_sub_f32 v143, v143, v217
    v_sub_f32 v148, v148, v217
    v_sub_f32 v149, v149, v217
    v_sub_f32 v150, v150, v217
    v_sub_f32 v151, v151, v217
    v_sub_f32 v156, v156, v217
    v_sub_f32 v157, v157, v217
    v_sub_f32 v158, v158, v217
    v_sub_f32 v159, v159, v217
    ds_bpermute_b32 v221, v220, v219 offset:0
    ds_bpermute_b32 v222, v220, v219 offset:4
    ds_bpermute_b32 v223, v220, v219 offset:8
    ds_bpermute_b32 v224, v220, v219 offset:12
    s_waitcnt lgkmcnt(0)
    v_mul_f32 v204, v204, v221
    v_mul_f32 v205, v205, v222
    v_mul_f32 v206, v206, v223
    v_mul_f32 v207, v207, v224
    v_mul_f32 v64, v64, v221
    v_mul_f32 v65, v65, v222
    v_mul_f32 v66, v66, v223
    v_mul_f32 v67, v67, v224
    v_mul_f32 v68, v68, v221
    v_mul_f32 v69, v69, v222
    v_mul_f32 v70, v70, v223
    v_mul_f32 v71, v71, v224
    v_mul_f32 v72, v72, v221
    v_mul_f32 v73, v73, v222
    v_mul_f32 v74, v74, v223
    v_mul_f32 v75, v75, v224
    v_mul_f32 v76, v76, v221
    v_mul_f32 v77, v77, v222
    v_mul_f32 v78, v78, v223
    v_mul_f32 v79, v79, v224
    v_mul_f32 v80, v80, v221
    v_mul_f32 v81, v81, v222
    v_mul_f32 v82, v82, v223
    v_mul_f32 v83, v83, v224
    v_mul_f32 v84, v84, v221
    v_mul_f32 v85, v85, v222
    v_mul_f32 v86, v86, v223
    v_mul_f32 v87, v87, v224
    v_mul_f32 v88, v88, v221
    v_mul_f32 v89, v89, v222
    v_mul_f32 v90, v90, v223
    v_mul_f32 v91, v91, v224
    v_mul_f32 v92, v92, v221
    v_mul_f32 v93, v93, v222
    v_mul_f32 v94, v94, v223
    v_mul_f32 v95, v95, v224
    v_mul_f32 v96, v96, v221
    v_mul_f32 v97, v97, v222
    v_mul_f32 v98, v98, v223
    v_mul_f32 v99, v99, v224
    v_mul_f32 v100, v100, v221
    v_mul_f32 v101, v101, v222
    v_mul_f32 v102, v102, v223
    v_mul_f32 v103, v103, v224
    v_mul_f32 v104, v104, v221
    v_mul_f32 v105, v105, v222
    v_mul_f32 v106, v106, v223
    v_mul_f32 v107, v107, v224
    v_mul_f32 v108, v108, v221
    v_mul_f32 v109, v109, v222
    v_mul_f32 v110, v110, v223
    v_mul_f32 v111, v111, v224
    v_mul_f32 v112, v112, v221
    v_mul_f32 v113, v113, v222
    v_mul_f32 v114, v114, v223
    v_mul_f32 v115, v115, v224
    v_mul_f32 v116, v116, v221
    v_mul_f32 v117, v117, v222
    v_mul_f32 v118, v118, v223
    v_mul_f32 v119, v119, v224
    v_mul_f32 v120, v120, v221
    v_mul_f32 v121, v121, v222
    v_mul_f32 v122, v122, v223
    v_mul_f32 v123, v123, v224
    v_mul_f32 v124, v124, v221
    v_mul_f32 v125, v125, v222
    v_mul_f32 v126, v126, v223
    v_mul_f32 v127, v127, v224
    v_exp_f32 v208, v144
    s_nop 0
    v_exp_f32 v209, v145
    s_nop 0
    v_exp_f32 v210, v146
    s_nop 0
    v_cvt_pk_bf16_f32 v168, v208, v209
    v_exp_f32 v211, v147
    s_nop 0
    v_exp_f32 v212, v152
    s_nop 0
    v_cvt_pk_bf16_f32 v169, v210, v211
    v_exp_f32 v213, v153
    s_nop 0
    v_exp_f32 v214, v154
    s_nop 0
    v_cvt_pk_bf16_f32 v170, v212, v213
    v_exp_f32 v215, v155
    s_nop 0
    v_exp_f32 v208, v148
    s_nop 0
    v_cvt_pk_bf16_f32 v171, v214, v215
    v_or3_b32 v197, v168, v169, v170
    v_exp_f32 v209, v149
    s_nop 0
    v_exp_f32 v210, v150
    s_nop 0
    v_cvt_pk_bf16_f32 v172, v208, v209
    v_exp_f32 v211, v151
    s_nop 0
    v_exp_f32 v212, v156
    s_nop 0
    v_cvt_pk_bf16_f32 v173, v210, v211
    v_or3_b32 v197, v197, v171, v172
    v_exp_f32 v213, v157
    s_nop 0
    v_exp_f32 v214, v158
    s_nop 0
    v_cvt_pk_bf16_f32 v174, v212, v213
    v_exp_f32 v215, v159
    s_nop 0
    v_or3_b32 v197, v197, v173, v174
    v_cvt_pk_bf16_f32 v175, v214, v215
    v_or_b32 v197, v197, v175
    v_and_b32 v197, s48, v197
    v_cmp_ne_u32 vcc, 0, v197
    s_nop 1
    s_branch L_back3
L_frare0_1:
    s_nop 7
    v_and_b32 v220, 48, v216
    v_max3_f32 v217, v144, v145, v146
    v_max3_f32 v217, v217, v147, v152
    v_max3_f32 v217, v217, v153, v154
    v_max_f32 v217, v217, v155
    v_mov_b32 v218, v217
    s_nop 1
    v_permlane32_swap_b32 v217, v218
    s_nop 0
    v_max_f32 v217, v217, v218
    v_mov_b32 v218, v217
    s_nop 1
    v_permlane16_swap_b32 v217, v218
    s_nop 0
    v_max_f32 v217, v217, v218
    v_add_f32 v217, 0x41c00000, v217
    v_max_f32 v217, 0, v217
    v_ceil_f32 v217, v217
    v_sub_f32 v219, 0, v217
    v_exp_f32 v219, v219
    v_sub_f32 v232, v232, v217
    v_sub_f32 v233, v233, v217
    v_sub_f32 v234, v234, v217
    v_sub_f32 v235, v235, v217
    v_sub_f32 v128, v128, v217
    v_sub_f32 v129, v129, v217
    v_sub_f32 v130, v130, v217
    v_sub_f32 v131, v131, v217
    v_sub_f32 v136, v136, v217
    v_sub_f32 v137, v137, v217
    v_sub_f32 v138, v138, v217
    v_sub_f32 v139, v139, v217
    v_sub_f32 v144, v144, v217
    v_sub_f32 v145, v145, v217
    v_sub_f32 v146, v146, v217
    v_sub_f32 v147, v147, v217
    v_sub_f32 v152, v152, v217
    v_sub_f32 v153, v153, v217
    v_sub_f32 v154, v154, v217
    v_sub_f32 v155, v155, v217
    ds_bpermute_b32 v221, v220, v219 offset:0
    ds_bpermute_b32 v222, v220, v219 offset:4
    ds_bpermute_b32 v223, v220, v219 offset:8
    ds_bpermute_b32 v224, v220, v219 offset:12
    v_lshlrev_b32 v225, 16, v160
    v_and_b32 v226, 0xffff0000, v160
    v_mul_f32 v225, v225, v219
    v_mul_f32 v226, v226, v219
    v_cvt_pk_bf16_f32 v160, v225, v226
    v_lshlrev_b32 v225, 16, v161
    v_and_b32 v226, 0xffff0000, v161
    v_mul_f32 v225, v225, v219
    v_mul_f32 v226, v226, v219
    v_cvt_pk_bf16_f32 v161, v225, v226
    v_lshlrev_b32 v225, 16, v162
    v_and_b32 v226, 0xffff0000, v162
    v_mul_f32 v225, v225, v219
    v_mul_f32 v226, v226, v219
    v_cvt_pk_bf16_f32 v162, v225, v226
    v_lshlrev_b32 v225, 16, v163
    v_and_b32 v226, 0xffff0000, v163
    v_mul_f32 v225, v225, v219
    v_mul_f32 v226, v226, v219
    v_cvt_pk_bf16_f32 v163, v225, v226
    s_waitcnt lgkmcnt(0)
    v_mul_f32 v200, v200, v221
    v_mul_f32 v201, v201, v222
    v_mul_f32 v202, v202, v223
    v_mul_f32 v203, v203, v224
    v_mul_f32 v0, v0, v221
    v_mul_f32 v1, v1, v222
    v_mul_f32 v2, v2, v223
    v_mul_f32 v3, v3, v224
    v_mul_f32 v4, v4, v221
    v_mul_f32 v5, v5, v222
    v_mul_f32 v6, v6, v223
    v_mul_f32 v7, v7, v224
    v_mul_f32 v8, v8, v221
    v_mul_f32 v9, v9, v222
    v_mul_f32 v10, v10, v223
    v_mul_f32 v11, v11, v224
    v_mul_f32 v12, v12, v221
    v_mul_f32 v13, v13, v222
    v_mul_f32 v14, v14, v223
    v_mul_f32 v15, v15, v224
    v_mul_f32 v16, v16, v221
    v_mul_f32 v17, v17, v222
    v_mul_f32 v18, v18, v223
    v_mul_f32 v19, v19, v224
    v_mul_f32 v20, v20, v221
    v_mul_f32 v21, v21, v222
    v_mul_f32 v22, v22, v223
    v_mul_f32 v23, v23, v224
    v_mul_f32 v24, v24, v221
    v_mul_f32 v25, v25, v222
    v_mul_f32 v26, v26, v223
    v_mul_f32 v27, v27, v224
    v_mul_f32 v28, v28, v221
    v_mul_f32 v29, v29, v222
    v_mul_f32 v30, v30, v223
    v_mul_f32 v31, v31, v224
    v_mul_f32 v32, v32, v221
    v_mul_f32 v33, v33, v222
    v_mul_f32 v34, v34, v223
    v_mul_f32 v35, v35, v224
    v_mul_f32 v36, v36, v221
    v_mul_f32 v37, v37, v222
    v_mul_f32 v38, v38, v223
    v_mul_f32 v39, v39, v224
    v_mul_f32 v40, v40, v221
    v_mul_f32 v41, v41, v222
    v_mul_f32 v42, v42, v223
    v_mul_f32 v43, v43, v224
    v_mul_f32 v44, v44, v221
    v_mul_f32 v45, v45, v222
    v_mul_f32 v46, v46, v223
    v_mul_f32 v47, v47, v224
    v_mul_f32 v48, v48, v221
    v_mul_f32 v49, v49, v222
    v_mul_f32 v50, v50, v223
    v_mul_f32 v51, v51, v224
    v_mul_f32 v52, v52, v221
    v_mul_f32 v53, v53, v222
    v_mul_f32 v54, v54, v223
    v_mul_f32 v55, v55, v224
    v_mul_f32 v56, v56, v221
    v_mul_f32 v57, v57, v222
    v_mul_f32 v58, v58, v223
    v_mul_f32 v59, v59, v224
    v_mul_f32 v60, v60, v221
    v_mul_f32 v61, v61, v222
    v_mul_f32 v62, v62, v223
    v_mul_f32 v63, v63, v224
    v_max3_f32 v217, v148, v149, v150
    v_max3_f32 v217, v217, v151, v156
    v_max3_f32 v217, v217, v157, v158
    v_max_f32 v217, v217, v159
    v_mov_b32 v218, v217
    s_nop 1
    v_permlane32_swap_b32 v217, v218
    s_nop 0
    v_max_f32 v217, v217, v218
    v_mov_b32 v218, v217
    s_nop 1
    v_permlane16_swap_b32 v217, v218
    s_nop 0
    v_max_f32 v217, v217, v218
    v_add_f32 v217, 0x41c00000, v217
    v_max_f32 v217, 0, v217
    v_ceil_f32 v217, v217
    v_sub_f32 v219, 0, v217
    v_exp_f32 v219, v219
    v_sub_f32 v236, v236, v217
    v_sub_f32 v237, v237, v217
    v_sub_f32 v238, v238, v217
    v_sub_f32 v239, v239, v217
    v_sub_f32 v132, v132, v217
    v_sub_f32 v133, v133, v217
    v_sub_f32 v134, v134, v217
    v_sub_f32 v135, v135, v217
    v_sub_f32 v140, v140, v217
    v_sub_f32 v141, v141, v217
    v_sub_f32 v142, v142, v217
    v_sub_f32 v143, v143, v217
    v_sub_f32 v148, v148, v217
    v_sub_f32 v149, v149, v217
    v_sub_f32 v150, v150, v217
    v_sub_f32 v151, v151, v217
    v_sub_f32 v156, v156, v217
    v_sub_f32 v157, v157, v217
    v_sub_f32 v158, v158, v217
    v_sub_f32 v159, v159, v217
    ds_bpermute_b32 v221, v220, v219 offset:0
    ds_bpermute_b32 v222, v220, v219 offset:4
    ds_bpermute_b32 v223, v220, v219 offset:8
    ds_bpermute_b32 v224, v220, v219 offset:12
    v_lshlrev_b32 v225, 16, v164
    v_and_b32 v226, 0xffff0000, v164
    v_mul_f32 v225, v225, v219
    v_mul_f32 v226, v226, v219
    v_cvt_pk_bf16_f32 v164, v225, v226
    v_lshlrev_b32 v225, 16, v165
    v_and_b32 v226, 0xffff0000, v165
    v_mul_f32 v225, v225, v219
    v_mul_f32 v226, v226, v219
    v_cvt_pk_bf16_f32 v165, v225, v226
    v_lshlrev_b32 v225, 16, v166
    v_and_b32 v226, 0xffff0000, v166
    v_mul_f32 v225, v225, v219
    v_mul_f32 v226, v226, v219
    v_cvt_pk_bf16_f32 v166, v225, v226
    v_lshlrev_b32 v225, 16, v167
    v_and_b32 v226, 0xffff0000, v167
    v_mul_f32 v225, v225, v219
    v_mul_f32 v226, v226, v219
    v_cvt_pk_bf16_f32 v167, v225, v226
    s_waitcnt lgkmcnt(0)
    v_mul_f32 v204, v204, v221
    v_mul_f32 v205, v205, v222
    v_mul_f32 v206, v206, v223
    v_mul_f32 v207, v207, v224
    v_mul_f32 v64, v64, v221
    v_mul_f32 v65, v65, v222
    v_mul_f32 v66, v66, v223
    v_mul_f32 v67, v67, v224
    v_mul_f32 v68, v68, v221
    v_mul_f32 v69, v69, v222
    v_mul_f32 v70, v70, v223
    v_mul_f32 v71, v71, v224
    v_mul_f32 v72, v72, v221
    v_mul_f32 v73, v73, v222
    v_mul_f32 v74, v74, v223
    v_mul_f32 v75, v75, v224
    v_mul_f32 v76, v76, v221
    v_mul_f32 v77, v77, v222
    v_mul_f32 v78, v78, v223
    v_mul_f32 v79, v79, v224
    v_mul_f32 v80, v80, v221
    v_mul_f32 v81, v81, v222
    v_mul_f32 v82, v82, v223
    v_mul_f32 v83, v83, v224
    v_mul_f32 v84, v84, v221
    v_mul_f32 v85, v85, v222
    v_mul_f32 v86, v86, v223
    v_mul_f32 v87, v87, v224
    v_mul_f32 v88, v88, v221
    v_mul_f32 v89, v89, v222
    v_mul_f32 v90, v90, v223
    v_mul_f32 v91, v91, v224
    v_mul_f32 v92, v92, v221
    v_mul_f32 v93, v93, v222
    v_mul_f32 v94, v94, v223
    v_mul_f32 v95, v95, v224
    v_mul_f32 v96, v96, v221
    v_mul_f32 v97, v97, v222
    v_mul_f32 v98, v98, v223
    v_mul_f32 v99, v99, v224
    v_mul_f32 v100, v100, v221
    v_mul_f32 v101, v101, v222
    v_mul_f32 v102, v102, v223
    v_mul_f32 v103, v103, v224
    v_mul_f32 v104, v104, v221
    v_mul_f32 v105, v105, v222
    v_mul_f32 v106, v106, v223
    v_mul_f32 v107, v107, v224
    v_mul_f32 v108, v108, v221
    v_mul_f32 v109, v109, v222
    v_mul_f32 v110, v110, v223
    v_mul_f32 v111, v111, v224
    v_mul_f32 v112, v112, v221
    v_mul_f32 v113, v113, v222
    v_mul_f32 v114, v114, v223
    v_mul_f32 v115, v115, v224
    v_mul_f32 v116, v116, v221
    v_mul_f32 v117, v117, v222
    v_mul_f32 v118, v118, v223
    v_mul_f32 v119, v119, v224
    v_mul_f32 v120, v120, v221
    v_mul_f32 v121, v121, v222
    v_mul_f32 v122, v122, v223
    v_mul_f32 v123, v123, v224
    v_mul_f32 v124, v124, v221
    v_mul_f32 v125, v125, v222
    v_mul_f32 v126, v126, v223
    v_mul_f32 v127, v127, v224
    v_exp_f32 v208, v144
    s_nop 0
    v_exp_f32 v209, v145
    s_nop 0
    v_exp_f32 v210, v146
    s_nop 0
    v_cvt_pk_bf16_f32 v168, v208, v209
    v_exp_f32 v211, v147
    s_nop 0
    v_exp_f32 v212, v152
    s_nop 0
    v_cvt_pk_bf16_f32 v169, v210, v211
    v_exp_f32 v213, v153
    s_nop 0
    v_exp_f32 v214, v154
    s_nop 0
    v_cvt_pk_bf16_f32 v170, v212, v213
    v_exp_f32 v215, v155
    s_nop 0
    v_exp_f32 v208, v148
    s_nop 0
    v_cvt_pk_bf16_f32 v171, v214, v215
    v_or3_b32 v197, v168, v169, v170
    v_exp_f32 v209, v149
    s_nop 0
    v_exp_f32 v210, v150
    s_nop 0
    v_cvt_pk_bf16_f32 v172, v208, v209
    v_exp_f32 v211, v151
    s_nop 0
    v_exp_f32 v212, v156
    s_nop 0
    v_cvt_pk_bf16_f32 v173, v210, v211
    v_or3_b32 v197, v197, v171, v172
    v_exp_f32 v213, v157
    s_nop 0
    v_exp_f32 v214, v158
    s_nop 0
    v_cvt_pk_bf16_f32 v174, v212, v213
    v_exp_f32 v215, v159
    s_nop 0
    v_or3_b32 v197, v197, v173, v174
    v_cvt_pk_bf16_f32 v175, v214, v215
    v_or_b32 v197, v197, v175
    v_and_b32 v197, s48, v197
    v_cmp_ne_u32 vcc, 0, v197
    s_nop 1
    s_branch L_fback0_1
L_frare0_2:
    s_nop 7
    v_and_b32 v220, 48, v216
    v_max3_f32 v217, v128, v129, v130
    v_max3_f32 v217, v217, v131, v136
    v_max3_f32 v217, v217, v137, v138
    v_max_f32 v217, v217, v139
    v_mov_b32 v218, v217
    s_nop 1
    v_permlane32_swap_b32 v217, v218
    s_nop 0
    v_max_f32 v217, v217, v218
    v_mov_b32 v218, v217
    s_nop 1
    v_permlane16_swap_b32 v217, v218
    s_nop 0
    v_max_f32 v217, v217, v218
    v_add_f32 v217, 0x41c00000, v217
    v_max_f32 v217, 0, v217
    v_ceil_f32 v217, v217
    v_sub_f32 v219, 0, v217
    v_exp_f32 v219, v219
    v_sub_f32 v232, v232, v217
    v_sub_f32 v233, v233, v217
    v_sub_f32 v234, v234, v217
    v_sub_f32 v235, v235, v217
    v_sub_f32 v128, v128, v217
    v_sub_f32 v129, v129, v217
    v_sub_f32 v130, v130, v217
    v_sub_f32 v131, v131, v217
    v_sub_f32 v136, v136, v217
    v_sub_f32 v137, v137, v217
    v_sub_f32 v138, v138, v217
    v_sub_f32 v139, v139, v217
    v_sub_f32 v144, v144, v217
    v_sub_f32 v145, v145, v217
    v_sub_f32 v146, v146, v217
    v_sub_f32 v147, v147, v217
    v_sub_f32 v152, v152, v217
    v_sub_f32 v153, v153, v217
    v_sub_f32 v154, v154, v217
    v_sub_f32 v155, v155, v217
    ds_bpermute_b32 v221, v220, v219 offset:0
    ds_bpermute_b32 v222, v220, v219 offset:4
    ds_bpermute_b32 v223, v220, v219 offset:8
    ds_bpermute_b32 v224, v220, v219 offset:12
    v_lshlrev_b32 v225, 16, v160
    v_and_b32 v226, 0xffff0000, v160
    v_mul_f32 v225, v225, v219
    v_mul_f32 v226, v226, v219
    v_cvt_pk_bf16_f32 v160, v225, v226
    v_lshlrev_b32 v225, 16, v161
    v_and_b32 v226, 0xffff0000, v161
    v_mul_f32 v225, v225, v219
    v_mul_f32 v226, v226, v219
    v_cvt_pk_bf16_f32 v161, v225, v226
    v_lshlrev_b32 v225, 16, v162
    v_and_b32 v226, 0xffff0000, v162
    v_mul_f32 v225, v225, v219
    v_mul_f32 v226, v226, v219
    v_cvt_pk_bf16_f32 v162, v225, v226
    v_lshlrev_b32 v225, 16, v163
    v_and_b32 v226, 0xffff0000, v163
    v_mul_f32 v225, v225, v219
    v_mul_f32 v226, v226, v219
    v_cvt_pk_bf16_f32 v163, v225, v226
    v_lshlrev_b32 v225, 16, v168
    v_and_b32 v226, 0xffff0000, v168
    v_mul_f32 v225, v225, v219
    v_mul_f32 v226, v226, v219
    v_cvt_pk_bf16_f32 v168, v225, v226
    v_lshlrev_b32 v225, 16, v169
    v_and_b32 v226, 0xffff0000, v169
    v_mul_f32 v225, v225, v219
    v_mul_f32 v226, v226, v219
    v_cvt_pk_bf16_f32 v169, v225, v226
    v_lshlrev_b32 v225, 16, v170
    v_and_b32 v226, 0xffff0000, v170
    v_mul_f32 v225, v225, v219
    v_mul_f32 v226, v226, v219
    v_cvt_pk_bf16_f32 v170, v225, v226
    v_lshlrev_b32 v225, 16, v171
    v_and_b32 v226, 0xffff0000, v171
    v_mul_f32 v225, v225, v219
    v_mul_f32 v226, v226, v219
    v_cvt_pk_bf16_f32 v171, v225, v226
    s_waitcnt lgkmcnt(0)
    v_mul_f32 v200, v200, v221
    v_mul_f32 v201, v201, v222
    v_mul_f32 v202, v202, v223
    v_mul_f32 v203, v203, v224
    v_mul_f32 v0, v0, v221
    v_mul_f32 v1, v1, v222
    v_mul_f32 v2, v2, v223
    v_mul_f32 v3, v3, v224
    v_mul_f32 v4, v4, v221
    v_mul_f32 v5, v5, v222
    v_mul_f32 v6, v6, v223
    v_mul_f32 v7, v7, v224
    v_mul_f32 v8, v8, v221
    v_mul_f32 v9, v9, v222
    v_mul_f32 v10, v10, v223
    v_mul_f32 v11, v11, v224
    v_mul_f32 v12, v12, v221
    v_mul_f32 v13, v13, v222
    v_mul_f32 v14, v14, v223
    v_mul_f32 v15, v15, v224
    v_mul_f32 v16, v16, v221
    v_mul_f32 v17, v17, v222
    v_mul_f32 v18, v18, v223
    v_mul_f32 v19, v19, v224
    v_mul_f32 v20, v20, v221
    v_mul_f32 v21, v21, v222
    v_mul_f32 v22, v22, v223
    v_mul_f32 v23, v23, v224
    v_mul_f32 v24, v24, v221
    v_mul_f32 v25, v25, v222
    v_mul_f32 v26, v26, v223
    v_mul_f32 v27, v27, v224
    v_mul_f32 v28, v28, v221
    v_mul_f32 v29, v29, v222
    v_mul_f32 v30, v30, v223
    v_mul_f32 v31, v31, v224
    v_mul_f32 v32, v32, v221
    v_mul_f32 v33, v33, v222
    v_mul_f32 v34, v34, v223
    v_mul_f32 v35, v35, v224
    v_mul_f32 v36, v36, v221
    v_mul_f32 v37, v37, v222
    v_mul_f32 v38, v38, v223
    v_mul_f32 v39, v39, v224
    v_mul_f32 v40, v40, v221
    v_mul_f32 v41, v41, v222
    v_mul_f32 v42, v42, v223
    v_mul_f32 v43, v43, v224
    v_mul_f32 v44, v44, v221
    v_mul_f32 v45, v45, v222
    v_mul_f32 v46, v46, v223
    v_mul_f32 v47, v47, v224
    v_mul_f32 v48, v48, v221
    v_mul_f32 v49, v49, v222
    v_mul_f32 v50, v50, v223
    v_mul_f32 v51, v51, v224
    v_mul_f32 v52, v52, v221
    v_mul_f32 v53, v53, v222
    v_mul_f32 v54, v54, v223
    v_mul_f32 v55, v55, v224
    v_mul_f32 v56, v56, v221
    v_mul_f32 v57, v57, v222
    v_mul_f32 v58, v58, v223
    v_mul_f32 v59, v59, v224
    v_mul_f32 v60, v60, v221
    v_mul_f32 v61, v61, v222
    v_mul_f32 v62, v62, v223
    v_mul_f32 v63, v63, v224
    v_max3_f32 v217, v132, v133, v134
    v_max3_f32 v217, v217, v135, v140
    v_max3_f32 v217, v217, v141, v142
    v_max_f32 v217, v217, v143
    v_mov_b32 v218, v217
    s_nop 1
    v_permlane32_swap_b32 v217, v218
    s_nop 0
    v_max_f32 v217, v217, v218
    v_mov_b32 v218, v217
    s_nop 1
    v_permlane16_swap_b32 v217, v218
    s_nop 0
    v_max_f32 v217, v217, v218
    v_add_f32 v217, 0x41c00000, v217
    v_max_f32 v217, 0, v217
    v_ceil_f32 v217, v217
    v_sub_f32 v219, 0, v217
    v_exp_f32 v219, v219
    v_sub_f32 v236, v236, v217
    v_sub_f32 v237, v237, v217
    v_sub_f32 v238, v238, v217
    v_sub_f32 v239, v239, v217
    v_sub_f32 v132, v132, v217
    v_sub_f32 v133, v133, v217
    v_sub_f32 v134, v134, v217
    v_sub_f32 v135, v135, v217
    v_sub_f32 v140, v140, v217
    v_sub_f32 v141, v141, v217
    v_sub_f32 v142, v142, v217
    v_sub_f32 v143, v143, v217
    v_sub_f32 v148, v148, v217
    v_sub_f32 v149, v149, v217
    v_sub_f32 v150, v150, v217
    v_sub_f32 v151, v151, v217
    v_sub_f32 v156, v156, v217
    v_sub_f32 v157, v157, v217
    v_sub_f32 v158, v158, v217
    v_sub_f32 v159, v159, v217
    ds_bpermute_b32 v221, v220, v219 offset:0
    ds_bpermute_b32 v222, v220, v219 offset:4
    ds_bpermute_b32 v223, v220, v219 offset:8
    ds_bpermute_b32 v224, v220, v219 offset:12
    v_lshlrev_b32 v225, 16, v164
    v_and_b32 v226, 0xffff0000, v164
    v_mul_f32 v225, v225, v219
    v_mul_f32 v226, v226, v219
    v_cvt_pk_bf16_f32 v164, v225, v226
    v_lshlrev_b32 v225, 16, v165
    v_and_b32 v226, 0xffff0000, v165
    v_mul_f32 v225, v225, v219
    v_mul_f32 v226, v226, v219
    v_cvt_pk_bf16_f32 v165, v225, v226
    v_lshlrev_b32 v225, 16, v166
    v_and_b32 v226, 0xffff0000, v166
    v_mul_f32 v225, v225, v219
    v_mul_f32 v226, v226, v219
    v_cvt_pk_bf16_f32 v166, v225, v226
    v_lshlrev_b32 v225, 16, v167
    v_and_b32 v226, 0xffff0000, v167
    v_mul_f32 v225, v225, v219
    v_mul_f32 v226, v226, v219
    v_cvt_pk_bf16_f32 v167, v225, v226
    v_lshlrev_b32 v225, 16, v172
    v_and_b32 v226, 0xffff0000, v172
    v_mul_f32 v225, v225, v219
    v_mul_f32 v226, v226, v219
    v_cvt_pk_bf16_f32 v172, v225, v226
    v_lshlrev_b32 v225, 16, v173
    v_and_b32 v226, 0xffff0000, v173
    v_mul_f32 v225, v225, v219
    v_mul_f32 v226, v226, v219
    v_cvt_pk_bf16_f32 v173, v225, v226
    v_lshlrev_b32 v225, 16, v174
    v_and_b32 v226, 0xffff0000, v174
    v_mul_f32 v225, v225, v219
    v_mul_f32 v226, v226, v219
    v_cvt_pk_bf16_f32 v174, v225, v226
    v_lshlrev_b32 v225, 16, v175
    v_and_b32 v226, 0xffff0000, v175
    v_mul_f32 v225, v225, v219
    v_mul_f32 v226, v226, v219
    v_cvt_pk_bf16_f32 v175, v225, v226
    s_waitcnt lgkmcnt(0)
    v_mul_f32 v204, v204, v221
    v_mul_f32 v205, v205, v222
    v_mul_f32 v206, v206, v223
    v_mul_f32 v207, v207, v224
    v_mul_f32 v64, v64, v221
    v_mul_f32 v65, v65, v222
    v_mul_f32 v66, v66, v223
    v_mul_f32 v67, v67, v224
    v_mul_f32 v68, v68, v221
    v_mul_f32 v69, v69, v222
    v_mul_f32 v70, v70, v223
    v_mul_f32 v71, v71, v224
    v_mul_f32 v72, v72, v221
    v_mul_f32 v73, v73, v222
    v_mul_f32 v74, v74, v223
    v_mul_f32 v75, v75, v224
    v_mul_f32 v76, v76, v221
    v_mul_f32 v77, v77, v222
    v_mul_f32 v78, v78, v223
    v_mul_f32 v79, v79, v224
    v_mul_f32 v80, v80, v221
    v_mul_f32 v81, v81, v222
    v_mul_f32 v82, v82, v223
    v_mul_f32 v83, v83, v224
    v_mul_f32 v84, v84, v221
    v_mul_f32 v85, v85, v222
    v_mul_f32 v86, v86, v223
    v_mul_f32 v87, v87, v224
    v_mul_f32 v88, v88, v221
    v_mul_f32 v89, v89, v222
    v_mul_f32 v90, v90, v223
    v_mul_f32 v91, v91, v224
    v_mul_f32 v92, v92, v221
    v_mul_f32 v93, v93, v222
    v_mul_f32 v94, v94, v223
    v_mul_f32 v95, v95, v224
    v_mul_f32 v96, v96, v221
    v_mul_f32 v97, v97, v222
    v_mul_f32 v98, v98, v223
    v_mul_f32 v99, v99, v224
    v_mul_f32 v100, v100, v221
    v_mul_f32 v101, v101, v222
    v_mul_f32 v102, v102, v223
    v_mul_f32 v103, v103, v224
    v_mul_f32 v104, v104, v221
    v_mul_f32 v105, v105, v222
    v_mul_f32 v106, v106, v223
    v_mul_f32 v107, v107, v224
    v_mul_f32 v108, v108, v221
    v_mul_f32 v109, v109, v222
    v_mul_f32 v110, v110, v223
    v_mul_f32 v111, v111, v224
    v_mul_f32 v112, v112, v221
    v_mul_f32 v113, v113, v222
    v_mul_f32 v114, v114, v223
    v_mul_f32 v115, v115, v224
    v_mul_f32 v116, v116, v221
    v_mul_f32 v117, v117, v222
    v_mul_f32 v118, v118, v223
    v_mul_f32 v119, v119, v224
    v_mul_f32 v120, v120, v221
    v_mul_f32 v121, v121, v222
    v_mul_f32 v122, v122, v223
    v_mul_f32 v123, v123, v224
    v_mul_f32 v124, v124, v221
    v_mul_f32 v125, v125, v222
    v_mul_f32 v126, v126, v223
    v_mul_f32 v127, v127, v224
    v_exp_f32 v208, v128
    s_nop 0
    v_exp_f32 v209, v129
    s_nop 0
    v_exp_f32 v210, v130
    s_nop 0
    v_cvt_pk_bf16_f32 v240, v208, v209
    v_exp_f32 v211, v131
    s_nop 0
    v_exp_f32 v212, v136
    s_nop 0
    v_cvt_pk_bf16_f32 v241, v210, v211
    v_exp_f32 v213, v137
    s_nop 0
    v_exp_f32 v214, v138
    s_nop 0
    v_cvt_pk_bf16_f32 v242, v212, v213
    v_exp_f32 v215, v139
    s_nop 0
    v_exp_f32 v208, v132
    s_nop 0
    v_cvt_pk_bf16_f32 v243, v214, v215
    v_or3_b32 v197, v240, v241, v242
    v_exp_f32 v209, v133
    s_nop 0
    v_exp_f32 v210, v134
    s_nop 0
    v_cvt_pk_bf16_f32 v244, v208, v209
    v_exp_f32 v211, v135
    s_nop 0
    v_exp_f32 v212, v140
    s_nop 0
    v_cvt_pk_bf16_f32 v245, v210, v211
    v_or3_b32 v197, v197, v243, v244
    v_exp_f32 v213, v141
    s_nop 0
    v_exp_f32 v214, v142
    s_nop 0
    v_cvt_pk_bf16_f32 v246, v212, v213
    v_exp_f32 v215, v143
    s_nop 0
    v_or3_b32 v197, v197, v245, v246
    v_cvt_pk_bf16_f32 v247, v214, v215
    v_or_b32 v197, v197, v247
    v_and_b32 v197, s48, v197
    v_cmp_ne_u32 vcc, 0, v197
    s_nop 1
    s_branch L_fback0_2
L_frare0_3:
    s_nop 7
    v_and_b32 v220, 48, v216
    v_max3_f32 v217, v144, v145, v146
    v_max3_f32 v217, v217, v147, v152
    v_max3_f32 v217, v217, v153, v154
    v_max_f32 v217, v217, v155
    v_mov_b32 v218, v217
    s_nop 1
    v_permlane32_swap_b32 v217, v218
    s_nop 0
    v_max_f32 v217, v217, v218
    v_mov_b32 v218, v217
    s_nop 1
    v_permlane16_swap_b32 v217, v218
    s_nop 0
    v_max_f32 v217, v217, v218
    v_add_f32 v217, 0x41c00000, v217
    v_max_f32 v217, 0, v217
    v_ceil_f32 v217, v217
    v_sub_f32 v219, 0, v217
    v_exp_f32 v219, v219
    v_sub_f32 v232, v232, v217
    v_sub_f32 v233, v233, v217
    v_sub_f32 v234, v234, v217
    v_sub_f32 v235, v235, v217
    v_sub_f32 v128, v128, v217
    v_sub_f32 v129, v129, v217
    v_sub_f32 v130, v130, v217
    v_sub_f32 v131, v131, v217
    v_sub_f32 v136, v136, v217
    v_sub_f32 v137, v137, v217
    v_sub_f32 v138, v138, v217
    v_sub_f32 v139, v139, v217
    v_sub_f32 v144, v144, v217
    v_sub_f32 v145, v145, v217
    v_sub_f32 v146, v146, v217
    v_sub_f32 v147, v147, v217
    v_sub_f32 v152, v152, v217
    v_sub_f32 v153, v153, v217
    v_sub_f32 v154, v154, v217
    v_sub_f32 v155, v155, v217
    ds_bpermute_b32 v221, v220, v219 offset:0
    ds_bpermute_b32 v222, v220, v219 offset:4
    ds_bpermute_b32 v223, v220, v219 offset:8
    ds_bpermute_b32 v224, v220, v219 offset:12
    v_lshlrev_b32 v225, 16, v160
    v_and_b32 v226, 0xffff0000, v160
    v_mul_f32 v225, v225, v219
    v_mul_f32 v226, v226, v219
    v_cvt_pk_bf16_f32 v160, v225, v226
    v_lshlrev_b32 v225, 16, v161
    v_and_b32 v226, 0xffff0000, v161
    v_mul_f32 v225, v225, v219
    v_mul_f32 v226, v226, v219
    v_cvt_pk_bf16_f32 v161, v225, v226
    v_lshlrev_b32 v225, 16, v162
    v_and_b32 v226, 0xffff0000, v162
    v_mul_f32 v225, v225, v219
    v_mul_f32 v226, v226, v219
    v_cvt_pk_bf16_f32 v162, v225, v226
    v_lshlrev_b32 v225, 16, v163
    v_and_b32 v226, 0xffff0000, v163
    v_mul_f32 v225, v225, v219
    v_mul_f32 v226, v226, v219
    v_cvt_pk_bf16_f32 v163, v225, v226
    v_lshlrev_b32 v225, 16, v168
    v_and_b32 v226, 0xffff0000, v168
    v_mul_f32 v225, v225, v219
    v_mul_f32 v226, v226, v219
    v_cvt_pk_bf16_f32 v168, v225, v226
    v_lshlrev_b32 v225, 16, v169
    v_and_b32 v226, 0xffff0000, v169
    v_mul_f32 v225, v225, v219
    v_mul_f32 v226, v226, v219
    v_cvt_pk_bf16_f32 v169, v225, v226
    v_lshlrev_b32 v225, 16, v170
    v_and_b32 v226, 0xffff0000, v170
    v_mul_f32 v225, v225, v219
    v_mul_f32 v226, v226, v219
    v_cvt_pk_bf16_f32 v170, v225, v226
    v_lshlrev_b32 v225, 16, v171
    v_and_b32 v226, 0xffff0000, v171
    v_mul_f32 v225, v225, v219
    v_mul_f32 v226, v226, v219
    v_cvt_pk_bf16_f32 v171, v225, v226
    v_lshlrev_b32 v225, 16, v240
    v_and_b32 v226, 0xffff0000, v240
    v_mul_f32 v225, v225, v219
    v_mul_f32 v226, v226, v219
    v_cvt_pk_bf16_f32 v240, v225, v226
    v_lshlrev_b32 v225, 16, v241
    v_and_b32 v226, 0xffff0000, v241
    v_mul_f32 v225, v225, v219
    v_mul_f32 v226, v226, v219
    v_cvt_pk_bf16_f32 v241, v225, v226
    v_lshlrev_b32 v225, 16, v242
    v_and_b32 v226, 0xffff0000, v242
    v_mul_f32 v225, v225, v219
    v_mul_f32 v226, v226, v219
    v_cvt_pk_bf16_f32 v242, v225, v226
    v_lshlrev_b32 v225, 16, v243
    v_and_b32 v226, 0xffff0000, v243
    v_mul_f32 v225, v225, v219
    v_mul_f32 v226, v226, v219
    v_cvt_pk_bf16_f32 v243, v225, v226
    s_waitcnt lgkmcnt(0)
    v_mul_f32 v200, v200, v221
    v_mul_f32 v201, v201, v222
    v_mul_f32 v202, v202, v223
    v_mul_f32 v203, v203, v224
    v_mul_f32 v0, v0, v221
    v_mul_f32 v1, v1, v222
    v_mul_f32 v2, v2, v223
    v_mul_f32 v3, v3, v224
    v_mul_f32 v4, v4, v221
    v_mul_f32 v5, v5, v222
    v_mul_f32 v6, v6, v223
    v_mul_f32 v7, v7, v224
    v_mul_f32 v8, v8, v221
    v_mul_f32 v9, v9, v222
    v_mul_f32 v10, v10, v223
    v_mul_f32 v11, v11, v224
    v_mul_f32 v12, v12, v221
    v_mul_f32 v13, v13, v222
    v_mul_f32 v14, v14, v223
    v_mul_f32 v15, v15, v224
    v_mul_f32 v16, v16, v221
    v_mul_f32 v17, v17, v222
    v_mul_f32 v18, v18, v223
    v_mul_f32 v19, v19, v224
    v_mul_f32 v20, v20, v221
    v_mul_f32 v21, v21, v222
    v_mul_f32 v22, v22, v223
    v_mul_f32 v23, v23, v224
    v_mul_f32 v24, v24, v221
    v_mul_f32 v25, v25, v222
    v_mul_f32 v26, v26, v223
    v_mul_f32 v27, v27, v224
    v_mul_f32 v28, v28, v221
    v_mul_f32 v29, v29, v222
    v_mul_f32 v30, v30, v223
    v_mul_f32 v31, v31, v224
    v_mul_f32 v32, v32, v221
    v_mul_f32 v33, v33, v222
    v_mul_f32 v34, v34, v223
    v_mul_f32 v35, v35, v224
    v_mul_f32 v36, v36, v221
    v_mul_f32 v37, v37, v222
    v_mul_f32 v38, v38, v223
    v_mul_f32 v39, v39, v224
    v_mul_f32 v40, v40, v221
    v_mul_f32 v41, v41, v222
    v_mul_f32 v42, v42, v223
    v_mul_f32 v43, v43, v224
    v_mul_f32 v44, v44, v221
    v_mul_f32 v45, v45, v222
    v_mul_f32 v46, v46, v223
    v_mul_f32 v47, v47, v224
    v_mul_f32 v48, v48, v221
    v_mul_f32 v49, v49, v222
    v_mul_f32 v50, v50, v223
    v_mul_f32 v51, v51, v224
    v_mul_f32 v52, v52, v221
    v_mul_f32 v53, v53, v222
    v_mul_f32 v54, v54, v223
    v_mul_f32 v55, v55, v224
    v_mul_f32 v56, v56, v221
    v_mul_f32 v57, v57, v222
    v_mul_f32 v58, v58, v223
    v_mul_f32 v59, v59, v224
    v_mul_f32 v60, v60, v221
    v_mul_f32 v61, v61, v222
    v_mul_f32 v62, v62, v223
    v_mul_f32 v63, v63, v224
    v_max3_f32 v217, v148, v149, v150
    v_max3_f32 v217, v217, v151, v156
    v_max3_f32 v217, v217, v157, v158
    v_max_f32 v217, v217, v159
    v_mov_b32 v218, v217
    s_nop 1
    v_permlane32_swap_b32 v217, v218
    s_nop 0
    v_max_f32 v217, v217, v218
    v_mov_b32 v218, v217
    s_nop 1
    v_permlane16_swap_b32 v217, v218
    s_nop 0
    v_max_f32 v217, v217, v218
    v_add_f32 v217, 0x41c00000, v217
    v_max_f32 v217, 0, v217
    v_ceil_f32 v217, v217
    v_sub_f32 v219, 0, v217
    v_exp_f32 v219, v219
    v_sub_f32 v236, v236, v217
    v_sub_f32 v237, v237, v217
    v_sub_f32 v238, v238, v217
    v_sub_f32 v239, v239, v217
    v_sub_f32 v132, v132, v217
    v_sub_f32 v133, v133, v217
    v_sub_f32 v134, v134, v217
    v_sub_f32 v135, v135, v217
    v_sub_f32 v140, v140, v217
    v_sub_f32 v141, v141, v217
    v_sub_f32 v142, v142, v217
    v_sub_f32 v143, v143, v217
    v_sub_f32 v148, v148, v217
    v_sub_f32 v149, v149, v217
    v_sub_f32 v150, v150, v217
    v_sub_f32 v151, v151, v217
    v_sub_f32 v156, v156, v217
    v_sub_f32 v157, v157, v217
    v_sub_f32 v158, v158, v217
    v_sub_f32 v159, v159, v217
    ds_bpermute_b32 v221, v220, v219 offset:0
    ds_bpermute_b32 v222, v220, v219 offset:4
    ds_bpermute_b32 v223, v220, v219 offset:8
    ds_bpermute_b32 v224, v220, v219 offset:12
    v_lshlrev_b32 v225, 16, v164
    v_and_b32 v226, 0xffff0000, v164
    v_mul_f32 v225, v225, v219
    v_mul_f32 v226, v226, v219
    v_cvt_pk_bf16_f32 v164, v225, v226
    v_lshlrev_b32 v225, 16, v165
    v_and_b32 v226, 0xffff0000, v165
    v_mul_f32 v225, v225, v219
    v_mul_f32 v226, v226, v219
    v_cvt_pk_bf16_f32 v165, v225, v226
    v_lshlrev_b32 v225, 16, v166
    v_and_b32 v226, 0xffff0000, v166
    v_mul_f32 v225, v225, v219
    v_mul_f32 v226, v226, v219
    v_cvt_pk_bf16_f32 v166, v225, v226
    v_lshlrev_b32 v225, 16, v167
    v_and_b32 v226, 0xffff0000, v167
    v_mul_f32 v225, v225, v219
    v_mul_f32 v226, v226, v219
    v_cvt_pk_bf16_f32 v167, v225, v226
    v_lshlrev_b32 v225, 16, v172
    v_and_b32 v226, 0xffff0000, v172
    v_mul_f32 v225, v225, v219
    v_mul_f32 v226, v226, v219
    v_cvt_pk_bf16_f32 v172, v225, v226
    v_lshlrev_b32 v225, 16, v173
    v_and_b32 v226, 0xffff0000, v173
    v_mul_f32 v225, v225, v219
    v_mul_f32 v226, v226, v219
    v_cvt_pk_bf16_f32 v173, v225, v226
    v_lshlrev_b32 v225, 16, v174
    v_and_b32 v226, 0xffff0000, v174
    v_mul_f32 v225, v225, v219
    v_mul_f32 v226, v226, v219
    v_cvt_pk_bf16_f32 v174, v225, v226
    v_lshlrev_b32 v225, 16, v175
    v_and_b32 v226, 0xffff0000, v175
    v_mul_f32 v225, v225, v219
    v_mul_f32 v226, v226, v219
    v_cvt_pk_bf16_f32 v175, v225, v226
    v_lshlrev_b32 v225, 16, v244
    v_and_b32 v226, 0xffff0000, v244
    v_mul_f32 v225, v225, v219
    v_mul_f32 v226, v226, v219
    v_cvt_pk_bf16_f32 v244, v225, v226
    v_lshlrev_b32 v225, 16, v245
    v_and_b32 v226, 0xffff0000, v245
    v_mul_f32 v225, v225, v219
    v_mul_f32 v226, v226, v219
    v_cvt_pk_bf16_f32 v245, v225, v226
    v_lshlrev_b32 v225, 16, v246
    v_and_b32 v226, 0xffff0000, v246
    v_mul_f32 v225, v225, v219
    v_mul_f32 v226, v226, v219
    v_cvt_pk_bf16_f32 v246, v225, v226
    v_lshlrev_b32 v225, 16, v247
    v_and_b32 v226, 0xffff0000, v247
    v_mul_f32 v225, v225, v219
    v_mul_f32 v226, v226, v219
    v_cvt_pk_bf16_f32 v247, v225, v226
    s_waitcnt lgkmcnt(0)
    v_mul_f32 v204, v204, v221
    v_mul_f32 v205, v205, v222
    v_mul_f32 v206, v206, v223
    v_mul_f32 v207, v207, v224
    v_mul_f32 v64, v64, v221
    v_mul_f32 v65, v65, v222
    v_mul_f32 v66, v66, v223
    v_mul_f32 v67, v67, v224
    v_mul_f32 v68, v68, v221
    v_mul_f32 v69, v69, v222
    v_mul_f32 v70, v70, v223
    v_mul_f32 v71, v71, v224
    v_mul_f32 v72, v72, v221
    v_mul_f32 v73, v73, v222
    v_mul_f32 v74, v74, v223
    v_mul_f32 v75, v75, v224
    v_mul_f32 v76, v76, v221
    v_mul_f32 v77, v77, v222
    v_mul_f32 v78, v78, v223
    v_mul_f32 v79, v79, v224
    v_mul_f32 v80, v80, v221
    v_mul_f32 v81, v81, v222
    v_mul_f32 v82, v82, v223
    v_mul_f32 v83, v83, v224
    v_mul_f32 v84, v84, v221
    v_mul_f32 v85, v85, v222
    v_mul_f32 v86, v86, v223
    v_mul_f32 v87, v87, v224
    v_mul_f32 v88, v88, v221
    v_mul_f32 v89, v89, v222
    v_mul_f32 v90, v90, v223
    v_mul_f32 v91, v91, v224
    v_mul_f32 v92, v92, v221
    v_mul_f32 v93, v93, v222
    v_mul_f32 v94, v94, v223
    v_mul_f32 v95, v95, v224
    v_mul_f32 v96, v96, v221
    v_mul_f32 v97, v97, v222
    v_mul_f32 v98, v98, v223
    v_mul_f32 v99, v99, v224
    v_mul_f32 v100, v100, v221
    v_mul_f32 v101, v101, v222
    v_mul_f32 v102, v102, v223
    v_mul_f32 v103, v103, v224
    v_mul_f32 v104, v104, v221
    v_mul_f32 v105, v105, v222
    v_mul_f32 v106, v106, v223
    v_mul_f32 v107, v107, v224
    v_mul_f32 v108, v108, v221
    v_mul_f32 v109, v109, v222
    v_mul_f32 v110, v110, v223
    v_mul_f32 v111, v111, v224
    v_mul_f32 v112, v112, v221
    v_mul_f32 v113, v113, v222
    v_mul_f32 v114, v114, v223
    v_mul_f32 v115, v115, v224
    v_mul_f32 v116, v116, v221
    v_mul_f32 v117, v117, v222
    v_mul_f32 v118, v118, v223
    v_mul_f32 v119, v119, v224
    v_mul_f32 v120, v120, v221
    v_mul_f32 v121, v121, v222
    v_mul_f32 v122, v122, v223
    v_mul_f32 v123, v123, v224
    v_mul_f32 v124, v124, v221
    v_mul_f32 v125, v125, v222
    v_mul_f32 v126, v126, v223
    v_mul_f32 v127, v127, v224
    v_exp_f32 v208, v144
    s_nop 0
    v_exp_f32 v209, v145
    s_nop 0
    v_exp_f32 v210, v146
    s_nop 0
    v_cvt_pk_bf16_f32 v248, v208, v209
    v_exp_f32 v211, v147
    s_nop 0
    v_exp_f32 v212, v152
    s_nop 0
    v_cvt_pk_bf16_f32 v249, v210, v211
    v_exp_f32 v213, v153
    s_nop 0
    v_exp_f32 v214, v154
    s_nop 0
    v_cvt_pk_bf16_f32 v250, v212, v213
    v_exp_f32 v215, v155
    s_nop 0
    v_exp_f32 v208, v148
    s_nop 0
    v_cvt_pk_bf16_f32 v251, v214, v215
    v_or3_b32 v197, v248, v249, v250
    v_exp_f32 v209, v149
    s_nop 0
    v_exp_f32 v210, v150
    s_nop 0
    v_cvt_pk_bf16_f32 v252, v208, v209
    v_exp_f32 v211, v151
    s_nop 0
    v_exp_f32 v212, v156
    s_nop 0
    v_cvt_pk_bf16_f32 v253, v210, v211
    v_or3_b32 v197, v197, v251, v252
    v_exp_f32 v213, v157
    s_nop 0
    v_exp_f32 v214, v158
    s_nop 0
    v_cvt_pk_bf16_f32 v254, v212, v213
    v_exp_f32 v215, v159
    s_nop 0
    v_or3_b32 v197, v197, v253, v254
    v_cvt_pk_bf16_f32 v255, v214, v215
    v_or_b32 v197, v197, v255
    v_and_b32 v197, s48, v197
    v_cmp_ne_u32 vcc, 0, v197
    s_nop 1
    s_branch L_fback0_3
L_frare1_1:
    s_nop 7
    v_and_b32 v220, 48, v216
    v_max3_f32 v217, v128, v129, v130
    v_max3_f32 v217, v217, v131, v136
    v_max3_f32 v217, v217, v137, v138
    v_max_f32 v217, v217, v139
    v_mov_b32 v218, v217
    s_nop 1
    v_permlane32_swap_b32 v217, v218
    s_nop 0
    v_max_f32 v217, v217, v218
    v_mov_b32 v218, v217
    s_nop 1
    v_permlane16_swap_b32 v217, v218
    s_nop 0
    v_max_f32 v217, v217, v218
    v_add_f32 v217, 0x41c00000, v217
    v_max_f32 v217, 0, v217
    v_ceil_f32 v217, v217
    v_sub_f32 v219, 0, v217
    v_exp_f32 v219, v219
    v_sub_f32 v232, v232, v217
    v_sub_f32 v233, v233, v217
    v_sub_f32 v234, v234, v217
    v_sub_f32 v235, v235, v217
    v_sub_f32 v128, v128, v217
    v_sub_f32 v129, v129, v217
    v_sub_f32 v130, v130, v217
    v_sub_f32 v131, v131, v217
    v_sub_f32 v136, v136, v217
    v_sub_f32 v137, v137, v217
    v_sub_f32 v138, v138, v217
    v_sub_f32 v139, v139, v217
    v_sub_f32 v144, v144, v217
    v_sub_f32 v145, v145, v217
    v_sub_f32 v146, v146, v217
    v_sub_f32 v147, v147, v217
    v_sub_f32 v152, v152, v217
    v_sub_f32 v153, v153, v217
    v_sub_f32 v154, v154, v217
    v_sub_f32 v155, v155, v217
    ds_bpermute_b32 v221, v220, v219 offset:0
    ds_bpermute_b32 v222, v220, v219 offset:4
    ds_bpermute_b32 v223, v220, v219 offset:8
    ds_bpermute_b32 v224, v220, v219 offset:12
    v_lshlrev_b32 v225, 16, v168
    v_and_b32 v226, 0xffff0000, v168
    v_mul_f32 v225, v225, v219
    v_mul_f32 v226, v226, v219
    v_cvt_pk_bf16_f32 v168, v225, v226
    v_lshlrev_b32 v225, 16, v169
    v_and_b32 v226, 0xffff0000, v169
    v_mul_f32 v225, v225, v219
    v_mul_f32 v226, v226, v219
    v_cvt_pk_bf16_f32 v169, v225, v226
    v_lshlrev_b32 v225, 16, v170
    v_and_b32 v226, 0xffff0000, v170
    v_mul_f32 v225, v225, v219
    v_mul_f32 v226, v226, v219
    v_cvt_pk_bf16_f32 v170, v225, v226
    v_lshlrev_b32 v225, 16, v171
    v_and_b32 v226, 0xffff0000, v171
    v_mul_f32 v225, v225, v219
    v_mul_f32 v226, v226, v219
    v_cvt_pk_bf16_f32 v171, v225, v226
    s_waitcnt lgkmcnt(0)
    v_mul_f32 v200, v200, v221
    v_mul_f32 v201, v201, v222
    v_mul_f32 v202, v202, v223
    v_mul_f32 v203, v203, v224
    v_mul_f32 v0, v0, v221
    v_mul_f32 v1, v1, v222
    v_mul_f32 v2, v2, v223
    v_mul_f32 v3, v3, v224
    v_mul_f32 v4, v4, v221
    v_mul_f32 v5, v5, v222
    v_mul_f32 v6, v6, v223
    v_mul_f32 v7, v7, v224
    v_mul_f32 v8, v8, v221
    v_mul_f32 v9, v9, v222
    v_mul_f32 v10, v10, v223
    v_mul_f32 v11, v11, v224
    v_mul_f32 v12, v12, v221
    v_mul_f32 v13, v13, v222
    v_mul_f32 v14, v14, v223
    v_mul_f32 v15, v15, v224
    v_mul_f32 v16, v16, v221
    v_mul_f32 v17, v17, v222
    v_mul_f32 v18, v18, v223
    v_mul_f32 v19, v19, v224
    v_mul_f32 v20, v20, v221
    v_mul_f32 v21, v21, v222
    v_mul_f32 v22, v22, v223
    v_mul_f32 v23, v23, v224
    v_mul_f32 v24, v24, v221
    v_mul_f32 v25, v25, v222
    v_mul_f32 v26, v26, v223
    v_mul_f32 v27, v27, v224
    v_mul_f32 v28, v28, v221
    v_mul_f32 v29, v29, v222
    v_mul_f32 v30, v30, v223
    v_mul_f32 v31, v31, v224
    v_mul_f32 v32, v32, v221
    v_mul_f32 v33, v33, v222
    v_mul_f32 v34, v34, v223
    v_mul_f32 v35, v35, v224
    v_mul_f32 v36, v36, v221
    v_mul_f32 v37, v37, v222
    v_mul_f32 v38, v38, v223
    v_mul_f32 v39, v39, v224
    v_mul_f32 v40, v40, v221
    v_mul_f32 v41, v41, v222
    v_mul_f32 v42, v42, v223
    v_mul_f32 v43, v43, v224
    v_mul_f32 v44, v44, v221
    v_mul_f32 v45, v45, v222
    v_mul_f32 v46, v46, v223
    v_mul_f32 v47, v47, v224
    v_mul_f32 v48, v48, v221
    v_mul_f32 v49, v49, v222
    v_mul_f32 v50, v50, v223
    v_mul_f32 v51, v51, v224
    v_mul_f32 v52, v52, v221
    v_mul_f32 v53, v53, v222
    v_mul_f32 v54, v54, v223
    v_mul_f32 v55, v55, v224
    v_mul_f32 v56, v56, v221
    v_mul_f32 v57, v57, v222
    v_mul_f32 v58, v58, v223
    v_mul_f32 v59, v59, v224
    v_mul_f32 v60, v60, v221
    v_mul_f32 v61, v61, v222
    v_mul_f32 v62, v62, v223
    v_mul_f32 v63, v63, v224
    v_max3_f32 v217, v132, v133, v134
    v_max3_f32 v217, v217, v135, v140
    v_max3_f32 v217, v217, v141, v142
    v_max_f32 v217, v217, v143
    v_mov_b32 v218, v217
    s_nop 1
    v_permlane32_swap_b32 v217, v218
    s_nop 0
    v_max_f32 v217, v217, v218
    v_mov_b32 v218, v217
    s_nop 1
    v_permlane16_swap_b32 v217, v218
    s_nop 0
    v_max_f32 v217, v217, v218
    v_add_f32 v217, 0x41c00000, v217
    v_max_f32 v217, 0, v217
    v_ceil_f32 v217, v217
    v_sub_f32 v219, 0, v217
    v_exp_f32 v219, v219
    v_sub_f32 v236, v236, v217
    v_sub_f32 v237, v237, v217
    v_sub_f32 v238, v238, v217
    v_sub_f32 v239, v239, v217
    v_sub_f32 v132, v132, v217
    v_sub_f32 v133, v133, v217
    v_sub_f32 v134, v134, v217
    v_sub_f32 v135, v135, v217
    v_sub_f32 v140, v140, v217
    v_sub_f32 v141, v141, v217
    v_sub_f32 v142, v142, v217
    v_sub_f32 v143, v143, v217
    v_sub_f32 v148, v148, v217
    v_sub_f32 v149, v149, v217
    v_sub_f32 v150, v150, v217
    v_sub_f32 v151, v151, v217
    v_sub_f32 v156, v156, v217
    v_sub_f32 v157, v157, v217
    v_sub_f32 v158, v158, v217
    v_sub_f32 v159, v159, v217
    ds_bpermute_b32 v221, v220, v219 offset:0
    ds_bpermute_b32 v222, v220, v219 offset:4
    ds_bpermute_b32 v223, v220, v219 offset:8
    ds_bpermute_b32 v224, v220, v219 offset:12
    v_lshlrev_b32 v225, 16, v172
    v_and_b32 v226, 0xffff0000, v172
    v_mul_f32 v225, v225, v219
    v_mul_f32 v226, v226, v219
    v_cvt_pk_bf16_f32 v172, v225, v226
    v_lshlrev_b32 v225, 16, v173
    v_and_b32 v226, 0xffff0000, v173
    v_mul_f32 v225, v225, v219
    v_mul_f32 v226, v226, v219
    v_cvt_pk_bf16_f32 v173, v225, v226
    v_lshlrev_b32 v225, 16, v174
    v_and_b32 v226, 0xffff0000, v174
    v_mul_f32 v225, v225, v219
    v_mul_f32 v226, v226, v219
    v_cvt_pk_bf16_f32 v174, v225, v226
    v_lshlrev_b32 v225, 16, v175
    v_and_b32 v226, 0xffff0000, v175
    v_mul_f32 v225, v225, v219
    v_mul_f32 v226, v226, v219
    v_cvt_pk_bf16_f32 v175, v225, v226
    s_waitcnt lgkmcnt(0)
    v_mul_f32 v204, v204, v221
    v_mul_f32 v205, v205, v222
    v_mul_f32 v206, v206, v223
    v_mul_f32 v207, v207, v224
    v_mul_f32 v64, v64, v221
    v_mul_f32 v65, v65, v222
    v_mul_f32 v66, v66, v223
    v_mul_f32 v67, v67, v224
    v_mul_f32 v68, v68, v221
    v_mul_f32 v69, v69, v222
    v_mul_f32 v70, v70, v223
    v_mul_f32 v71, v71, v224
    v_mul_f32 v72, v72, v221
    v_mul_f32 v73, v73, v222
    v_mul_f32 v74, v74, v223
    v_mul_f32 v75, v75, v224
    v_mul_f32 v76, v76, v221
    v_mul_f32 v77, v77, v222
    v_mul_f32 v78, v78, v223
    v_mul_f32 v79, v79, v224
    v_mul_f32 v80, v80, v221
    v_mul_f32 v81, v81, v222
    v_mul_f32 v82, v82, v223
    v_mul_f32 v83, v83, v224
    v_mul_f32 v84, v84, v221
    v_mul_f32 v85, v85, v222
    v_mul_f32 v86, v86, v223
    v_mul_f32 v87, v87, v224
    v_mul_f32 v88, v88, v221
    v_mul_f32 v89, v89, v222
    v_mul_f32 v90, v90, v223
    v_mul_f32 v91, v91, v224
    v_mul_f32 v92, v92, v221
    v_mul_f32 v93, v93, v222
    v_mul_f32 v94, v94, v223
    v_mul_f32 v95, v95, v224
    v_mul_f32 v96, v96, v221
    v_mul_f32 v97, v97, v222
    v_mul_f32 v98, v98, v223
    v_mul_f32 v99, v99, v224
    v_mul_f32 v100, v100, v221
    v_mul_f32 v101, v101, v222
    v_mul_f32 v102, v102, v223
    v_mul_f32 v103, v103, v224
    v_mul_f32 v104, v104, v221
    v_mul_f32 v105, v105, v222
    v_mul_f32 v106, v106, v223
    v_mul_f32 v107, v107, v224
    v_mul_f32 v108, v108, v221
    v_mul_f32 v109, v109, v222
    v_mul_f32 v110, v110, v223
    v_mul_f32 v111, v111, v224
    v_mul_f32 v112, v112, v221
    v_mul_f32 v113, v113, v222
    v_mul_f32 v114, v114, v223
    v_mul_f32 v115, v115, v224
    v_mul_f32 v116, v116, v221
    v_mul_f32 v117, v117, v222
    v_mul_f32 v118, v118, v223
    v_mul_f32 v119, v119, v224
    v_mul_f32 v120, v120, v221
    v_mul_f32 v121, v121, v222
    v_mul_f32 v122, v122, v223
    v_mul_f32 v123, v123, v224
    v_mul_f32 v124, v124, v221
    v_mul_f32 v125, v125, v222
    v_mul_f32 v126, v126, v223
    v_mul_f32 v127, v127, v224
    v_exp_f32 v208, v128
    s_nop 0
    v_exp_f32 v209, v129
    s_nop 0
    v_exp_f32 v210, v130
    s_nop 0
    v_cvt_pk_bf16_f32 v160, v208, v209
    v_exp_f32 v211, v131
    s_nop 0
    v_exp_f32 v212, v136
    s_nop 0
    v_cvt_pk_bf16_f32 v161, v210, v211
    v_exp_f32 v213, v137
    s_nop 0
    v_exp_f32 v214, v138
    s_nop 0
    v_cvt_pk_bf16_f32 v162, v212, v213
    v_exp_f32 v215, v139
    s_nop 0
    v_exp_f32 v208, v132
    s_nop 0
    v_cvt_pk_bf16_f32 v163, v214, v215
    v_or3_b32 v197, v160, v161, v162
    v_exp_f32 v209, v133
    s_nop 0
    v_exp_f32 v210, v134
    s_nop 0
    v_cvt_pk_bf16_f32 v164, v208, v209
    v_exp_f32 v211, v135
    s_nop 0
    v_exp_f32 v212, v140
    s_nop 0
    v_cvt_pk_bf16_f32 v165, v210, v211
    v_or3_b32 v197, v197, v163, v164
    v_exp_f32 v213, v141
    s_nop 0
    v_exp_f32 v214, v142
    s_nop 0
    v_cvt_pk_bf16_f32 v166, v212, v213
    v_exp_f32 v215, v143
    s_nop 0
    v_or3_b32 v197, v197, v165, v166
    v_cvt_pk_bf16_f32 v167, v214, v215
    v_or_b32 v197, v197, v167
    v_and_b32 v197, s48, v197
    v_cmp_ne_u32 vcc, 0, v197
    s_nop 1
    s_branch L_fback1_1
L_frare1_2:
    s_nop 7
    v_and_b32 v220, 48, v216
    v_max3_f32 v217, v144, v145, v146
    v_max3_f32 v217, v217, v147, v152
    v_max3_f32 v217, v217, v153, v154
    v_max_f32 v217, v217, v155
    v_mov_b32 v218, v217
    s_nop 1
    v_permlane32_swap_b32 v217, v218
    s_nop 0
    v_max_f32 v217, v217, v218
    v_mov_b32 v218, v217
    s_nop 1
    v_permlane16_swap_b32 v217, v218
    s_nop 0
    v_max_f32 v217, v217, v218
    v_add_f32 v217, 0x41c00000, v217
    v_max_f32 v217, 0, v217
    v_ceil_f32 v217, v217
    v_sub_f32 v219, 0, v217
    v_exp_f32 v219, v219
    v_sub_f32 v232, v232, v217
    v_sub_f32 v233, v233, v217
    v_sub_f32 v234, v234, v217
    v_sub_f32 v235, v235, v217
    v_sub_f32 v128, v128, v217
    v_sub_f32 v129, v129, v217
    v_sub_f32 v130, v130, v217
    v_sub_f32 v131, v131, v217
    v_sub_f32 v136, v136, v217
    v_sub_f32 v137, v137, v217
    v_sub_f32 v138, v138, v217
    v_sub_f32 v139, v139, v217
    v_sub_f32 v144, v144, v217
    v_sub_f32 v145, v145, v217
    v_sub_f32 v146, v146, v217
    v_sub_f32 v147, v147, v217
    v_sub_f32 v152, v152, v217
    v_sub_f32 v153, v153, v217
    v_sub_f32 v154, v154, v217
    v_sub_f32 v155, v155, v217
    ds_bpermute_b32 v221, v220, v219 offset:0
    ds_bpermute_b32 v222, v220, v219 offset:4
    ds_bpermute_b32 v223, v220, v219 offset:8
    ds_bpermute_b32 v224, v220, v219 offset:12
    v_lshlrev_b32 v225, 16, v168
    v_and_b32 v226, 0xffff0000, v168
    v_mul_f32 v225, v225, v219
    v_mul_f32 v226, v226, v219
    v_cvt_pk_bf16_f32 v168, v225, v226
    v_lshlrev_b32 v225, 16, v169
    v_and_b32 v226, 0xffff0000, v169
    v_mul_f32 v225, v225, v219
    v_mul_f32 v226, v226, v219
    v_cvt_pk_bf16_f32 v169, v225, v226
    v_lshlrev_b32 v225, 16, v170
    v_and_b32 v226, 0xffff0000, v170
    v_mul_f32 v225, v225, v219
    v_mul_f32 v226, v226, v219
    v_cvt_pk_bf16_f32 v170, v225, v226
    v_lshlrev_b32 v225, 16, v171
    v_and_b32 v226, 0xffff0000, v171
    v_mul_f32 v225, v225, v219
    v_mul_f32 v226, v226, v219
    v_cvt_pk_bf16_f32 v171, v225, v226
    v_lshlrev_b32 v225, 16, v160
    v_and_b32 v226, 0xffff0000, v160
    v_mul_f32 v225, v225, v219
    v_mul_f32 v226, v226, v219
    v_cvt_pk_bf16_f32 v160, v225, v226
    v_lshlrev_b32 v225, 16, v161
    v_and_b32 v226, 0xffff0000, v161
    v_mul_f32 v225, v225, v219
    v_mul_f32 v226, v226, v219
    v_cvt_pk_bf16_f32 v161, v225, v226
    v_lshlrev_b32 v225, 16, v162
    v_and_b32 v226, 0xffff0000, v162
    v_mul_f32 v225, v225, v219
    v_mul_f32 v226, v226, v219
    v_cvt_pk_bf16_f32 v162, v225, v226
    v_lshlrev_b32 v225, 16, v163
    v_and_b32 v226, 0xffff0000, v163
    v_mul_f32 v225, v225, v219
    v_mul_f32 v226, v226, v219
    v_cvt_pk_bf16_f32 v163, v225, v226
    s_waitcnt lgkmcnt(0)
    v_mul_f32 v200, v200, v221
    v_mul_f32 v201, v201, v222
    v_mul_f32 v202, v202, v223
    v_mul_f32 v203, v203, v224
    v_mul_f32 v0, v0, v221
    v_mul_f32 v1, v1, v222
    v_mul_f32 v2, v2, v223
    v_mul_f32 v3, v3, v224
    v_mul_f32 v4, v4, v221
    v_mul_f32 v5, v5, v222
    v_mul_f32 v6, v6, v223
    v_mul_f32 v7, v7, v224
    v_mul_f32 v8, v8, v221
    v_mul_f32 v9, v9, v222
    v_mul_f32 v10, v10, v223
    v_mul_f32 v11, v11, v224
    v_mul_f32 v12, v12, v221
    v_mul_f32 v13, v13, v222
    v_mul_f32 v14, v14, v223
    v_mul_f32 v15, v15, v224
    v_mul_f32 v16, v16, v221
    v_mul_f32 v17, v17, v222
    v_mul_f32 v18, v18, v223
    v_mul_f32 v19, v19, v224
    v_mul_f32 v20, v20, v221
    v_mul_f32 v21, v21, v222
    v_mul_f32 v22, v22, v223
    v_mul_f32 v23, v23, v224
    v_mul_f32 v24, v24, v221
    v_mul_f32 v25, v25, v222
    v_mul_f32 v26, v26, v223
    v_mul_f32 v27, v27, v224
    v_mul_f32 v28, v28, v221
    v_mul_f32 v29, v29, v222
    v_mul_f32 v30, v30, v223
    v_mul_f32 v31, v31, v224
    v_mul_f32 v32, v32, v221
    v_mul_f32 v33, v33, v222
    v_mul_f32 v34, v34, v223
    v_mul_f32 v35, v35, v224
    v_mul_f32 v36, v36, v221
    v_mul_f32 v37, v37, v222
    v_mul_f32 v38, v38, v223
    v_mul_f32 v39, v39, v224
    v_mul_f32 v40, v40, v221
    v_mul_f32 v41, v41, v222
    v_mul_f32 v42, v42, v223
    v_mul_f32 v43, v43, v224
    v_mul_f32 v44, v44, v221
    v_mul_f32 v45, v45, v222
    v_mul_f32 v46, v46, v223
    v_mul_f32 v47, v47, v224
    v_mul_f32 v48, v48, v221
    v_mul_f32 v49, v49, v222
    v_mul_f32 v50, v50, v223
    v_mul_f32 v51, v51, v224
    v_mul_f32 v52, v52, v221
    v_mul_f32 v53, v53, v222
    v_mul_f32 v54, v54, v223
    v_mul_f32 v55, v55, v224
    v_mul_f32 v56, v56, v221
    v_mul_f32 v57, v57, v222
    v_mul_f32 v58, v58, v223
    v_mul_f32 v59, v59, v224
    v_mul_f32 v60, v60, v221
    v_mul_f32 v61, v61, v222
    v_mul_f32 v62, v62, v223
    v_mul_f32 v63, v63, v224
    v_max3_f32 v217, v148, v149, v150
    v_max3_f32 v217, v217, v151, v156
    v_max3_f32 v217, v217, v157, v158
    v_max_f32 v217, v217, v159
    v_mov_b32 v218, v217
    s_nop 1
    v_permlane32_swap_b32 v217, v218
    s_nop 0
    v_max_f32 v217, v217, v218
    v_mov_b32 v218, v217
    s_nop 1
    v_permlane16_swap_b32 v217, v218
    s_nop 0
    v_max_f32 v217, v217, v218
    v_add_f32 v217, 0x41c00000, v217
    v_max_f32 v217, 0, v217
    v_ceil_f32 v217, v217
    v_sub_f32 v219, 0, v217
    v_exp_f32 v219, v219
    v_sub_f32 v236, v236, v217
    v_sub_f32 v237, v237, v217
    v_sub_f32 v238, v238, v217
    v_sub_f32 v239, v239, v217
    v_sub_f32 v132, v132, v217
    v_sub_f32 v133, v133, v217
    v_sub_f32 v134, v134, v217
    v_sub_f32 v135, v135, v217
    v_sub_f32 v140, v140, v217
    v_sub_f32 v141, v141, v217
    v_sub_f32 v142, v142, v217
    v_sub_f32 v143, v143, v217
    v_sub_f32 v148, v148, v217
    v_sub_f32 v149, v149, v217
    v_sub_f32 v150, v150, v217
    v_sub_f32 v151, v151, v217
    v_sub_f32 v156, v156, v217
    v_sub_f32 v157, v157, v217
    v_sub_f32 v158, v158, v217
    v_sub_f32 v159, v159, v217
    ds_bpermute_b32 v221, v220, v219 offset:0
    ds_bpermute_b32 v222, v220, v219 offset:4
    ds_bpermute_b32 v223, v220, v219 offset:8
    ds_bpermute_b32 v224, v220, v219 offset:12
    v_lshlrev_b32 v225, 16, v172
    v_and_b32 v226, 0xffff0000, v172
    v_mul_f32 v225, v225, v219
    v_mul_f32 v226, v226, v219
    v_cvt_pk_bf16_f32 v172, v225, v226
    v_lshlrev_b32 v225, 16, v173
    v_and_b32 v226, 0xffff0000, v173
    v_mul_f32 v225, v225, v219
    v_mul_f32 v226, v226, v219
    v_cvt_pk_bf16_f32 v173, v225, v226
    v_lshlrev_b32 v225, 16, v174
    v_and_b32 v226, 0xffff0000, v174
    v_mul_f32 v225, v225, v219
    v_mul_f32 v226, v226, v219
    v_cvt_pk_bf16_f32 v174, v225, v226
    v_lshlrev_b32 v225, 16, v175
    v_and_b32 v226, 0xffff0000, v175
    v_mul_f32 v225, v225, v219
    v_mul_f32 v226, v226, v219
    v_cvt_pk_bf16_f32 v175, v225, v226
    v_lshlrev_b32 v225, 16, v164
    v_and_b32 v226, 0xffff0000, v164
    v_mul_f32 v225, v225, v219
    v_mul_f32 v226, v226, v219
    v_cvt_pk_bf16_f32 v164, v225, v226
    v_lshlrev_b32 v225, 16, v165
    v_and_b32 v226, 0xffff0000, v165
    v_mul_f32 v225, v225, v219
    v_mul_f32 v226, v226, v219
    v_cvt_pk_bf16_f32 v165, v225, v226
    v_lshlrev_b32 v225, 16, v166
    v_and_b32 v226, 0xffff0000, v166
    v_mul_f32 v225, v225, v219
    v_mul_f32 v226, v226, v219
    v_cvt_pk_bf16_f32 v166, v225, v226
    v_lshlrev_b32 v225, 16, v167
    v_and_b32 v226, 0xffff0000, v167
    v_mul_f32 v225, v225, v219
    v_mul_f32 v226, v226, v219
    v_cvt_pk_bf16_f32 v167, v225, v226
    s_waitcnt lgkmcnt(0)
    v_mul_f32 v204, v204, v221
    v_mul_f32 v205, v205, v222
    v_mul_f32 v206, v206, v223
    v_mul_f32 v207, v207, v224
    v_mul_f32 v64, v64, v221
    v_mul_f32 v65, v65, v222
    v_mul_f32 v66, v66, v223
    v_mul_f32 v67, v67, v224
    v_mul_f32 v68, v68, v221
    v_mul_f32 v69, v69, v222
    v_mul_f32 v70, v70, v223
    v_mul_f32 v71, v71, v224
    v_mul_f32 v72, v72, v221
    v_mul_f32 v73, v73, v222
    v_mul_f32 v74, v74, v223
    v_mul_f32 v75, v75, v224
    v_mul_f32 v76, v76, v221
    v_mul_f32 v77, v77, v222
    v_mul_f32 v78, v78, v223
    v_mul_f32 v79, v79, v224
    v_mul_f32 v80, v80, v221
    v_mul_f32 v81, v81, v222
    v_mul_f32 v82, v82, v223
    v_mul_f32 v83, v83, v224
    v_mul_f32 v84, v84, v221
    v_mul_f32 v85, v85, v222
    v_mul_f32 v86, v86, v223
    v_mul_f32 v87, v87, v224
    v_mul_f32 v88, v88, v221
    v_mul_f32 v89, v89, v222
    v_mul_f32 v90, v90, v223
    v_mul_f32 v91, v91, v224
    v_mul_f32 v92, v92, v221
    v_mul_f32 v93, v93, v222
    v_mul_f32 v94, v94, v223
    v_mul_f32 v95, v95, v224
    v_mul_f32 v96, v96, v221
    v_mul_f32 v97, v97, v222
    v_mul_f32 v98, v98, v223
    v_mul_f32 v99, v99, v224
    v_mul_f32 v100, v100, v221
    v_mul_f32 v101, v101, v222
    v_mul_f32 v102, v102, v223
    v_mul_f32 v103, v103, v224
    v_mul_f32 v104, v104, v221
    v_mul_f32 v105, v105, v222
    v_mul_f32 v106, v106, v223
    v_mul_f32 v107, v107, v224
    v_mul_f32 v108, v108, v221
    v_mul_f32 v109, v109, v222
    v_mul_f32 v110, v110, v223
    v_mul_f32 v111, v111, v224
    v_mul_f32 v112, v112, v221
    v_mul_f32 v113, v113, v222
    v_mul_f32 v114, v114, v223
    v_mul_f32 v115, v115, v224
    v_mul_f32 v116, v116, v221
    v_mul_f32 v117, v117, v222
    v_mul_f32 v118, v118, v223
    v_mul_f32 v119, v119, v224
    v_mul_f32 v120, v120, v221
    v_mul_f32 v121, v121, v222
    v_mul_f32 v122, v122, v223
    v_mul_f32 v123, v123, v224
    v_mul_f32 v124, v124, v221
    v_mul_f32 v125, v125, v222
    v_mul_f32 v126, v126, v223
    v_mul_f32 v127, v127, v224
    v_exp_f32 v208, v144
    s_nop 0
    v_exp_f32 v209, v145
    s_nop 0
    v_exp_f32 v210, v146
    s_nop 0
    v_cvt_pk_bf16_f32 v240, v208, v209
    v_exp_f32 v211, v147
    s_nop 0
    v_exp_f32 v212, v152
    s_nop 0
    v_cvt_pk_bf16_f32 v241, v210, v211
    v_exp_f32 v213, v153
    s_nop 0
    v_exp_f32 v214, v154
    s_nop 0
    v_cvt_pk_bf16_f32 v242, v212, v213
    v_exp_f32 v215, v155
    s_nop 0
    v_exp_f32 v208, v148
    s_nop 0
    v_cvt_pk_bf16_f32 v243, v214, v215
    v_or3_b32 v197, v240, v241, v242
    v_exp_f32 v209, v149
    s_nop 0
    v_exp_f32 v210, v150
    s_nop 0
    v_cvt_pk_bf16_f32 v244, v208, v209
    v_exp_f32 v211, v151
    s_nop 0
    v_exp_f32 v212, v156
    s_nop 0
    v_cvt_pk_bf16_f32 v245, v210, v211
    v_or3_b32 v197, v197, v243, v244
    v_exp_f32 v213, v157
    s_nop 0
    v_exp_f32 v214, v158
    s_nop 0
    v_cvt_pk_bf16_f32 v246, v212, v213
    v_exp_f32 v215, v159
    s_nop 0
    v_or3_b32 v197, v197, v245, v246
    v_cvt_pk_bf16_f32 v247, v214, v215
    v_or_b32 v197, v197, v247
    v_and_b32 v197, s48, v197
    v_cmp_ne_u32 vcc, 0, v197
    s_nop 1
    s_branch L_fback1_2
L_frare1_3:
    s_nop 7
    v_and_b32 v220, 48, v216
    v_max3_f32 v217, v128, v129, v130
    v_max3_f32 v217, v217, v131, v136
    v_max3_f32 v217, v217, v137, v138
    v_max_f32 v217, v217, v139
    v_mov_b32 v218, v217
    s_nop 1
    v_permlane32_swap_b32 v217, v218
    s_nop 0
    v_max_f32 v217, v217, v218
    v_mov_b32 v218, v217
    s_nop 1
    v_permlane16_swap_b32 v217, v218
    s_nop 0
    v_max_f32 v217, v217, v218
    v_add_f32 v217, 0x41c00000, v217
    v_max_f32 v217, 0, v217
    v_ceil_f32 v217, v217
    v_sub_f32 v219, 0, v217
    v_exp_f32 v219, v219
    v_sub_f32 v232, v232, v217
    v_sub_f32 v233, v233, v217
    v_sub_f32 v234, v234, v217
    v_sub_f32 v235, v235, v217
    v_sub_f32 v128, v128, v217
    v_sub_f32 v129, v129, v217
    v_sub_f32 v130, v130, v217
    v_sub_f32 v131, v131, v217
    v_sub_f32 v136, v136, v217
    v_sub_f32 v137, v137, v217
    v_sub_f32 v138, v138, v217
    v_sub_f32 v139, v139, v217
    v_sub_f32 v144, v144, v217
    v_sub_f32 v145, v145, v217
    v_sub_f32 v146, v146, v217
    v_sub_f32 v147, v147, v217
    v_sub_f32 v152, v152, v217
    v_sub_f32 v153, v153, v217
    v_sub_f32 v154, v154, v217
    v_sub_f32 v155, v155, v217
    ds_bpermute_b32 v221, v220, v219 offset:0
    ds_bpermute_b32 v222, v220, v219 offset:4
    ds_bpermute_b32 v223, v220, v219 offset:8
    ds_bpermute_b32 v224, v220, v219 offset:12
    v_lshlrev_b32 v225, 16, v168
    v_and_b32 v226, 0xffff0000, v168
    v_mul_f32 v225, v225, v219
    v_mul_f32 v226, v226, v219
    v_cvt_pk_bf16_f32 v168, v225, v226
    v_lshlrev_b32 v225, 16, v169
    v_and_b32 v226, 0xffff0000, v169
    v_mul_f32 v225, v225, v219
    v_mul_f32 v226, v226, v219
    v_cvt_pk_bf16_f32 v169, v225, v226
    v_lshlrev_b32 v225, 16, v170
    v_and_b32 v226, 0xffff0000, v170
    v_mul_f32 v225, v225, v219
    v_mul_f32 v226, v226, v219
    v_cvt_pk_bf16_f32 v170, v225, v226
    v_lshlrev_b32 v225, 16, v171
    v_and_b32 v226, 0xffff0000, v171
    v_mul_f32 v225, v225, v219
    v_mul_f32 v226, v226, v219
    v_cvt_pk_bf16_f32 v171, v225, v226
    v_lshlrev_b32 v225, 16, v160
    v_and_b32 v226, 0xffff0000, v160
    v_mul_f32 v225, v225, v219
    v_mul_f32 v226, v226, v219
    v_cvt_pk_bf16_f32 v160, v225, v226
    v_lshlrev_b32 v225, 16, v161
    v_and_b32 v226, 0xffff0000, v161
    v_mul_f32 v225, v225, v219
    v_mul_f32 v226, v226, v219
    v_cvt_pk_bf16_f32 v161, v225, v226
    v_lshlrev_b32 v225, 16, v162
    v_and_b32 v226, 0xffff0000, v162
    v_mul_f32 v225, v225, v219
    v_mul_f32 v226, v226, v219
    v_cvt_pk_bf16_f32 v162, v225, v226
    v_lshlrev_b32 v225, 16, v163
    v_and_b32 v226, 0xffff0000, v163
    v_mul_f32 v225, v225, v219
    v_mul_f32 v226, v226, v219
    v_cvt_pk_bf16_f32 v163, v225, v226
    v_lshlrev_b32 v225, 16, v240
    v_and_b32 v226, 0xffff0000, v240
    v_mul_f32 v225, v225, v219
    v_mul_f32 v226, v226, v219
    v_cvt_pk_bf16_f32 v240, v225, v226
    v_lshlrev_b32 v225, 16, v241
    v_and_b32 v226, 0xffff0000, v241
    v_mul_f32 v225, v225, v219
    v_mul_f32 v226, v226, v219
    v_cvt_pk_bf16_f32 v241, v225, v226
    v_lshlrev_b32 v225, 16, v242
    v_and_b32 v226, 0xffff0000, v242
    v_mul_f32 v225, v225, v219
    v_mul_f32 v226, v226, v219
    v_cvt_pk_bf16_f32 v242, v225, v226
    v_lshlrev_b32 v225, 16, v243
    v_and_b32 v226, 0xffff0000, v243
    v_mul_f32 v225, v225, v219
    v_mul_f32 v226, v226, v219
    v_cvt_pk_bf16_f32 v243, v225, v226
    s_waitcnt lgkmcnt(0)
    v_mul_f32 v200, v200, v221
    v_mul_f32 v201, v201, v222
    v_mul_f32 v202, v202, v223
    v_mul_f32 v203, v203, v224
    v_mul_f32 v0, v0, v221
    v_mul_f32 v1, v1, v222
    v_mul_f32 v2, v2, v223
    v_mul_f32 v3, v3, v224
    v_mul_f32 v4, v4, v221
    v_mul_f32 v5, v5, v222
    v_mul_f32 v6, v6, v223
    v_mul_f32 v7, v7, v224
    v_mul_f32 v8, v8, v221
    v_mul_f32 v9, v9, v222
    v_mul_f32 v10, v10, v223
    v_mul_f32 v11, v11, v224
    v_mul_f32 v12, v12, v221
    v_mul_f32 v13, v13, v222
    v_mul_f32 v14, v14, v223
    v_mul_f32 v15, v15, v224
    v_mul_f32 v16, v16, v221
    v_mul_f32 v17, v17, v222
    v_mul_f32 v18, v18, v223
    v_mul_f32 v19, v19, v224
    v_mul_f32 v20, v20, v221
    v_mul_f32 v21, v21, v222
    v_mul_f32 v22, v22, v223
    v_mul_f32 v23, v23, v224
    v_mul_f32 v24, v24, v221
    v_mul_f32 v25, v25, v222
    v_mul_f32 v26, v26, v223
    v_mul_f32 v27, v27, v224
    v_mul_f32 v28, v28, v221
    v_mul_f32 v29, v29, v222
    v_mul_f32 v30, v30, v223
    v_mul_f32 v31, v31, v224
    v_mul_f32 v32, v32, v221
    v_mul_f32 v33, v33, v222
    v_mul_f32 v34, v34, v223
    v_mul_f32 v35, v35, v224
    v_mul_f32 v36, v36, v221
    v_mul_f32 v37, v37, v222
    v_mul_f32 v38, v38, v223
    v_mul_f32 v39, v39, v224
    v_mul_f32 v40, v40, v221
    v_mul_f32 v41, v41, v222
    v_mul_f32 v42, v42, v223
    v_mul_f32 v43, v43, v224
    v_mul_f32 v44, v44, v221
    v_mul_f32 v45, v45, v222
    v_mul_f32 v46, v46, v223
    v_mul_f32 v47, v47, v224
    v_mul_f32 v48, v48, v221
    v_mul_f32 v49, v49, v222
    v_mul_f32 v50, v50, v223
    v_mul_f32 v51, v51, v224
    v_mul_f32 v52, v52, v221
    v_mul_f32 v53, v53, v222
    v_mul_f32 v54, v54, v223
    v_mul_f32 v55, v55, v224
    v_mul_f32 v56, v56, v221
    v_mul_f32 v57, v57, v222
    v_mul_f32 v58, v58, v223
    v_mul_f32 v59, v59, v224
    v_mul_f32 v60, v60, v221
    v_mul_f32 v61, v61, v222
    v_mul_f32 v62, v62, v223
    v_mul_f32 v63, v63, v224
    v_max3_f32 v217, v132, v133, v134
    v_max3_f32 v217, v217, v135, v140
    v_max3_f32 v217, v217, v141, v142
    v_max_f32 v217, v217, v143
    v_mov_b32 v218, v217
    s_nop 1
    v_permlane32_swap_b32 v217, v218
    s_nop 0
    v_max_f32 v217, v217, v218
    v_mov_b32 v218, v217
    s_nop 1
    v_permlane16_swap_b32 v217, v218
    s_nop 0
    v_max_f32 v217, v217, v218
    v_add_f32 v217, 0x41c00000, v217
    v_max_f32 v217, 0, v217
    v_ceil_f32 v217, v217
    v_sub_f32 v219, 0, v217
    v_exp_f32 v219, v219
    v_sub_f32 v236, v236, v217
    v_sub_f32 v237, v237, v217
    v_sub_f32 v238, v238, v217
    v_sub_f32 v239, v239, v217
    v_sub_f32 v132, v132, v217
    v_sub_f32 v133, v133, v217
    v_sub_f32 v134, v134, v217
    v_sub_f32 v135, v135, v217
    v_sub_f32 v140, v140, v217
    v_sub_f32 v141, v141, v217
    v_sub_f32 v142, v142, v217
    v_sub_f32 v143, v143, v217
    v_sub_f32 v148, v148, v217
    v_sub_f32 v149, v149, v217
    v_sub_f32 v150, v150, v217
    v_sub_f32 v151, v151, v217
    v_sub_f32 v156, v156, v217
    v_sub_f32 v157, v157, v217
    v_sub_f32 v158, v158, v217
    v_sub_f32 v159, v159, v217
    ds_bpermute_b32 v221, v220, v219 offset:0
    ds_bpermute_b32 v222, v220, v219 offset:4
    ds_bpermute_b32 v223, v220, v219 offset:8
    ds_bpermute_b32 v224, v220, v219 offset:12
    v_lshlrev_b32 v225, 16, v172
    v_and_b32 v226, 0xffff0000, v172
    v_mul_f32 v225, v225, v219
    v_mul_f32 v226, v226, v219
    v_cvt_pk_bf16_f32 v172, v225, v226
    v_lshlrev_b32 v225, 16, v173
    v_and_b32 v226, 0xffff0000, v173
    v_mul_f32 v225, v225, v219
    v_mul_f32 v226, v226, v219
    v_cvt_pk_bf16_f32 v173, v225, v226
    v_lshlrev_b32 v225, 16, v174
    v_and_b32 v226, 0xffff0000, v174
    v_mul_f32 v225, v225, v219
    v_mul_f32 v226, v226, v219
    v_cvt_pk_bf16_f32 v174, v225, v226
    v_lshlrev_b32 v225, 16, v175
    v_and_b32 v226, 0xffff0000, v175
    v_mul_f32 v225, v225, v219
    v_mul_f32 v226, v226, v219
    v_cvt_pk_bf16_f32 v175, v225, v226
    v_lshlrev_b32 v225, 16, v164
    v_and_b32 v226, 0xffff0000, v164
    v_mul_f32 v225, v225, v219
    v_mul_f32 v226, v226, v219
    v_cvt_pk_bf16_f32 v164, v225, v226
    v_lshlrev_b32 v225, 16, v165
    v_and_b32 v226, 0xffff0000, v165
    v_mul_f32 v225, v225, v219
    v_mul_f32 v226, v226, v219
    v_cvt_pk_bf16_f32 v165, v225, v226
    v_lshlrev_b32 v225, 16, v166
    v_and_b32 v226, 0xffff0000, v166
    v_mul_f32 v225, v225, v219
    v_mul_f32 v226, v226, v219
    v_cvt_pk_bf16_f32 v166, v225, v226
    v_lshlrev_b32 v225, 16, v167
    v_and_b32 v226, 0xffff0000, v167
    v_mul_f32 v225, v225, v219
    v_mul_f32 v226, v226, v219
    v_cvt_pk_bf16_f32 v167, v225, v226
    v_lshlrev_b32 v225, 16, v244
    v_and_b32 v226, 0xffff0000, v244
    v_mul_f32 v225, v225, v219
    v_mul_f32 v226, v226, v219
    v_cvt_pk_bf16_f32 v244, v225, v226
    v_lshlrev_b32 v225, 16, v245
    v_and_b32 v226, 0xffff0000, v245
    v_mul_f32 v225, v225, v219
    v_mul_f32 v226, v226, v219
    v_cvt_pk_bf16_f32 v245, v225, v226
    v_lshlrev_b32 v225, 16, v246
    v_and_b32 v226, 0xffff0000, v246
    v_mul_f32 v225, v225, v219
    v_mul_f32 v226, v226, v219
    v_cvt_pk_bf16_f32 v246, v225, v226
    v_lshlrev_b32 v225, 16, v247
    v_and_b32 v226, 0xffff0000, v247
    v_mul_f32 v225, v225, v219
    v_mul_f32 v226, v226, v219
    v_cvt_pk_bf16_f32 v247, v225, v226
    s_waitcnt lgkmcnt(0)
    v_mul_f32 v204, v204, v221
    v_mul_f32 v205, v205, v222
    v_mul_f32 v206, v206, v223
    v_mul_f32 v207, v207, v224
    v_mul_f32 v64, v64, v221
    v_mul_f32 v65, v65, v222
    v_mul_f32 v66, v66, v223
    v_mul_f32 v67, v67, v224
    v_mul_f32 v68, v68, v221
    v_mul_f32 v69, v69, v222
    v_mul_f32 v70, v70, v223
    v_mul_f32 v71, v71, v224
    v_mul_f32 v72, v72, v221
    v_mul_f32 v73, v73, v222
    v_mul_f32 v74, v74, v223
    v_mul_f32 v75, v75, v224
    v_mul_f32 v76, v76, v221
    v_mul_f32 v77, v77, v222
    v_mul_f32 v78, v78, v223
    v_mul_f32 v79, v79, v224
    v_mul_f32 v80, v80, v221
    v_mul_f32 v81, v81, v222
    v_mul_f32 v82, v82, v223
    v_mul_f32 v83, v83, v224
    v_mul_f32 v84, v84, v221
    v_mul_f32 v85, v85, v222
    v_mul_f32 v86, v86, v223
    v_mul_f32 v87, v87, v224
    v_mul_f32 v88, v88, v221
    v_mul_f32 v89, v89, v222
    v_mul_f32 v90, v90, v223
    v_mul_f32 v91, v91, v224
    v_mul_f32 v92, v92, v221
    v_mul_f32 v93, v93, v222
    v_mul_f32 v94, v94, v223
    v_mul_f32 v95, v95, v224
    v_mul_f32 v96, v96, v221
    v_mul_f32 v97, v97, v222
    v_mul_f32 v98, v98, v223
    v_mul_f32 v99, v99, v224
    v_mul_f32 v100, v100, v221
    v_mul_f32 v101, v101, v222
    v_mul_f32 v102, v102, v223
    v_mul_f32 v103, v103, v224
    v_mul_f32 v104, v104, v221
    v_mul_f32 v105, v105, v222
    v_mul_f32 v106, v106, v223
    v_mul_f32 v107, v107, v224
    v_mul_f32 v108, v108, v221
    v_mul_f32 v109, v109, v222
    v_mul_f32 v110, v110, v223
    v_mul_f32 v111, v111, v224
    v_mul_f32 v112, v112, v221
    v_mul_f32 v113, v113, v222
    v_mul_f32 v114, v114, v223
    v_mul_f32 v115, v115, v224
    v_mul_f32 v116, v116, v221
    v_mul_f32 v117, v117, v222
    v_mul_f32 v118, v118, v223
    v_mul_f32 v119, v119, v224
    v_mul_f32 v120, v120, v221
    v_mul_f32 v121, v121, v222
    v_mul_f32 v122, v122, v223
    v_mul_f32 v123, v123, v224
    v_mul_f32 v124, v124, v221
    v_mul_f32 v125, v125, v222
    v_mul_f32 v126, v126, v223
    v_mul_f32 v127, v127, v224
    v_exp_f32 v208, v128
    s_nop 0
    v_exp_f32 v209, v129
    s_nop 0
    v_exp_f32 v210, v130
    s_nop 0
    v_cvt_pk_bf16_f32 v248, v208, v209
    v_exp_f32 v211, v131
    s_nop 0
    v_exp_f32 v212, v136
    s_nop 0
    v_cvt_pk_bf16_f32 v249, v210, v211
    v_exp_f32 v213, v137
    s_nop 0
    v_exp_f32 v214, v138
    s_nop 0
    v_cvt_pk_bf16_f32 v250, v212, v213
    v_exp_f32 v215, v139
    s_nop 0
    v_exp_f32 v208, v132
    s_nop 0
    v_cvt_pk_bf16_f32 v251, v214, v215
    v_or3_b32 v197, v248, v249, v250
    v_exp_f32 v209, v133
    s_nop 0
    v_exp_f32 v210, v134
    s_nop 0
    v_cvt_pk_bf16_f32 v252, v208, v209
    v_exp_f32 v211, v135
    s_nop 0
    v_exp_f32 v212, v140
    s_nop 0
    v_cvt_pk_bf16_f32 v253, v210, v211
    v_or3_b32 v197, v197, v251, v252
    v_exp_f32 v213, v141
    s_nop 0
    v_exp_f32 v214, v142
    s_nop 0
    v_cvt_pk_bf16_f32 v254, v212, v213
    v_exp_f32 v215, v143
    s_nop 0
    v_or3_b32 v197, v197, v253, v254
    v_cvt_pk_bf16_f32 v255, v214, v215
    v_or_b32 v197, v197, v255
    v_and_b32 v197, s48, v197
    v_cmp_ne_u32 vcc, 0, v197
    s_nop 1
    s_branch L_fback1_3
L_frare2_1:
    s_nop 7
    v_and_b32 v220, 48, v216
    v_max3_f32 v217, v144, v145, v146
    v_max3_f32 v217, v217, v147, v152
    v_max3_f32 v217, v217, v153, v154
    v_max_f32 v217, v217, v155
    v_mov_b32 v218, v217
    s_nop 1
    v_permlane32_swap_b32 v217, v218
    s_nop 0
    v_max_f32 v217, v217, v218
    v_mov_b32 v218, v217
    s_nop 1
    v_permlane16_swap_b32 v217, v218
    s_nop 0
    v_max_f32 v217, v217, v218
    v_add_f32 v217, 0x41c00000, v217
    v_max_f32 v217, 0, v217
    v_ceil_f32 v217, v217
    v_sub_f32 v219, 0, v217
    v_exp_f32 v219, v219
    v_sub_f32 v232, v232, v217
    v_sub_f32 v233, v233, v217
    v_sub_f32 v234, v234, v217
    v_sub_f32 v235, v235, v217
    v_sub_f32 v128, v128, v217
    v_sub_f32 v129, v129, v217
    v_sub_f32 v130, v130, v217
    v_sub_f32 v131, v131, v217
    v_sub_f32 v136, v136, v217
    v_sub_f32 v137, v137, v217
    v_sub_f32 v138, v138, v217
    v_sub_f32 v139, v139, v217
    v_sub_f32 v144, v144, v217
    v_sub_f32 v145, v145, v217
    v_sub_f32 v146, v146, v217
    v_sub_f32 v147, v147, v217
    v_sub_f32 v152, v152, v217
    v_sub_f32 v153, v153, v217
    v_sub_f32 v154, v154, v217
    v_sub_f32 v155, v155, v217
    ds_bpermute_b32 v221, v220, v219 offset:0
    ds_bpermute_b32 v222, v220, v219 offset:4
    ds_bpermute_b32 v223, v220, v219 offset:8
    ds_bpermute_b32 v224, v220, v219 offset:12
    v_lshlrev_b32 v225, 16, v160
    v_and_b32 v226, 0xffff0000, v160
    v_mul_f32 v225, v225, v219
    v_mul_f32 v226, v226, v219
    v_cvt_pk_bf16_f32 v160, v225, v226
    v_lshlrev_b32 v225, 16, v161
    v_and_b32 v226, 0xffff0000, v161
    v_mul_f32 v225, v225, v219
    v_mul_f32 v226, v226, v219
    v_cvt_pk_bf16_f32 v161, v225, v226
    v_lshlrev_b32 v225, 16, v162
    v_and_b32 v226, 0xffff0000, v162
    v_mul_f32 v225, v225, v219
    v_mul_f32 v226, v226, v219
    v_cvt_pk_bf16_f32 v162, v225, v226
    v_lshlrev_b32 v225, 16, v163
    v_and_b32 v226, 0xffff0000, v163
    v_mul_f32 v225, v225, v219
    v_mul_f32 v226, v226, v219
    v_cvt_pk_bf16_f32 v163, v225, v226
    s_waitcnt lgkmcnt(0)
    v_mul_f32 v200, v200, v221
    v_mul_f32 v201, v201, v222
    v_mul_f32 v202, v202, v223
    v_mul_f32 v203, v203, v224
    v_mul_f32 v0, v0, v221
    v_mul_f32 v1, v1, v222
    v_mul_f32 v2, v2, v223
    v_mul_f32 v3, v3, v224
    v_mul_f32 v4, v4, v221
    v_mul_f32 v5, v5, v222
    v_mul_f32 v6, v6, v223
    v_mul_f32 v7, v7, v224
    v_mul_f32 v8, v8, v221
    v_mul_f32 v9, v9, v222
    v_mul_f32 v10, v10, v223
    v_mul_f32 v11, v11, v224
    v_mul_f32 v12, v12, v221
    v_mul_f32 v13, v13, v222
    v_mul_f32 v14, v14, v223
    v_mul_f32 v15, v15, v224
    v_mul_f32 v16, v16, v221
    v_mul_f32 v17, v17, v222
    v_mul_f32 v18, v18, v223
    v_mul_f32 v19, v19, v224
    v_mul_f32 v20, v20, v221
    v_mul_f32 v21, v21, v222
    v_mul_f32 v22, v22, v223
    v_mul_f32 v23, v23, v224
    v_mul_f32 v24, v24, v221
    v_mul_f32 v25, v25, v222
    v_mul_f32 v26, v26, v223
    v_mul_f32 v27, v27, v224
    v_mul_f32 v28, v28, v221
    v_mul_f32 v29, v29, v222
    v_mul_f32 v30, v30, v223
    v_mul_f32 v31, v31, v224
    v_mul_f32 v32, v32, v221
    v_mul_f32 v33, v33, v222
    v_mul_f32 v34, v34, v223
    v_mul_f32 v35, v35, v224
    v_mul_f32 v36, v36, v221
    v_mul_f32 v37, v37, v222
    v_mul_f32 v38, v38, v223
    v_mul_f32 v39, v39, v224
    v_mul_f32 v40, v40, v221
    v_mul_f32 v41, v41, v222
    v_mul_f32 v42, v42, v223
    v_mul_f32 v43, v43, v224
    v_mul_f32 v44, v44, v221
    v_mul_f32 v45, v45, v222
    v_mul_f32 v46, v46, v223
    v_mul_f32 v47, v47, v224
    v_mul_f32 v48, v48, v221
    v_mul_f32 v49, v49, v222
    v_mul_f32 v50, v50, v223
    v_mul_f32 v51, v51, v224
    v_mul_f32 v52, v52, v221
    v_mul_f32 v53, v53, v222
    v_mul_f32 v54, v54, v223
    v_mul_f32 v55, v55, v224
    v_mul_f32 v56, v56, v221
    v_mul_f32 v57, v57, v222
    v_mul_f32 v58, v58, v223
    v_mul_f32 v59, v59, v224
    v_mul_f32 v60, v60, v221
    v_mul_f32 v61, v61, v222
    v_mul_f32 v62, v62, v223
    v_mul_f32 v63, v63, v224
    v_max3_f32 v217, v148, v149, v150
    v_max3_f32 v217, v217, v151, v156
    v_max3_f32 v217, v217, v157, v158
    v_max_f32 v217, v217, v159
    v_mov_b32 v218, v217
    s_nop 1
    v_permlane32_swap_b32 v217, v218
    s_nop 0
    v_max_f32 v217, v217, v218
    v_mov_b32 v218, v217
    s_nop 1
    v_permlane16_swap_b32 v217, v218
    s_nop 0
    v_max_f32 v217, v217, v218
    v_add_f32 v217, 0x41c00000, v217
    v_max_f32 v217, 0, v217
    v_ceil_f32 v217, v217
    v_sub_f32 v219, 0, v217
    v_exp_f32 v219, v219
    v_sub_f32 v236, v236, v217
    v_sub_f32 v237, v237, v217
    v_sub_f32 v238, v238, v217
    v_sub_f32 v239, v239, v217
    v_sub_f32 v132, v132, v217
    v_sub_f32 v133, v133, v217
    v_sub_f32 v134, v134, v217
    v_sub_f32 v135, v135, v217
    v_sub_f32 v140, v140, v217
    v_sub_f32 v141, v141, v217
    v_sub_f32 v142, v142, v217
    v_sub_f32 v143, v143, v217
    v_sub_f32 v148, v148, v217
    v_sub_f32 v149, v149, v217
    v_sub_f32 v150, v150, v217
    v_sub_f32 v151, v151, v217
    v_sub_f32 v156, v156, v217
    v_sub_f32 v157, v157, v217
    v_sub_f32 v158, v158, v217
    v_sub_f32 v159, v159, v217
    ds_bpermute_b32 v221, v220, v219 offset:0
    ds_bpermute_b32 v222, v220, v219 offset:4
    ds_bpermute_b32 v223, v220, v219 offset:8
    ds_bpermute_b32 v224, v220, v219 offset:12
    v_lshlrev_b32 v225, 16, v164
    v_and_b32 v226, 0xffff0000, v164
    v_mul_f32 v225, v225, v219
    v_mul_f32 v226, v226, v219
    v_cvt_pk_bf16_f32 v164, v225, v226
    v_lshlrev_b32 v225, 16, v165
    v_and_b32 v226, 0xffff0000, v165
    v_mul_f32 v225, v225, v219
    v_mul_f32 v226, v226, v219
    v_cvt_pk_bf16_f32 v165, v225, v226
    v_lshlrev_b32 v225, 16, v166
    v_and_b32 v226, 0xffff0000, v166
    v_mul_f32 v225, v225, v219
    v_mul_f32 v226, v226, v219
    v_cvt_pk_bf16_f32 v166, v225, v226
    v_lshlrev_b32 v225, 16, v167
    v_and_b32 v226, 0xffff0000, v167
    v_mul_f32 v225, v225, v219
    v_mul_f32 v226, v226, v219
    v_cvt_pk_bf16_f32 v167, v225, v226
    s_waitcnt lgkmcnt(0)
    v_mul_f32 v204, v204, v221
    v_mul_f32 v205, v205, v222
    v_mul_f32 v206, v206, v223
    v_mul_f32 v207, v207, v224
    v_mul_f32 v64, v64, v221
    v_mul_f32 v65, v65, v222
    v_mul_f32 v66, v66, v223
    v_mul_f32 v67, v67, v224
    v_mul_f32 v68, v68, v221
    v_mul_f32 v69, v69, v222
    v_mul_f32 v70, v70, v223
    v_mul_f32 v71, v71, v224
    v_mul_f32 v72, v72, v221
    v_mul_f32 v73, v73, v222
    v_mul_f32 v74, v74, v223
    v_mul_f32 v75, v75, v224
    v_mul_f32 v76, v76, v221
    v_mul_f32 v77, v77, v222
    v_mul_f32 v78, v78, v223
    v_mul_f32 v79, v79, v224
    v_mul_f32 v80, v80, v221
    v_mul_f32 v81, v81, v222
    v_mul_f32 v82, v82, v223
    v_mul_f32 v83, v83, v224
    v_mul_f32 v84, v84, v221
    v_mul_f32 v85, v85, v222
    v_mul_f32 v86, v86, v223
    v_mul_f32 v87, v87, v224
    v_mul_f32 v88, v88, v221
    v_mul_f32 v89, v89, v222
    v_mul_f32 v90, v90, v223
    v_mul_f32 v91, v91, v224
    v_mul_f32 v92, v92, v221
    v_mul_f32 v93, v93, v222
    v_mul_f32 v94, v94, v223
    v_mul_f32 v95, v95, v224
    v_mul_f32 v96, v96, v221
    v_mul_f32 v97, v97, v222
    v_mul_f32 v98, v98, v223
    v_mul_f32 v99, v99, v224
    v_mul_f32 v100, v100, v221
    v_mul_f32 v101, v101, v222
    v_mul_f32 v102, v102, v223
    v_mul_f32 v103, v103, v224
    v_mul_f32 v104, v104, v221
    v_mul_f32 v105, v105, v222
    v_mul_f32 v106, v106, v223
    v_mul_f32 v107, v107, v224
    v_mul_f32 v108, v108, v221
    v_mul_f32 v109, v109, v222
    v_mul_f32 v110, v110, v223
    v_mul_f32 v111, v111, v224
    v_mul_f32 v112, v112, v221
    v_mul_f32 v113, v113, v222
    v_mul_f32 v114, v114, v223
    v_mul_f32 v115, v115, v224
    v_mul_f32 v116, v116, v221
    v_mul_f32 v117, v117, v222
    v_mul_f32 v118, v118, v223
    v_mul_f32 v119, v119, v224
    v_mul_f32 v120, v120, v221
    v_mul_f32 v121, v121, v222
    v_mul_f32 v122, v122, v223
    v_mul_f32 v123, v123, v224
    v_mul_f32 v124, v124, v221
    v_mul_f32 v125, v125, v222
    v_mul_f32 v126, v126, v223
    v_mul_f32 v127, v127, v224
    v_exp_f32 v208, v144
    s_nop 0
    v_exp_f32 v209, v145
    s_nop 0
    v_exp_f32 v210, v146
    s_nop 0
    v_cvt_pk_bf16_f32 v168, v208, v209
    v_exp_f32 v211, v147
    s_nop 0
    v_exp_f32 v212, v152
    s_nop 0
    v_cvt_pk_bf16_f32 v169, v210, v211
    v_exp_f32 v213, v153
    s_nop 0
    v_exp_f32 v214, v154
    s_nop 0
    v_cvt_pk_bf16_f32 v170, v212, v213
    v_exp_f32 v215, v155
    s_nop 0
    v_exp_f32 v208, v148
    s_nop 0
    v_cvt_pk_bf16_f32 v171, v214, v215
    v_or3_b32 v197, v168, v169, v170
    v_exp_f32 v209, v149
    s_nop 0
    v_exp_f32 v210, v150
    s_nop 0
    v_cvt_pk_bf16_f32 v172, v208, v209
    v_exp_f32 v211, v151
    s_nop 0
    v_exp_f32 v212, v156
    s_nop 0
    v_cvt_pk_bf16_f32 v173, v210, v211
    v_or3_b32 v197, v197, v171, v172
    v_exp_f32 v213, v157
    s_nop 0
    v_exp_f32 v214, v158
    s_nop 0
    v_cvt_pk_bf16_f32 v174, v212, v213
    v_exp_f32 v215, v159
    s_nop 0
    v_or3_b32 v197, v197, v173, v174
    v_cvt_pk_bf16_f32 v175, v214, v215
    v_or_b32 v197, v197, v175
    v_and_b32 v197, s48, v197
    v_cmp_ne_u32 vcc, 0, v197
    s_nop 1
    s_branch L_fback2_1
L_frare2_2:
    s_nop 7
    v_and_b32 v220, 48, v216
    v_max3_f32 v217, v128, v129, v130
    v_max3_f32 v217, v217, v131, v136
    v_max3_f32 v217, v217, v137, v138
    v_max_f32 v217, v217, v139
    v_mov_b32 v218, v217
    s_nop 1
    v_permlane32_swap_b32 v217, v218
    s_nop 0
    v_max_f32 v217, v217, v218
    v_mov_b32 v218, v217
    s_nop 1
    v_permlane16_swap_b32 v217, v218
    s_nop 0
    v_max_f32 v217, v217, v218
    v_add_f32 v217, 0x41c00000, v217
    v_max_f32 v217, 0, v217
    v_ceil_f32 v217, v217
    v_sub_f32 v219, 0, v217
    v_exp_f32 v219, v219
    v_sub_f32 v232, v232, v217
    v_sub_f32 v233, v233, v217
    v_sub_f32 v234, v234, v217
    v_sub_f32 v235, v235, v217
    v_sub_f32 v128, v128, v217
    v_sub_f32 v129, v129, v217
    v_sub_f32 v130, v130, v217
    v_sub_f32 v131, v131, v217
    v_sub_f32 v136, v136, v217
    v_sub_f32 v137, v137, v217
    v_sub_f32 v138, v138, v217
    v_sub_f32 v139, v139, v217
    v_sub_f32 v144, v144, v217
    v_sub_f32 v145, v145, v217
    v_sub_f32 v146, v146, v217
    v_sub_f32 v147, v147, v217
    v_sub_f32 v152, v152, v217
    v_sub_f32 v153, v153, v217
    v_sub_f32 v154, v154, v217
    v_sub_f32 v155, v155, v217
    ds_bpermute_b32 v221, v220, v219 offset:0
    ds_bpermute_b32 v222, v220, v219 offset:4
    ds_bpermute_b32 v223, v220, v219 offset:8
    ds_bpermute_b32 v224, v220, v219 offset:12
    v_lshlrev_b32 v225, 16, v160
    v_and_b32 v226, 0xffff0000, v160
    v_mul_f32 v225, v225, v219
    v_mul_f32 v226, v226, v219
    v_cvt_pk_bf16_f32 v160, v225, v226
    v_lshlrev_b32 v225, 16, v161
    v_and_b32 v226, 0xffff0000, v161
    v_mul_f32 v225, v225, v219
    v_mul_f32 v226, v226, v219
    v_cvt_pk_bf16_f32 v161, v225, v226
    v_lshlrev_b32 v225, 16, v162
    v_and_b32 v226, 0xffff0000, v162
    v_mul_f32 v225, v225, v219
    v_mul_f32 v226, v226, v219
    v_cvt_pk_bf16_f32 v162, v225, v226
    v_lshlrev_b32 v225, 16, v163
    v_and_b32 v226, 0xffff0000, v163
    v_mul_f32 v225, v225, v219
    v_mul_f32 v226, v226, v219
    v_cvt_pk_bf16_f32 v163, v225, v226
    v_lshlrev_b32 v225, 16, v168
    v_and_b32 v226, 0xffff0000, v168
    v_mul_f32 v225, v225, v219
    v_mul_f32 v226, v226, v219
    v_cvt_pk_bf16_f32 v168, v225, v226
    v_lshlrev_b32 v225, 16, v169
    v_and_b32 v226, 0xffff0000, v169
    v_mul_f32 v225, v225, v219
    v_mul_f32 v226, v226, v219
    v_cvt_pk_bf16_f32 v169, v225, v226
    v_lshlrev_b32 v225, 16, v170
    v_and_b32 v226, 0xffff0000, v170
    v_mul_f32 v225, v225, v219
    v_mul_f32 v226, v226, v219
    v_cvt_pk_bf16_f32 v170, v225, v226
    v_lshlrev_b32 v225, 16, v171
    v_and_b32 v226, 0xffff0000, v171
    v_mul_f32 v225, v225, v219
    v_mul_f32 v226, v226, v219
    v_cvt_pk_bf16_f32 v171, v225, v226
    s_waitcnt lgkmcnt(0)
    v_mul_f32 v200, v200, v221
    v_mul_f32 v201, v201, v222
    v_mul_f32 v202, v202, v223
    v_mul_f32 v203, v203, v224
    v_mul_f32 v0, v0, v221
    v_mul_f32 v1, v1, v222
    v_mul_f32 v2, v2, v223
    v_mul_f32 v3, v3, v224
    v_mul_f32 v4, v4, v221
    v_mul_f32 v5, v5, v222
    v_mul_f32 v6, v6, v223
    v_mul_f32 v7, v7, v224
    v_mul_f32 v8, v8, v221
    v_mul_f32 v9, v9, v222
    v_mul_f32 v10, v10, v223
    v_mul_f32 v11, v11, v224
    v_mul_f32 v12, v12, v221
    v_mul_f32 v13, v13, v222
    v_mul_f32 v14, v14, v223
    v_mul_f32 v15, v15, v224
    v_mul_f32 v16, v16, v221
    v_mul_f32 v17, v17, v222
    v_mul_f32 v18, v18, v223
    v_mul_f32 v19, v19, v224
    v_mul_f32 v20, v20, v221
    v_mul_f32 v21, v21, v222
    v_mul_f32 v22, v22, v223
    v_mul_f32 v23, v23, v224
    v_mul_f32 v24, v24, v221
    v_mul_f32 v25, v25, v222
    v_mul_f32 v26, v26, v223
    v_mul_f32 v27, v27, v224
    v_mul_f32 v28, v28, v221
    v_mul_f32 v29, v29, v222
    v_mul_f32 v30, v30, v223
    v_mul_f32 v31, v31, v224
    v_mul_f32 v32, v32, v221
    v_mul_f32 v33, v33, v222
    v_mul_f32 v34, v34, v223
    v_mul_f32 v35, v35, v224
    v_mul_f32 v36, v36, v221
    v_mul_f32 v37, v37, v222
    v_mul_f32 v38, v38, v223
    v_mul_f32 v39, v39, v224
    v_mul_f32 v40, v40, v221
    v_mul_f32 v41, v41, v222
    v_mul_f32 v42, v42, v223
    v_mul_f32 v43, v43, v224
    v_mul_f32 v44, v44, v221
    v_mul_f32 v45, v45, v222
    v_mul_f32 v46, v46, v223
    v_mul_f32 v47, v47, v224
    v_mul_f32 v48, v48, v221
    v_mul_f32 v49, v49, v222
    v_mul_f32 v50, v50, v223
    v_mul_f32 v51, v51, v224
    v_mul_f32 v52, v52, v221
    v_mul_f32 v53, v53, v222
    v_mul_f32 v54, v54, v223
    v_mul_f32 v55, v55, v224
    v_mul_f32 v56, v56, v221
    v_mul_f32 v57, v57, v222
    v_mul_f32 v58, v58, v223
    v_mul_f32 v59, v59, v224
    v_mul_f32 v60, v60, v221
    v_mul_f32 v61, v61, v222
    v_mul_f32 v62, v62, v223
    v_mul_f32 v63, v63, v224
    v_max3_f32 v217, v132, v133, v134
    v_max3_f32 v217, v217, v135, v140
    v_max3_f32 v217, v217, v141, v142
    v_max_f32 v217, v217, v143
    v_mov_b32 v218, v217
    s_nop 1
    v_permlane32_swap_b32 v217, v218
    s_nop 0
    v_max_f32 v217, v217, v218
    v_mov_b32 v218, v217
    s_nop 1
    v_permlane16_swap_b32 v217, v218
    s_nop 0
    v_max_f32 v217, v217, v218
    v_add_f32 v217, 0x41c00000, v217
    v_max_f32 v217, 0, v217
    v_ceil_f32 v217, v217
    v_sub_f32 v219, 0, v217
    v_exp_f32 v219, v219
    v_sub_f32 v236, v236, v217
    v_sub_f32 v237, v237, v217
    v_sub_f32 v238, v238, v217
    v_sub_f32 v239, v239, v217
    v_sub_f32 v132, v132, v217
    v_sub_f32 v133, v133, v217
    v_sub_f32 v134, v134, v217
    v_sub_f32 v135, v135, v217
    v_sub_f32 v140, v140, v217
    v_sub_f32 v141, v141, v217
    v_sub_f32 v142, v142, v217
    v_sub_f32 v143, v143, v217
    v_sub_f32 v148, v148, v217
    v_sub_f32 v149, v149, v217
    v_sub_f32 v150, v150, v217
    v_sub_f32 v151, v151, v217
    v_sub_f32 v156, v156, v217
    v_sub_f32 v157, v157, v217
    v_sub_f32 v158, v158, v217
    v_sub_f32 v159, v159, v217
    ds_bpermute_b32 v221, v220, v219 offset:0
    ds_bpermute_b32 v222, v220, v219 offset:4
    ds_bpermute_b32 v223, v220, v219 offset:8
    ds_bpermute_b32 v224, v220, v219 offset:12
    v_lshlrev_b32 v225, 16, v164
    v_and_b32 v226, 0xffff0000, v164
    v_mul_f32 v225, v225, v219
    v_mul_f32 v226, v226, v219
    v_cvt_pk_bf16_f32 v164, v225, v226
    v_lshlrev_b32 v225, 16, v165
    v_and_b32 v226, 0xffff0000, v165
    v_mul_f32 v225, v225, v219
    v_mul_f32 v226, v226, v219
    v_cvt_pk_bf16_f32 v165, v225, v226
    v_lshlrev_b32 v225, 16, v166
    v_and_b32 v226, 0xffff0000, v166
    v_mul_f32 v225, v225, v219
    v_mul_f32 v226, v226, v219
    v_cvt_pk_bf16_f32 v166, v225, v226
    v_lshlrev_b32 v225, 16, v167
    v_and_b32 v226, 0xffff0000, v167
    v_mul_f32 v225, v225, v219
    v_mul_f32 v226, v226, v219
    v_cvt_pk_bf16_f32 v167, v225, v226
    v_lshlrev_b32 v225, 16, v172
    v_and_b32 v226, 0xffff0000, v172
    v_mul_f32 v225, v225, v219
    v_mul_f32 v226, v226, v219
    v_cvt_pk_bf16_f32 v172, v225, v226
    v_lshlrev_b32 v225, 16, v173
    v_and_b32 v226, 0xffff0000, v173
    v_mul_f32 v225, v225, v219
    v_mul_f32 v226, v226, v219
    v_cvt_pk_bf16_f32 v173, v225, v226
    v_lshlrev_b32 v225, 16, v174
    v_and_b32 v226, 0xffff0000, v174
    v_mul_f32 v225, v225, v219
    v_mul_f32 v226, v226, v219
    v_cvt_pk_bf16_f32 v174, v225, v226
    v_lshlrev_b32 v225, 16, v175
    v_and_b32 v226, 0xffff0000, v175
    v_mul_f32 v225, v225, v219
    v_mul_f32 v226, v226, v219
    v_cvt_pk_bf16_f32 v175, v225, v226
    s_waitcnt lgkmcnt(0)
    v_mul_f32 v204, v204, v221
    v_mul_f32 v205, v205, v222
    v_mul_f32 v206, v206, v223
    v_mul_f32 v207, v207, v224
    v_mul_f32 v64, v64, v221
    v_mul_f32 v65, v65, v222
    v_mul_f32 v66, v66, v223
    v_mul_f32 v67, v67, v224
    v_mul_f32 v68, v68, v221
    v_mul_f32 v69, v69, v222
    v_mul_f32 v70, v70, v223
    v_mul_f32 v71, v71, v224
    v_mul_f32 v72, v72, v221
    v_mul_f32 v73, v73, v222
    v_mul_f32 v74, v74, v223
    v_mul_f32 v75, v75, v224
    v_mul_f32 v76, v76, v221
    v_mul_f32 v77, v77, v222
    v_mul_f32 v78, v78, v223
    v_mul_f32 v79, v79, v224
    v_mul_f32 v80, v80, v221
    v_mul_f32 v81, v81, v222
    v_mul_f32 v82, v82, v223
    v_mul_f32 v83, v83, v224
    v_mul_f32 v84, v84, v221
    v_mul_f32 v85, v85, v222
    v_mul_f32 v86, v86, v223
    v_mul_f32 v87, v87, v224
    v_mul_f32 v88, v88, v221
    v_mul_f32 v89, v89, v222
    v_mul_f32 v90, v90, v223
    v_mul_f32 v91, v91, v224
    v_mul_f32 v92, v92, v221
    v_mul_f32 v93, v93, v222
    v_mul_f32 v94, v94, v223
    v_mul_f32 v95, v95, v224
    v_mul_f32 v96, v96, v221
    v_mul_f32 v97, v97, v222
    v_mul_f32 v98, v98, v223
    v_mul_f32 v99, v99, v224
    v_mul_f32 v100, v100, v221
    v_mul_f32 v101, v101, v222
    v_mul_f32 v102, v102, v223
    v_mul_f32 v103, v103, v224
    v_mul_f32 v104, v104, v221
    v_mul_f32 v105, v105, v222
    v_mul_f32 v106, v106, v223
    v_mul_f32 v107, v107, v224
    v_mul_f32 v108, v108, v221
    v_mul_f32 v109, v109, v222
    v_mul_f32 v110, v110, v223
    v_mul_f32 v111, v111, v224
    v_mul_f32 v112, v112, v221
    v_mul_f32 v113, v113, v222
    v_mul_f32 v114, v114, v223
    v_mul_f32 v115, v115, v224
    v_mul_f32 v116, v116, v221
    v_mul_f32 v117, v117, v222
    v_mul_f32 v118, v118, v223
    v_mul_f32 v119, v119, v224
    v_mul_f32 v120, v120, v221
    v_mul_f32 v121, v121, v222
    v_mul_f32 v122, v122, v223
    v_mul_f32 v123, v123, v224
    v_mul_f32 v124, v124, v221
    v_mul_f32 v125, v125, v222
    v_mul_f32 v126, v126, v223
    v_mul_f32 v127, v127, v224
    v_exp_f32 v208, v128
    s_nop 0
    v_exp_f32 v209, v129
    s_nop 0
    v_exp_f32 v210, v130
    s_nop 0
    v_cvt_pk_bf16_f32 v240, v208, v209
    v_exp_f32 v211, v131
    s_nop 0
    v_exp_f32 v212, v136
    s_nop 0
    v_cvt_pk_bf16_f32 v241, v210, v211
    v_exp_f32 v213, v137
    s_nop 0
    v_exp_f32 v214, v138
    s_nop 0
    v_cvt_pk_bf16_f32 v242, v212, v213
    v_exp_f32 v215, v139
    s_nop 0
    v_exp_f32 v208, v132
    s_nop 0
    v_cvt_pk_bf16_f32 v243, v214, v215
    v_or3_b32 v197, v240, v241, v242
    v_exp_f32 v209, v133
    s_nop 0
    v_exp_f32 v210, v134
    s_nop 0
    v_cvt_pk_bf16_f32 v244, v208, v209
    v_exp_f32 v211, v135
    s_nop 0
    v_exp_f32 v212, v140
    s_nop 0
    v_cvt_pk_bf16_f32 v245, v210, v211
    v_or3_b32 v197, v197, v243, v244
    v_exp_f32 v213, v141
    s_nop 0
    v_exp_f32 v214, v142
    s_nop 0
    v_cvt_pk_bf16_f32 v246, v212, v213
    v_exp_f32 v215, v143
    s_nop 0
    v_or3_b32 v197, v197, v245, v246
    v_cvt_pk_bf16_f32 v247, v214, v215
    v_or_b32 v197, v197, v247
    v_and_b32 v197, s48, v197
    v_cmp_ne_u32 vcc, 0, v197
    s_nop 1
    s_branch L_fback2_2
L_frare2_3:
    s_nop 7
    v_and_b32 v220, 48, v216
    v_max3_f32 v217, v144, v145, v146
    v_max3_f32 v217, v217, v147, v152
    v_max3_f32 v217, v217, v153, v154
    v_max_f32 v217, v217, v155
    v_mov_b32 v218, v217
    s_nop 1
    v_permlane32_swap_b32 v217, v218
    s_nop 0
    v_max_f32 v217, v217, v218
    v_mov_b32 v218, v217
    s_nop 1
    v_permlane16_swap_b32 v217, v218
    s_nop 0
    v_max_f32 v217, v217, v218
    v_add_f32 v217, 0x41c00000, v217
    v_max_f32 v217, 0, v217
    v_ceil_f32 v217, v217
    v_sub_f32 v219, 0, v217
    v_exp_f32 v219, v219
    v_sub_f32 v232, v232, v217
    v_sub_f32 v233, v233, v217
    v_sub_f32 v234, v234, v217
    v_sub_f32 v235, v235, v217
    v_sub_f32 v128, v128, v217
    v_sub_f32 v129, v129, v217
    v_sub_f32 v130, v130, v217
    v_sub_f32 v131, v131, v217
    v_sub_f32 v136, v136, v217
    v_sub_f32 v137, v137, v217
    v_sub_f32 v138, v138, v217
    v_sub_f32 v139, v139, v217
    v_sub_f32 v144, v144, v217
    v_sub_f32 v145, v145, v217
    v_sub_f32 v146, v146, v217
    v_sub_f32 v147, v147, v217
    v_sub_f32 v152, v152, v217
    v_sub_f32 v153, v153, v217
    v_sub_f32 v154, v154, v217
    v_sub_f32 v155, v155, v217
    ds_bpermute_b32 v221, v220, v219 offset:0
    ds_bpermute_b32 v222, v220, v219 offset:4
    ds_bpermute_b32 v223, v220, v219 offset:8
    ds_bpermute_b32 v224, v220, v219 offset:12
    v_lshlrev_b32 v225, 16, v160
    v_and_b32 v226, 0xffff0000, v160
    v_mul_f32 v225, v225, v219
    v_mul_f32 v226, v226, v219
    v_cvt_pk_bf16_f32 v160, v225, v226
    v_lshlrev_b32 v225, 16, v161
    v_and_b32 v226, 0xffff0000, v161
    v_mul_f32 v225, v225, v219
    v_mul_f32 v226, v226, v219
    v_cvt_pk_bf16_f32 v161, v225, v226
    v_lshlrev_b32 v225, 16, v162
    v_and_b32 v226, 0xffff0000, v162
    v_mul_f32 v225, v225, v219
    v_mul_f32 v226, v226, v219
    v_cvt_pk_bf16_f32 v162, v225, v226
    v_lshlrev_b32 v225, 16, v163
    v_and_b32 v226, 0xffff0000, v163
    v_mul_f32 v225, v225, v219
    v_mul_f32 v226, v226, v219
    v_cvt_pk_bf16_f32 v163, v225, v226
    v_lshlrev_b32 v225, 16, v168
    v_and_b32 v226, 0xffff0000, v168
    v_mul_f32 v225, v225, v219
    v_mul_f32 v226, v226, v219
    v_cvt_pk_bf16_f32 v168, v225, v226
    v_lshlrev_b32 v225, 16, v169
    v_and_b32 v226, 0xffff0000, v169
    v_mul_f32 v225, v225, v219
    v_mul_f32 v226, v226, v219
    v_cvt_pk_bf16_f32 v169, v225, v226
    v_lshlrev_b32 v225, 16, v170
    v_and_b32 v226, 0xffff0000, v170
    v_mul_f32 v225, v225, v219
    v_mul_f32 v226, v226, v219
    v_cvt_pk_bf16_f32 v170, v225, v226
    v_lshlrev_b32 v225, 16, v171
    v_and_b32 v226, 0xffff0000, v171
    v_mul_f32 v225, v225, v219
    v_mul_f32 v226, v226, v219
    v_cvt_pk_bf16_f32 v171, v225, v226
    v_lshlrev_b32 v225, 16, v240
    v_and_b32 v226, 0xffff0000, v240
    v_mul_f32 v225, v225, v219
    v_mul_f32 v226, v226, v219
    v_cvt_pk_bf16_f32 v240, v225, v226
    v_lshlrev_b32 v225, 16, v241
    v_and_b32 v226, 0xffff0000, v241
    v_mul_f32 v225, v225, v219
    v_mul_f32 v226, v226, v219
    v_cvt_pk_bf16_f32 v241, v225, v226
    v_lshlrev_b32 v225, 16, v242
    v_and_b32 v226, 0xffff0000, v242
    v_mul_f32 v225, v225, v219
    v_mul_f32 v226, v226, v219
    v_cvt_pk_bf16_f32 v242, v225, v226
    v_lshlrev_b32 v225, 16, v243
    v_and_b32 v226, 0xffff0000, v243
    v_mul_f32 v225, v225, v219
    v_mul_f32 v226, v226, v219
    v_cvt_pk_bf16_f32 v243, v225, v226
    s_waitcnt lgkmcnt(0)
    v_mul_f32 v200, v200, v221
    v_mul_f32 v201, v201, v222
    v_mul_f32 v202, v202, v223
    v_mul_f32 v203, v203, v224
    v_mul_f32 v0, v0, v221
    v_mul_f32 v1, v1, v222
    v_mul_f32 v2, v2, v223
    v_mul_f32 v3, v3, v224
    v_mul_f32 v4, v4, v221
    v_mul_f32 v5, v5, v222
    v_mul_f32 v6, v6, v223
    v_mul_f32 v7, v7, v224
    v_mul_f32 v8, v8, v221
    v_mul_f32 v9, v9, v222
    v_mul_f32 v10, v10, v223
    v_mul_f32 v11, v11, v224
    v_mul_f32 v12, v12, v221
    v_mul_f32 v13, v13, v222
    v_mul_f32 v14, v14, v223
    v_mul_f32 v15, v15, v224
    v_mul_f32 v16, v16, v221
    v_mul_f32 v17, v17, v222
    v_mul_f32 v18, v18, v223
    v_mul_f32 v19, v19, v224
    v_mul_f32 v20, v20, v221
    v_mul_f32 v21, v21, v222
    v_mul_f32 v22, v22, v223
    v_mul_f32 v23, v23, v224
    v_mul_f32 v24, v24, v221
    v_mul_f32 v25, v25, v222
    v_mul_f32 v26, v26, v223
    v_mul_f32 v27, v27, v224
    v_mul_f32 v28, v28, v221
    v_mul_f32 v29, v29, v222
    v_mul_f32 v30, v30, v223
    v_mul_f32 v31, v31, v224
    v_mul_f32 v32, v32, v221
    v_mul_f32 v33, v33, v222
    v_mul_f32 v34, v34, v223
    v_mul_f32 v35, v35, v224
    v_mul_f32 v36, v36, v221
    v_mul_f32 v37, v37, v222
    v_mul_f32 v38, v38, v223
    v_mul_f32 v39, v39, v224
    v_mul_f32 v40, v40, v221
    v_mul_f32 v41, v41, v222
    v_mul_f32 v42, v42, v223
    v_mul_f32 v43, v43, v224
    v_mul_f32 v44, v44, v221
    v_mul_f32 v45, v45, v222
    v_mul_f32 v46, v46, v223
    v_mul_f32 v47, v47, v224
    v_mul_f32 v48, v48, v221
    v_mul_f32 v49, v49, v222
    v_mul_f32 v50, v50, v223
    v_mul_f32 v51, v51, v224
    v_mul_f32 v52, v52, v221
    v_mul_f32 v53, v53, v222
    v_mul_f32 v54, v54, v223
    v_mul_f32 v55, v55, v224
    v_mul_f32 v56, v56, v221
    v_mul_f32 v57, v57, v222
    v_mul_f32 v58, v58, v223
    v_mul_f32 v59, v59, v224
    v_mul_f32 v60, v60, v221
    v_mul_f32 v61, v61, v222
    v_mul_f32 v62, v62, v223
    v_mul_f32 v63, v63, v224
    v_max3_f32 v217, v148, v149, v150
    v_max3_f32 v217, v217, v151, v156
    v_max3_f32 v217, v217, v157, v158
    v_max_f32 v217, v217, v159
    v_mov_b32 v218, v217
    s_nop 1
    v_permlane32_swap_b32 v217, v218
    s_nop 0
    v_max_f32 v217, v217, v218
    v_mov_b32 v218, v217
    s_nop 1
    v_permlane16_swap_b32 v217, v218
    s_nop 0
    v_max_f32 v217, v217, v218
    v_add_f32 v217, 0x41c00000, v217
    v_max_f32 v217, 0, v217
    v_ceil_f32 v217, v217
    v_sub_f32 v219, 0, v217
    v_exp_f32 v219, v219
    v_sub_f32 v236, v236, v217
    v_sub_f32 v237, v237, v217
    v_sub_f32 v238, v238, v217
    v_sub_f32 v239, v239, v217
    v_sub_f32 v132, v132, v217
    v_sub_f32 v133, v133, v217
    v_sub_f32 v134, v134, v217
    v_sub_f32 v135, v135, v217
    v_sub_f32 v140, v140, v217
    v_sub_f32 v141, v141, v217
    v_sub_f32 v142, v142, v217
    v_sub_f32 v143, v143, v217
    v_sub_f32 v148, v148, v217
    v_sub_f32 v149, v149, v217
    v_sub_f32 v150, v150, v217
    v_sub_f32 v151, v151, v217
    v_sub_f32 v156, v156, v217
    v_sub_f32 v157, v157, v217
    v_sub_f32 v158, v158, v217
    v_sub_f32 v159, v159, v217
    ds_bpermute_b32 v221, v220, v219 offset:0
    ds_bpermute_b32 v222, v220, v219 offset:4
    ds_bpermute_b32 v223, v220, v219 offset:8
    ds_bpermute_b32 v224, v220, v219 offset:12
    v_lshlrev_b32 v225, 16, v164
    v_and_b32 v226, 0xffff0000, v164
    v_mul_f32 v225, v225, v219
    v_mul_f32 v226, v226, v219
    v_cvt_pk_bf16_f32 v164, v225, v226
    v_lshlrev_b32 v225, 16, v165
    v_and_b32 v226, 0xffff0000, v165
    v_mul_f32 v225, v225, v219
    v_mul_f32 v226, v226, v219
    v_cvt_pk_bf16_f32 v165, v225, v226
    v_lshlrev_b32 v225, 16, v166
    v_and_b32 v226, 0xffff0000, v166
    v_mul_f32 v225, v225, v219
    v_mul_f32 v226, v226, v219
    v_cvt_pk_bf16_f32 v166, v225, v226
    v_lshlrev_b32 v225, 16, v167
    v_and_b32 v226, 0xffff0000, v167
    v_mul_f32 v225, v225, v219
    v_mul_f32 v226, v226, v219
    v_cvt_pk_bf16_f32 v167, v225, v226
    v_lshlrev_b32 v225, 16, v172
    v_and_b32 v226, 0xffff0000, v172
    v_mul_f32 v225, v225, v219
    v_mul_f32 v226, v226, v219
    v_cvt_pk_bf16_f32 v172, v225, v226
    v_lshlrev_b32 v225, 16, v173
    v_and_b32 v226, 0xffff0000, v173
    v_mul_f32 v225, v225, v219
    v_mul_f32 v226, v226, v219
    v_cvt_pk_bf16_f32 v173, v225, v226
    v_lshlrev_b32 v225, 16, v174
    v_and_b32 v226, 0xffff0000, v174
    v_mul_f32 v225, v225, v219
    v_mul_f32 v226, v226, v219
    v_cvt_pk_bf16_f32 v174, v225, v226
    v_lshlrev_b32 v225, 16, v175
    v_and_b32 v226, 0xffff0000, v175
    v_mul_f32 v225, v225, v219
    v_mul_f32 v226, v226, v219
    v_cvt_pk_bf16_f32 v175, v225, v226
    v_lshlrev_b32 v225, 16, v244
    v_and_b32 v226, 0xffff0000, v244
    v_mul_f32 v225, v225, v219
    v_mul_f32 v226, v226, v219
    v_cvt_pk_bf16_f32 v244, v225, v226
    v_lshlrev_b32 v225, 16, v245
    v_and_b32 v226, 0xffff0000, v245
    v_mul_f32 v225, v225, v219
    v_mul_f32 v226, v226, v219
    v_cvt_pk_bf16_f32 v245, v225, v226
    v_lshlrev_b32 v225, 16, v246
    v_and_b32 v226, 0xffff0000, v246
    v_mul_f32 v225, v225, v219
    v_mul_f32 v226, v226, v219
    v_cvt_pk_bf16_f32 v246, v225, v226
    v_lshlrev_b32 v225, 16, v247
    v_and_b32 v226, 0xffff0000, v247
    v_mul_f32 v225, v225, v219
    v_mul_f32 v226, v226, v219
    v_cvt_pk_bf16_f32 v247, v225, v226
    s_waitcnt lgkmcnt(0)
    v_mul_f32 v204, v204, v221
    v_mul_f32 v205, v205, v222
    v_mul_f32 v206, v206, v223
    v_mul_f32 v207, v207, v224
    v_mul_f32 v64, v64, v221
    v_mul_f32 v65, v65, v222
    v_mul_f32 v66, v66, v223
    v_mul_f32 v67, v67, v224
    v_mul_f32 v68, v68, v221
    v_mul_f32 v69, v69, v222
    v_mul_f32 v70, v70, v223
    v_mul_f32 v71, v71, v224
    v_mul_f32 v72, v72, v221
    v_mul_f32 v73, v73, v222
    v_mul_f32 v74, v74, v223
    v_mul_f32 v75, v75, v224
    v_mul_f32 v76, v76, v221
    v_mul_f32 v77, v77, v222
    v_mul_f32 v78, v78, v223
    v_mul_f32 v79, v79, v224
    v_mul_f32 v80, v80, v221
    v_mul_f32 v81, v81, v222
    v_mul_f32 v82, v82, v223
    v_mul_f32 v83, v83, v224
    v_mul_f32 v84, v84, v221
    v_mul_f32 v85, v85, v222
    v_mul_f32 v86, v86, v223
    v_mul_f32 v87, v87, v224
    v_mul_f32 v88, v88, v221
    v_mul_f32 v89, v89, v222
    v_mul_f32 v90, v90, v223
    v_mul_f32 v91, v91, v224
    v_mul_f32 v92, v92, v221
    v_mul_f32 v93, v93, v222
    v_mul_f32 v94, v94, v223
    v_mul_f32 v95, v95, v224
    v_mul_f32 v96, v96, v221
    v_mul_f32 v97, v97, v222
    v_mul_f32 v98, v98, v223
    v_mul_f32 v99, v99, v224
    v_mul_f32 v100, v100, v221
    v_mul_f32 v101, v101, v222
    v_mul_f32 v102, v102, v223
    v_mul_f32 v103, v103, v224
    v_mul_f32 v104, v104, v221
    v_mul_f32 v105, v105, v222
    v_mul_f32 v106, v106, v223
    v_mul_f32 v107, v107, v224
    v_mul_f32 v108, v108, v221
    v_mul_f32 v109, v109, v222
    v_mul_f32 v110, v110, v223
    v_mul_f32 v111, v111, v224
    v_mul_f32 v112, v112, v221
    v_mul_f32 v113, v113, v222
    v_mul_f32 v114, v114, v223
    v_mul_f32 v115, v115, v224
    v_mul_f32 v116, v116, v221
    v_mul_f32 v117, v117, v222
    v_mul_f32 v118, v118, v223
    v_mul_f32 v119, v119, v224
    v_mul_f32 v120, v120, v221
    v_mul_f32 v121, v121, v222
    v_mul_f32 v122, v122, v223
    v_mul_f32 v123, v123, v224
    v_mul_f32 v124, v124, v221
    v_mul_f32 v125, v125, v222
    v_mul_f32 v126, v126, v223
    v_mul_f32 v127, v127, v224
    v_exp_f32 v208, v144
    s_nop 0
    v_exp_f32 v209, v145
    s_nop 0
    v_exp_f32 v210, v146
    s_nop 0
    v_cvt_pk_bf16_f32 v248, v208, v209
    v_exp_f32 v211, v147
    s_nop 0
    v_exp_f32 v212, v152
    s_nop 0
    v_cvt_pk_bf16_f32 v249, v210, v211
    v_exp_f32 v213, v153
    s_nop 0
    v_exp_f32 v214, v154
    s_nop 0
    v_cvt_pk_bf16_f32 v250, v212, v213
    v_exp_f32 v215, v155
    s_nop 0
    v_exp_f32 v208, v148
    s_nop 0
    v_cvt_pk_bf16_f32 v251, v214, v215
    v_or3_b32 v197, v248, v249, v250
    v_exp_f32 v209, v149
    s_nop 0
    v_exp_f32 v210, v150
    s_nop 0
    v_cvt_pk_bf16_f32 v252, v208, v209
    v_exp_f32 v211, v151
    s_nop 0
    v_exp_f32 v212, v156
    s_nop 0
    v_cvt_pk_bf16_f32 v253, v210, v211
    v_or3_b32 v197, v197, v251, v252
    v_exp_f32 v213, v157
    s_nop 0
    v_exp_f32 v214, v158
    s_nop 0
    v_cvt_pk_bf16_f32 v254, v212, v213
    v_exp_f32 v215, v159
    s_nop 0
    v_or3_b32 v197, v197, v253, v254
    v_cvt_pk_bf16_f32 v255, v214, v215
    v_or_b32 v197, v197, v255
    v_and_b32 v197, s48, v197
    v_cmp_ne_u32 vcc, 0, v197
    s_nop 1
    s_branch L_fback2_3
L_frare3_1:
    s_nop 7
    v_and_b32 v220, 48, v216
    v_max3_f32 v217, v128, v129, v130
    v_max3_f32 v217, v217, v131, v136
    v_max3_f32 v217, v217, v137, v138
    v_max_f32 v217, v217, v139
    v_mov_b32 v218, v217
    s_nop 1
    v_permlane32_swap_b32 v217, v218
    s_nop 0
    v_max_f32 v217, v217, v218
    v_mov_b32 v218, v217
    s_nop 1
    v_permlane16_swap_b32 v217, v218
    s_nop 0
    v_max_f32 v217, v217, v218
    v_add_f32 v217, 0x41c00000, v217
    v_max_f32 v217, 0, v217
    v_ceil_f32 v217, v217
    v_sub_f32 v219, 0, v217
    v_exp_f32 v219, v219
    v_sub_f32 v232, v232, v217
    v_sub_f32 v233, v233, v217
    v_sub_f32 v234, v234, v217
    v_sub_f32 v235, v235, v217
    v_sub_f32 v128, v128, v217
    v_sub_f32 v129, v129, v217
    v_sub_f32 v130, v130, v217
    v_sub_f32 v131, v131, v217
    v_sub_f32 v136, v136, v217
    v_sub_f32 v137, v137, v217
    v_sub_f32 v138, v138, v217
    v_sub_f32 v139, v139, v217
    v_sub_f32 v144, v144, v217
    v_sub_f32 v145, v145, v217
    v_sub_f32 v146, v146, v217
    v_sub_f32 v147, v147, v217
    v_sub_f32 v152, v152, v217
    v_sub_f32 v153, v153, v217
    v_sub_f32 v154, v154, v217
    v_sub_f32 v155, v155, v217
    ds_bpermute_b32 v221, v220, v219 offset:0
    ds_bpermute_b32 v222, v220, v219 offset:4
    ds_bpermute_b32 v223, v220, v219 offset:8
    ds_bpermute_b32 v224, v220, v219 offset:12
    v_lshlrev_b32 v225, 16, v168
    v_and_b32 v226, 0xffff0000, v168
    v_mul_f32 v225, v225, v219
    v_mul_f32 v226, v226, v219
    v_cvt_pk_bf16_f32 v168, v225, v226
    v_lshlrev_b32 v225, 16, v169
    v_and_b32 v226, 0xffff0000, v169
    v_mul_f32 v225, v225, v219
    v_mul_f32 v226, v226, v219
    v_cvt_pk_bf16_f32 v169, v225, v226
    v_lshlrev_b32 v225, 16, v170
    v_and_b32 v226, 0xffff0000, v170
    v_mul_f32 v225, v225, v219
    v_mul_f32 v226, v226, v219
    v_cvt_pk_bf16_f32 v170, v225, v226
    v_lshlrev_b32 v225, 16, v171
    v_and_b32 v226, 0xffff0000, v171
    v_mul_f32 v225, v225, v219
    v_mul_f32 v226, v226, v219
    v_cvt_pk_bf16_f32 v171, v225, v226
    s_waitcnt lgkmcnt(0)
    v_mul_f32 v200, v200, v221
    v_mul_f32 v201, v201, v222
    v_mul_f32 v202, v202, v223
    v_mul_f32 v203, v203, v224
    v_mul_f32 v0, v0, v221
    v_mul_f32 v1, v1, v222
    v_mul_f32 v2, v2, v223
    v_mul_f32 v3, v3, v224
    v_mul_f32 v4, v4, v221
    v_mul_f32 v5, v5, v222
    v_mul_f32 v6, v6, v223
    v_mul_f32 v7, v7, v224
    v_mul_f32 v8, v8, v221
    v_mul_f32 v9, v9, v222
    v_mul_f32 v10, v10, v223
    v_mul_f32 v11, v11, v224
    v_mul_f32 v12, v12, v221
    v_mul_f32 v13, v13, v222
    v_mul_f32 v14, v14, v223
    v_mul_f32 v15, v15, v224
    v_mul_f32 v16, v16, v221
    v_mul_f32 v17, v17, v222
    v_mul_f32 v18, v18, v223
    v_mul_f32 v19, v19, v224
    v_mul_f32 v20, v20, v221
    v_mul_f32 v21, v21, v222
    v_mul_f32 v22, v22, v223
    v_mul_f32 v23, v23, v224
    v_mul_f32 v24, v24, v221
    v_mul_f32 v25, v25, v222
    v_mul_f32 v26, v26, v223
    v_mul_f32 v27, v27, v224
    v_mul_f32 v28, v28, v221
    v_mul_f32 v29, v29, v222
    v_mul_f32 v30, v30, v223
    v_mul_f32 v31, v31, v224
    v_mul_f32 v32, v32, v221
    v_mul_f32 v33, v33, v222
    v_mul_f32 v34, v34, v223
    v_mul_f32 v35, v35, v224
    v_mul_f32 v36, v36, v221
    v_mul_f32 v37, v37, v222
    v_mul_f32 v38, v38, v223
    v_mul_f32 v39, v39, v224
    v_mul_f32 v40, v40, v221
    v_mul_f32 v41, v41, v222
    v_mul_f32 v42, v42, v223
    v_mul_f32 v43, v43, v224
    v_mul_f32 v44, v44, v221
    v_mul_f32 v45, v45, v222
    v_mul_f32 v46, v46, v223
    v_mul_f32 v47, v47, v224
    v_mul_f32 v48, v48, v221
    v_mul_f32 v49, v49, v222
    v_mul_f32 v50, v50, v223
    v_mul_f32 v51, v51, v224
    v_mul_f32 v52, v52, v221
    v_mul_f32 v53, v53, v222
    v_mul_f32 v54, v54, v223
    v_mul_f32 v55, v55, v224
    v_mul_f32 v56, v56, v221
    v_mul_f32 v57, v57, v222
    v_mul_f32 v58, v58, v223
    v_mul_f32 v59, v59, v224
    v_mul_f32 v60, v60, v221
    v_mul_f32 v61, v61, v222
    v_mul_f32 v62, v62, v223
    v_mul_f32 v63, v63, v224
    v_max3_f32 v217, v132, v133, v134
    v_max3_f32 v217, v217, v135, v140
    v_max3_f32 v217, v217, v141, v142
    v_max_f32 v217, v217, v143
    v_mov_b32 v218, v217
    s_nop 1
    v_permlane32_swap_b32 v217, v218
    s_nop 0
    v_max_f32 v217, v217, v218
    v_mov_b32 v218, v217
    s_nop 1
    v_permlane16_swap_b32 v217, v218
    s_nop 0
    v_max_f32 v217, v217, v218
    v_add_f32 v217, 0x41c00000, v217
    v_max_f32 v217, 0, v217
    v_ceil_f32 v217, v217
    v_sub_f32 v219, 0, v217
    v_exp_f32 v219, v219
    v_sub_f32 v236, v236, v217
    v_sub_f32 v237, v237, v217
    v_sub_f32 v238, v238, v217
    v_sub_f32 v239, v239, v217
    v_sub_f32 v132, v132, v217
    v_sub_f32 v133, v133, v217
    v_sub_f32 v134, v134, v217
    v_sub_f32 v135, v135, v217
    v_sub_f32 v140, v140, v217
    v_sub_f32 v141, v141, v217
    v_sub_f32 v142, v142, v217
    v_sub_f32 v143, v143, v217
    v_sub_f32 v148, v148, v217
    v_sub_f32 v149, v149, v217
    v_sub_f32 v150, v150, v217
    v_sub_f32 v151, v151, v217
    v_sub_f32 v156, v156, v217
    v_sub_f32 v157, v157, v217
    v_sub_f32 v158, v158, v217
    v_sub_f32 v159, v159, v217
    ds_bpermute_b32 v221, v220, v219 offset:0
    ds_bpermute_b32 v222, v220, v219 offset:4
    ds_bpermute_b32 v223, v220, v219 offset:8
    ds_bpermute_b32 v224, v220, v219 offset:12
    v_lshlrev_b32 v225, 16, v172
    v_and_b32 v226, 0xffff0000, v172
    v_mul_f32 v225, v225, v219
    v_mul_f32 v226, v226, v219
    v_cvt_pk_bf16_f32 v172, v225, v226
    v_lshlrev_b32 v225, 16, v173
    v_and_b32 v226, 0xffff0000, v173
    v_mul_f32 v225, v225, v219
    v_mul_f32 v226, v226, v219
    v_cvt_pk_bf16_f32 v173, v225, v226
    v_lshlrev_b32 v225, 16, v174
    v_and_b32 v226, 0xffff0000, v174
    v_mul_f32 v225, v225, v219
    v_mul_f32 v226, v226, v219
    v_cvt_pk_bf16_f32 v174, v225, v226
    v_lshlrev_b32 v225, 16, v175
    v_and_b32 v226, 0xffff0000, v175
    v_mul_f32 v225, v225, v219
    v_mul_f32 v226, v226, v219
    v_cvt_pk_bf16_f32 v175, v225, v226
    s_waitcnt lgkmcnt(0)
    v_mul_f32 v204, v204, v221
    v_mul_f32 v205, v205, v222
    v_mul_f32 v206, v206, v223
    v_mul_f32 v207, v207, v224
    v_mul_f32 v64, v64, v221
    v_mul_f32 v65, v65, v222
    v_mul_f32 v66, v66, v223
    v_mul_f32 v67, v67, v224
    v_mul_f32 v68, v68, v221
    v_mul_f32 v69, v69, v222
    v_mul_f32 v70, v70, v223
    v_mul_f32 v71, v71, v224
    v_mul_f32 v72, v72, v221
    v_mul_f32 v73, v73, v222
    v_mul_f32 v74, v74, v223
    v_mul_f32 v75, v75, v224
    v_mul_f32 v76, v76, v221
    v_mul_f32 v77, v77, v222
    v_mul_f32 v78, v78, v223
    v_mul_f32 v79, v79, v224
    v_mul_f32 v80, v80, v221
    v_mul_f32 v81, v81, v222
    v_mul_f32 v82, v82, v223
    v_mul_f32 v83, v83, v224
    v_mul_f32 v84, v84, v221
    v_mul_f32 v85, v85, v222
    v_mul_f32 v86, v86, v223
    v_mul_f32 v87, v87, v224
    v_mul_f32 v88, v88, v221
    v_mul_f32 v89, v89, v222
    v_mul_f32 v90, v90, v223
    v_mul_f32 v91, v91, v224
    v_mul_f32 v92, v92, v221
    v_mul_f32 v93, v93, v222
    v_mul_f32 v94, v94, v223
    v_mul_f32 v95, v95, v224
    v_mul_f32 v96, v96, v221
    v_mul_f32 v97, v97, v222
    v_mul_f32 v98, v98, v223
    v_mul_f32 v99, v99, v224
    v_mul_f32 v100, v100, v221
    v_mul_f32 v101, v101, v222
    v_mul_f32 v102, v102, v223
    v_mul_f32 v103, v103, v224
    v_mul_f32 v104, v104, v221
    v_mul_f32 v105, v105, v222
    v_mul_f32 v106, v106, v223
    v_mul_f32 v107, v107, v224
    v_mul_f32 v108, v108, v221
    v_mul_f32 v109, v109, v222
    v_mul_f32 v110, v110, v223
    v_mul_f32 v111, v111, v224
    v_mul_f32 v112, v112, v221
    v_mul_f32 v113, v113, v222
    v_mul_f32 v114, v114, v223
    v_mul_f32 v115, v115, v224
    v_mul_f32 v116, v116, v221
    v_mul_f32 v117, v117, v222
    v_mul_f32 v118, v118, v223
    v_mul_f32 v119, v119, v224
    v_mul_f32 v120, v120, v221
    v_mul_f32 v121, v121, v222
    v_mul_f32 v122, v122, v223
    v_mul_f32 v123, v123, v224
    v_mul_f32 v124, v124, v221
    v_mul_f32 v125, v125, v222
    v_mul_f32 v126, v126, v223
    v_mul_f32 v127, v127, v224
    v_exp_f32 v208, v128
    s_nop 0
    v_exp_f32 v209, v129
    s_nop 0
    v_exp_f32 v210, v130
    s_nop 0
    v_cvt_pk_bf16_f32 v160, v208, v209
    v_exp_f32 v211, v131
    s_nop 0
    v_exp_f32 v212, v136
    s_nop 0
    v_cvt_pk_bf16_f32 v161, v210, v211
    v_exp_f32 v213, v137
    s_nop 0
    v_exp_f32 v214, v138
    s_nop 0
    v_cvt_pk_bf16_f32 v162, v212, v213
    v_exp_f32 v215, v139
    s_nop 0
    v_exp_f32 v208, v132
    s_nop 0
    v_cvt_pk_bf16_f32 v163, v214, v215
    v_or3_b32 v197, v160, v161, v162
    v_exp_f32 v209, v133
    s_nop 0
    v_exp_f32 v210, v134
    s_nop 0
    v_cvt_pk_bf16_f32 v164, v208, v209
    v_exp_f32 v211, v135
    s_nop 0
    v_exp_f32 v212, v140
    s_nop 0
    v_cvt_pk_bf16_f32 v165, v210, v211
    v_or3_b32 v197, v197, v163, v164
    v_exp_f32 v213, v141
    s_nop 0
    v_exp_f32 v214, v142
    s_nop 0
    v_cvt_pk_bf16_f32 v166, v212, v213
    v_exp_f32 v215, v143
    s_nop 0
    v_or3_b32 v197, v197, v165, v166
    v_cvt_pk_bf16_f32 v167, v214, v215
    v_or_b32 v197, v197, v167
    v_and_b32 v197, s48, v197
    v_cmp_ne_u32 vcc, 0, v197
    s_nop 1
    s_branch L_fback3_1
L_frare3_2:
    s_nop 7
    v_and_b32 v220, 48, v216
    v_max3_f32 v217, v144, v145, v146
    v_max3_f32 v217, v217, v147, v152
    v_max3_f32 v217, v217, v153, v154
    v_max_f32 v217, v217, v155
    v_mov_b32 v218, v217
    s_nop 1
    v_permlane32_swap_b32 v217, v218
    s_nop 0
    v_max_f32 v217, v217, v218
    v_mov_b32 v218, v217
    s_nop 1
    v_permlane16_swap_b32 v217, v218
    s_nop 0
    v_max_f32 v217, v217, v218
    v_add_f32 v217, 0x41c00000, v217
    v_max_f32 v217, 0, v217
    v_ceil_f32 v217, v217
    v_sub_f32 v219, 0, v217
    v_exp_f32 v219, v219
    v_sub_f32 v232, v232, v217
    v_sub_f32 v233, v233, v217
    v_sub_f32 v234, v234, v217
    v_sub_f32 v235, v235, v217
    v_sub_f32 v128, v128, v217
    v_sub_f32 v129, v129, v217
    v_sub_f32 v130, v130, v217
    v_sub_f32 v131, v131, v217
    v_sub_f32 v136, v136, v217
    v_sub_f32 v137, v137, v217
    v_sub_f32 v138, v138, v217
    v_sub_f32 v139, v139, v217
    v_sub_f32 v144, v144, v217
    v_sub_f32 v145, v145, v217
    v_sub_f32 v146, v146, v217
    v_sub_f32 v147, v147, v217
    v_sub_f32 v152, v152, v217
    v_sub_f32 v153, v153, v217
    v_sub_f32 v154, v154, v217
    v_sub_f32 v155, v155, v217
    ds_bpermute_b32 v221, v220, v219 offset:0
    ds_bpermute_b32 v222, v220, v219 offset:4
    ds_bpermute_b32 v223, v220, v219 offset:8
    ds_bpermute_b32 v224, v220, v219 offset:12
    v_lshlrev_b32 v225, 16, v168
    v_and_b32 v226, 0xffff0000, v168
    v_mul_f32 v225, v225, v219
    v_mul_f32 v226, v226, v219
    v_cvt_pk_bf16_f32 v168, v225, v226
    v_lshlrev_b32 v225, 16, v169
    v_and_b32 v226, 0xffff0000, v169
    v_mul_f32 v225, v225, v219
    v_mul_f32 v226, v226, v219
    v_cvt_pk_bf16_f32 v169, v225, v226
    v_lshlrev_b32 v225, 16, v170
    v_and_b32 v226, 0xffff0000, v170
    v_mul_f32 v225, v225, v219
    v_mul_f32 v226, v226, v219
    v_cvt_pk_bf16_f32 v170, v225, v226
    v_lshlrev_b32 v225, 16, v171
    v_and_b32 v226, 0xffff0000, v171
    v_mul_f32 v225, v225, v219
    v_mul_f32 v226, v226, v219
    v_cvt_pk_bf16_f32 v171, v225, v226
    v_lshlrev_b32 v225, 16, v160
    v_and_b32 v226, 0xffff0000, v160
    v_mul_f32 v225, v225, v219
    v_mul_f32 v226, v226, v219
    v_cvt_pk_bf16_f32 v160, v225, v226
    v_lshlrev_b32 v225, 16, v161
    v_and_b32 v226, 0xffff0000, v161
    v_mul_f32 v225, v225, v219
    v_mul_f32 v226, v226, v219
    v_cvt_pk_bf16_f32 v161, v225, v226
    v_lshlrev_b32 v225, 16, v162
    v_and_b32 v226, 0xffff0000, v162
    v_mul_f32 v225, v225, v219
    v_mul_f32 v226, v226, v219
    v_cvt_pk_bf16_f32 v162, v225, v226
    v_lshlrev_b32 v225, 16, v163
    v_and_b32 v226, 0xffff0000, v163
    v_mul_f32 v225, v225, v219
    v_mul_f32 v226, v226, v219
    v_cvt_pk_bf16_f32 v163, v225, v226
    s_waitcnt lgkmcnt(0)
    v_mul_f32 v200, v200, v221
    v_mul_f32 v201, v201, v222
    v_mul_f32 v202, v202, v223
    v_mul_f32 v203, v203, v224
    v_mul_f32 v0, v0, v221
    v_mul_f32 v1, v1, v222
    v_mul_f32 v2, v2, v223
    v_mul_f32 v3, v3, v224
    v_mul_f32 v4, v4, v221
    v_mul_f32 v5, v5, v222
    v_mul_f32 v6, v6, v223
    v_mul_f32 v7, v7, v224
    v_mul_f32 v8, v8, v221
    v_mul_f32 v9, v9, v222
    v_mul_f32 v10, v10, v223
    v_mul_f32 v11, v11, v224
    v_mul_f32 v12, v12, v221
    v_mul_f32 v13, v13, v222
    v_mul_f32 v14, v14, v223
    v_mul_f32 v15, v15, v224
    v_mul_f32 v16, v16, v221
    v_mul_f32 v17, v17, v222
    v_mul_f32 v18, v18, v223
    v_mul_f32 v19, v19, v224
    v_mul_f32 v20, v20, v221
    v_mul_f32 v21, v21, v222
    v_mul_f32 v22, v22, v223
    v_mul_f32 v23, v23, v224
    v_mul_f32 v24, v24, v221
    v_mul_f32 v25, v25, v222
    v_mul_f32 v26, v26, v223
    v_mul_f32 v27, v27, v224
    v_mul_f32 v28, v28, v221
    v_mul_f32 v29, v29, v222
    v_mul_f32 v30, v30, v223
    v_mul_f32 v31, v31, v224
    v_mul_f32 v32, v32, v221
    v_mul_f32 v33, v33, v222
    v_mul_f32 v34, v34, v223
    v_mul_f32 v35, v35, v224
    v_mul_f32 v36, v36, v221
    v_mul_f32 v37, v37, v222
    v_mul_f32 v38, v38, v223
    v_mul_f32 v39, v39, v224
    v_mul_f32 v40, v40, v221
    v_mul_f32 v41, v41, v222
    v_mul_f32 v42, v42, v223
    v_mul_f32 v43, v43, v224
    v_mul_f32 v44, v44, v221
    v_mul_f32 v45, v45, v222
    v_mul_f32 v46, v46, v223
    v_mul_f32 v47, v47, v224
    v_mul_f32 v48, v48, v221
    v_mul_f32 v49, v49, v222
    v_mul_f32 v50, v50, v223
    v_mul_f32 v51, v51, v224
    v_mul_f32 v52, v52, v221
    v_mul_f32 v53, v53, v222
    v_mul_f32 v54, v54, v223
    v_mul_f32 v55, v55, v224
    v_mul_f32 v56, v56, v221
    v_mul_f32 v57, v57, v222
    v_mul_f32 v58, v58, v223
    v_mul_f32 v59, v59, v224
    v_mul_f32 v60, v60, v221
    v_mul_f32 v61, v61, v222
    v_mul_f32 v62, v62, v223
    v_mul_f32 v63, v63, v224
    v_max3_f32 v217, v148, v149, v150
    v_max3_f32 v217, v217, v151, v156
    v_max3_f32 v217, v217, v157, v158
    v_max_f32 v217, v217, v159
    v_mov_b32 v218, v217
    s_nop 1
    v_permlane32_swap_b32 v217, v218
    s_nop 0
    v_max_f32 v217, v217, v218
    v_mov_b32 v218, v217
    s_nop 1
    v_permlane16_swap_b32 v217, v218
    s_nop 0
    v_max_f32 v217, v217, v218
    v_add_f32 v217, 0x41c00000, v217
    v_max_f32 v217, 0, v217
    v_ceil_f32 v217, v217
    v_sub_f32 v219, 0, v217
    v_exp_f32 v219, v219
    v_sub_f32 v236, v236, v217
    v_sub_f32 v237, v237, v217
    v_sub_f32 v238, v238, v217
    v_sub_f32 v239, v239, v217
    v_sub_f32 v132, v132, v217
    v_sub_f32 v133, v133, v217
    v_sub_f32 v134, v134, v217
    v_sub_f32 v135, v135, v217
    v_sub_f32 v140, v140, v217
    v_sub_f32 v141, v141, v217
    v_sub_f32 v142, v142, v217
    v_sub_f32 v143, v143, v217
    v_sub_f32 v148, v148, v217
    v_sub_f32 v149, v149, v217
    v_sub_f32 v150, v150, v217
    v_sub_f32 v151, v151, v217
    v_sub_f32 v156, v156, v217
    v_sub_f32 v157, v157, v217
    v_sub_f32 v158, v158, v217
    v_sub_f32 v159, v159, v217
    ds_bpermute_b32 v221, v220, v219 offset:0
    ds_bpermute_b32 v222, v220, v219 offset:4
    ds_bpermute_b32 v223, v220, v219 offset:8
    ds_bpermute_b32 v224, v220, v219 offset:12
    v_lshlrev_b32 v225, 16, v172
    v_and_b32 v226, 0xffff0000, v172
    v_mul_f32 v225, v225, v219
    v_mul_f32 v226, v226, v219
    v_cvt_pk_bf16_f32 v172, v225, v226
    v_lshlrev_b32 v225, 16, v173
    v_and_b32 v226, 0xffff0000, v173
    v_mul_f32 v225, v225, v219
    v_mul_f32 v226, v226, v219
    v_cvt_pk_bf16_f32 v173, v225, v226
    v_lshlrev_b32 v225, 16, v174
    v_and_b32 v226, 0xffff0000, v174
    v_mul_f32 v225, v225, v219
    v_mul_f32 v226, v226, v219
    v_cvt_pk_bf16_f32 v174, v225, v226
    v_lshlrev_b32 v225, 16, v175
    v_and_b32 v226, 0xffff0000, v175
    v_mul_f32 v225, v225, v219
    v_mul_f32 v226, v226, v219
    v_cvt_pk_bf16_f32 v175, v225, v226
    v_lshlrev_b32 v225, 16, v164
    v_and_b32 v226, 0xffff0000, v164
    v_mul_f32 v225, v225, v219
    v_mul_f32 v226, v226, v219
    v_cvt_pk_bf16_f32 v164, v225, v226
    v_lshlrev_b32 v225, 16, v165
    v_and_b32 v226, 0xffff0000, v165
    v_mul_f32 v225, v225, v219
    v_mul_f32 v226, v226, v219
    v_cvt_pk_bf16_f32 v165, v225, v226
    v_lshlrev_b32 v225, 16, v166
    v_and_b32 v226, 0xffff0000, v166
    v_mul_f32 v225, v225, v219
    v_mul_f32 v226, v226, v219
    v_cvt_pk_bf16_f32 v166, v225, v226
    v_lshlrev_b32 v225, 16, v167
    v_and_b32 v226, 0xffff0000, v167
    v_mul_f32 v225, v225, v219
    v_mul_f32 v226, v226, v219
    v_cvt_pk_bf16_f32 v167, v225, v226
    s_waitcnt lgkmcnt(0)
    v_mul_f32 v204, v204, v221
    v_mul_f32 v205, v205, v222
    v_mul_f32 v206, v206, v223
    v_mul_f32 v207, v207, v224
    v_mul_f32 v64, v64, v221
    v_mul_f32 v65, v65, v222
    v_mul_f32 v66, v66, v223
    v_mul_f32 v67, v67, v224
    v_mul_f32 v68, v68, v221
    v_mul_f32 v69, v69, v222
    v_mul_f32 v70, v70, v223
    v_mul_f32 v71, v71, v224
    v_mul_f32 v72, v72, v221
    v_mul_f32 v73, v73, v222
    v_mul_f32 v74, v74, v223
    v_mul_f32 v75, v75, v224
    v_mul_f32 v76, v76, v221
    v_mul_f32 v77, v77, v222
    v_mul_f32 v78, v78, v223
    v_mul_f32 v79, v79, v224
    v_mul_f32 v80, v80, v221
    v_mul_f32 v81, v81, v222
    v_mul_f32 v82, v82, v223
    v_mul_f32 v83, v83, v224
    v_mul_f32 v84, v84, v221
    v_mul_f32 v85, v85, v222
    v_mul_f32 v86, v86, v223
    v_mul_f32 v87, v87, v224
    v_mul_f32 v88, v88, v221
    v_mul_f32 v89, v89, v222
    v_mul_f32 v90, v90, v223
    v_mul_f32 v91, v91, v224
    v_mul_f32 v92, v92, v221
    v_mul_f32 v93, v93, v222
    v_mul_f32 v94, v94, v223
    v_mul_f32 v95, v95, v224
    v_mul_f32 v96, v96, v221
    v_mul_f32 v97, v97, v222
    v_mul_f32 v98, v98, v223
    v_mul_f32 v99, v99, v224
    v_mul_f32 v100, v100, v221
    v_mul_f32 v101, v101, v222
    v_mul_f32 v102, v102, v223
    v_mul_f32 v103, v103, v224
    v_mul_f32 v104, v104, v221
    v_mul_f32 v105, v105, v222
    v_mul_f32 v106, v106, v223
    v_mul_f32 v107, v107, v224
    v_mul_f32 v108, v108, v221
    v_mul_f32 v109, v109, v222
    v_mul_f32 v110, v110, v223
    v_mul_f32 v111, v111, v224
    v_mul_f32 v112, v112, v221
    v_mul_f32 v113, v113, v222
    v_mul_f32 v114, v114, v223
    v_mul_f32 v115, v115, v224
    v_mul_f32 v116, v116, v221
    v_mul_f32 v117, v117, v222
    v_mul_f32 v118, v118, v223
    v_mul_f32 v119, v119, v224
    v_mul_f32 v120, v120, v221
    v_mul_f32 v121, v121, v222
    v_mul_f32 v122, v122, v223
    v_mul_f32 v123, v123, v224
    v_mul_f32 v124, v124, v221
    v_mul_f32 v125, v125, v222
    v_mul_f32 v126, v126, v223
    v_mul_f32 v127, v127, v224
    v_exp_f32 v208, v144
    s_nop 0
    v_exp_f32 v209, v145
    s_nop 0
    v_exp_f32 v210, v146
    s_nop 0
    v_cvt_pk_bf16_f32 v240, v208, v209
    v_exp_f32 v211, v147
    s_nop 0
    v_exp_f32 v212, v152
    s_nop 0
    v_cvt_pk_bf16_f32 v241, v210, v211
    v_exp_f32 v213, v153
    s_nop 0
    v_exp_f32 v214, v154
    s_nop 0
    v_cvt_pk_bf16_f32 v242, v212, v213
    v_exp_f32 v215, v155
    s_nop 0
    v_exp_f32 v208, v148
    s_nop 0
    v_cvt_pk_bf16_f32 v243, v214, v215
    v_or3_b32 v197, v240, v241, v242
    v_exp_f32 v209, v149
    s_nop 0
    v_exp_f32 v210, v150
    s_nop 0
    v_cvt_pk_bf16_f32 v244, v208, v209
    v_exp_f32 v211, v151
    s_nop 0
    v_exp_f32 v212, v156
    s_nop 0
    v_cvt_pk_bf16_f32 v245, v210, v211
    v_or3_b32 v197, v197, v243, v244
    v_exp_f32 v213, v157
    s_nop 0
    v_exp_f32 v214, v158
    s_nop 0
    v_cvt_pk_bf16_f32 v246, v212, v213
    v_exp_f32 v215, v159
    s_nop 0
    v_or3_b32 v197, v197, v245, v246
    v_cvt_pk_bf16_f32 v247, v214, v215
    v_or_b32 v197, v197, v247
    v_and_b32 v197, s48, v197
    v_cmp_ne_u32 vcc, 0, v197
    s_nop 1
    s_branch L_fback3_2
L_frare3_3:
    s_nop 7
    v_and_b32 v220, 48, v216
    v_max3_f32 v217, v128, v129, v130
    v_max3_f32 v217, v217, v131, v136
    v_max3_f32 v217, v217, v137, v138
    v_max_f32 v217, v217, v139
    v_mov_b32 v218, v217
    s_nop 1
    v_permlane32_swap_b32 v217, v218
    s_nop 0
    v_max_f32 v217, v217, v218
    v_mov_b32 v218, v217
    s_nop 1
    v_permlane16_swap_b32 v217, v218
    s_nop 0
    v_max_f32 v217, v217, v218
    v_add_f32 v217, 0x41c00000, v217
    v_max_f32 v217, 0, v217
    v_ceil_f32 v217, v217
    v_sub_f32 v219, 0, v217
    v_exp_f32 v219, v219
    v_sub_f32 v232, v232, v217
    v_sub_f32 v233, v233, v217
    v_sub_f32 v234, v234, v217
    v_sub_f32 v235, v235, v217
    v_sub_f32 v128, v128, v217
    v_sub_f32 v129, v129, v217
    v_sub_f32 v130, v130, v217
    v_sub_f32 v131, v131, v217
    v_sub_f32 v136, v136, v217
    v_sub_f32 v137, v137, v217
    v_sub_f32 v138, v138, v217
    v_sub_f32 v139, v139, v217
    v_sub_f32 v144, v144, v217
    v_sub_f32 v145, v145, v217
    v_sub_f32 v146, v146, v217
    v_sub_f32 v147, v147, v217
    v_sub_f32 v152, v152, v217
    v_sub_f32 v153, v153, v217
    v_sub_f32 v154, v154, v217
    v_sub_f32 v155, v155, v217
    ds_bpermute_b32 v221, v220, v219 offset:0
    ds_bpermute_b32 v222, v220, v219 offset:4
    ds_bpermute_b32 v223, v220, v219 offset:8
    ds_bpermute_b32 v224, v220, v219 offset:12
    v_lshlrev_b32 v225, 16, v168
    v_and_b32 v226, 0xffff0000, v168
    v_mul_f32 v225, v225, v219
    v_mul_f32 v226, v226, v219
    v_cvt_pk_bf16_f32 v168, v225, v226
    v_lshlrev_b32 v225, 16, v169
    v_and_b32 v226, 0xffff0000, v169
    v_mul_f32 v225, v225, v219
    v_mul_f32 v226, v226, v219
    v_cvt_pk_bf16_f32 v169, v225, v226
    v_lshlrev_b32 v225, 16, v170
    v_and_b32 v226, 0xffff0000, v170
    v_mul_f32 v225, v225, v219
    v_mul_f32 v226, v226, v219
    v_cvt_pk_bf16_f32 v170, v225, v226
    v_lshlrev_b32 v225, 16, v171
    v_and_b32 v226, 0xffff0000, v171
    v_mul_f32 v225, v225, v219
    v_mul_f32 v226, v226, v219
    v_cvt_pk_bf16_f32 v171, v225, v226
    v_lshlrev_b32 v225, 16, v160
    v_and_b32 v226, 0xffff0000, v160
    v_mul_f32 v225, v225, v219
    v_mul_f32 v226, v226, v219
    v_cvt_pk_bf16_f32 v160, v225, v226
    v_lshlrev_b32 v225, 16, v161
    v_and_b32 v226, 0xffff0000, v161
    v_mul_f32 v225, v225, v219
    v_mul_f32 v226, v226, v219
    v_cvt_pk_bf16_f32 v161, v225, v226
    v_lshlrev_b32 v225, 16, v162
    v_and_b32 v226, 0xffff0000, v162
    v_mul_f32 v225, v225, v219
    v_mul_f32 v226, v226, v219
    v_cvt_pk_bf16_f32 v162, v225, v226
    v_lshlrev_b32 v225, 16, v163
    v_and_b32 v226, 0xffff0000, v163
    v_mul_f32 v225, v225, v219
    v_mul_f32 v226, v226, v219
    v_cvt_pk_bf16_f32 v163, v225, v226
    v_lshlrev_b32 v225, 16, v240
    v_and_b32 v226, 0xffff0000, v240
    v_mul_f32 v225, v225, v219
    v_mul_f32 v226, v226, v219
    v_cvt_pk_bf16_f32 v240, v225, v226
    v_lshlrev_b32 v225, 16, v241
    v_and_b32 v226, 0xffff0000, v241
    v_mul_f32 v225, v225, v219
    v_mul_f32 v226, v226, v219
    v_cvt_pk_bf16_f32 v241, v225, v226
    v_lshlrev_b32 v225, 16, v242
    v_and_b32 v226, 0xffff0000, v242
    v_mul_f32 v225, v225, v219
    v_mul_f32 v226, v226, v219
    v_cvt_pk_bf16_f32 v242, v225, v226
    v_lshlrev_b32 v225, 16, v243
    v_and_b32 v226, 0xffff0000, v243
    v_mul_f32 v225, v225, v219
    v_mul_f32 v226, v226, v219
    v_cvt_pk_bf16_f32 v243, v225, v226
    s_waitcnt lgkmcnt(0)
    v_mul_f32 v200, v200, v221
    v_mul_f32 v201, v201, v222
    v_mul_f32 v202, v202, v223
    v_mul_f32 v203, v203, v224
    v_mul_f32 v0, v0, v221
    v_mul_f32 v1, v1, v222
    v_mul_f32 v2, v2, v223
    v_mul_f32 v3, v3, v224
    v_mul_f32 v4, v4, v221
    v_mul_f32 v5, v5, v222
    v_mul_f32 v6, v6, v223
    v_mul_f32 v7, v7, v224
    v_mul_f32 v8, v8, v221
    v_mul_f32 v9, v9, v222
    v_mul_f32 v10, v10, v223
    v_mul_f32 v11, v11, v224
    v_mul_f32 v12, v12, v221
    v_mul_f32 v13, v13, v222
    v_mul_f32 v14, v14, v223
    v_mul_f32 v15, v15, v224
    v_mul_f32 v16, v16, v221
    v_mul_f32 v17, v17, v222
    v_mul_f32 v18, v18, v223
    v_mul_f32 v19, v19, v224
    v_mul_f32 v20, v20, v221
    v_mul_f32 v21, v21, v222
    v_mul_f32 v22, v22, v223
    v_mul_f32 v23, v23, v224
    v_mul_f32 v24, v24, v221
    v_mul_f32 v25, v25, v222
    v_mul_f32 v26, v26, v223
    v_mul_f32 v27, v27, v224
    v_mul_f32 v28, v28, v221
    v_mul_f32 v29, v29, v222
    v_mul_f32 v30, v30, v223
    v_mul_f32 v31, v31, v224
    v_mul_f32 v32, v32, v221
    v_mul_f32 v33, v33, v222
    v_mul_f32 v34, v34, v223
    v_mul_f32 v35, v35, v224
    v_mul_f32 v36, v36, v221
    v_mul_f32 v37, v37, v222
    v_mul_f32 v38, v38, v223
    v_mul_f32 v39, v39, v224
    v_mul_f32 v40, v40, v221
    v_mul_f32 v41, v41, v222
    v_mul_f32 v42, v42, v223
    v_mul_f32 v43, v43, v224
    v_mul_f32 v44, v44, v221
    v_mul_f32 v45, v45, v222
    v_mul_f32 v46, v46, v223
    v_mul_f32 v47, v47, v224
    v_mul_f32 v48, v48, v221
    v_mul_f32 v49, v49, v222
    v_mul_f32 v50, v50, v223
    v_mul_f32 v51, v51, v224
    v_mul_f32 v52, v52, v221
    v_mul_f32 v53, v53, v222
    v_mul_f32 v54, v54, v223
    v_mul_f32 v55, v55, v224
    v_mul_f32 v56, v56, v221
    v_mul_f32 v57, v57, v222
    v_mul_f32 v58, v58, v223
    v_mul_f32 v59, v59, v224
    v_mul_f32 v60, v60, v221
    v_mul_f32 v61, v61, v222
    v_mul_f32 v62, v62, v223
    v_mul_f32 v63, v63, v224
    v_max3_f32 v217, v132, v133, v134
    v_max3_f32 v217, v217, v135, v140
    v_max3_f32 v217, v217, v141, v142
    v_max_f32 v217, v217, v143
    v_mov_b32 v218, v217
    s_nop 1
    v_permlane32_swap_b32 v217, v218
    s_nop 0
    v_max_f32 v217, v217, v218
    v_mov_b32 v218, v217
    s_nop 1
    v_permlane16_swap_b32 v217, v218
    s_nop 0
    v_max_f32 v217, v217, v218
    v_add_f32 v217, 0x41c00000, v217
    v_max_f32 v217, 0, v217
    v_ceil_f32 v217, v217
    v_sub_f32 v219, 0, v217
    v_exp_f32 v219, v219
    v_sub_f32 v236, v236, v217
    v_sub_f32 v237, v237, v217
    v_sub_f32 v238, v238, v217
    v_sub_f32 v239, v239, v217
    v_sub_f32 v132, v132, v217
    v_sub_f32 v133, v133, v217
    v_sub_f32 v134, v134, v217
    v_sub_f32 v135, v135, v217
    v_sub_f32 v140, v140, v217
    v_sub_f32 v141, v141, v217
    v_sub_f32 v142, v142, v217
    v_sub_f32 v143, v143, v217
    v_sub_f32 v148, v148, v217
    v_sub_f32 v149, v149, v217
    v_sub_f32 v150, v150, v217
    v_sub_f32 v151, v151, v217
    v_sub_f32 v156, v156, v217
    v_sub_f32 v157, v157, v217
    v_sub_f32 v158, v158, v217
    v_sub_f32 v159, v159, v217
    ds_bpermute_b32 v221, v220, v219 offset:0
    ds_bpermute_b32 v222, v220, v219 offset:4
    ds_bpermute_b32 v223, v220, v219 offset:8
    ds_bpermute_b32 v224, v220, v219 offset:12
    v_lshlrev_b32 v225, 16, v172
    v_and_b32 v226, 0xffff0000, v172
    v_mul_f32 v225, v225, v219
    v_mul_f32 v226, v226, v219
    v_cvt_pk_bf16_f32 v172, v225, v226
    v_lshlrev_b32 v225, 16, v173
    v_and_b32 v226, 0xffff0000, v173
    v_mul_f32 v225, v225, v219
    v_mul_f32 v226, v226, v219
    v_cvt_pk_bf16_f32 v173, v225, v226
    v_lshlrev_b32 v225, 16, v174
    v_and_b32 v226, 0xffff0000, v174
    v_mul_f32 v225, v225, v219
    v_mul_f32 v226, v226, v219
    v_cvt_pk_bf16_f32 v174, v225, v226
    v_lshlrev_b32 v225, 16, v175
    v_and_b32 v226, 0xffff0000, v175
    v_mul_f32 v225, v225, v219
    v_mul_f32 v226, v226, v219
    v_cvt_pk_bf16_f32 v175, v225, v226
    v_lshlrev_b32 v225, 16, v164
    v_and_b32 v226, 0xffff0000, v164
    v_mul_f32 v225, v225, v219
    v_mul_f32 v226, v226, v219
    v_cvt_pk_bf16_f32 v164, v225, v226
    v_lshlrev_b32 v225, 16, v165
    v_and_b32 v226, 0xffff0000, v165
    v_mul_f32 v225, v225, v219
    v_mul_f32 v226, v226, v219
    v_cvt_pk_bf16_f32 v165, v225, v226
    v_lshlrev_b32 v225, 16, v166
    v_and_b32 v226, 0xffff0000, v166
    v_mul_f32 v225, v225, v219
    v_mul_f32 v226, v226, v219
    v_cvt_pk_bf16_f32 v166, v225, v226
    v_lshlrev_b32 v225, 16, v167
    v_and_b32 v226, 0xffff0000, v167
    v_mul_f32 v225, v225, v219
    v_mul_f32 v226, v226, v219
    v_cvt_pk_bf16_f32 v167, v225, v226
    v_lshlrev_b32 v225, 16, v244
    v_and_b32 v226, 0xffff0000, v244
    v_mul_f32 v225, v225, v219
    v_mul_f32 v226, v226, v219
    v_cvt_pk_bf16_f32 v244, v225, v226
    v_lshlrev_b32 v225, 16, v245
    v_and_b32 v226, 0xffff0000, v245
    v_mul_f32 v225, v225, v219
    v_mul_f32 v226, v226, v219
    v_cvt_pk_bf16_f32 v245, v225, v226
    v_lshlrev_b32 v225, 16, v246
    v_and_b32 v226, 0xffff0000, v246
    v_mul_f32 v225, v225, v219
    v_mul_f32 v226, v226, v219
    v_cvt_pk_bf16_f32 v246, v225, v226
    v_lshlrev_b32 v225, 16, v247
    v_and_b32 v226, 0xffff0000, v247
    v_mul_f32 v225, v225, v219
    v_mul_f32 v226, v226, v219
    v_cvt_pk_bf16_f32 v247, v225, v226
    s_waitcnt lgkmcnt(0)
    v_mul_f32 v204, v204, v221
    v_mul_f32 v205, v205, v222
    v_mul_f32 v206, v206, v223
    v_mul_f32 v207, v207, v224
    v_mul_f32 v64, v64, v221
    v_mul_f32 v65, v65, v222
    v_mul_f32 v66, v66, v223
    v_mul_f32 v67, v67, v224
    v_mul_f32 v68, v68, v221
    v_mul_f32 v69, v69, v222
    v_mul_f32 v70, v70, v223
    v_mul_f32 v71, v71, v224
    v_mul_f32 v72, v72, v221
    v_mul_f32 v73, v73, v222
    v_mul_f32 v74, v74, v223
    v_mul_f32 v75, v75, v224
    v_mul_f32 v76, v76, v221
    v_mul_f32 v77, v77, v222
    v_mul_f32 v78, v78, v223
    v_mul_f32 v79, v79, v224
    v_mul_f32 v80, v80, v221
    v_mul_f32 v81, v81, v222
    v_mul_f32 v82, v82, v223
    v_mul_f32 v83, v83, v224
    v_mul_f32 v84, v84, v221
    v_mul_f32 v85, v85, v222
    v_mul_f32 v86, v86, v223
    v_mul_f32 v87, v87, v224
    v_mul_f32 v88, v88, v221
    v_mul_f32 v89, v89, v222
    v_mul_f32 v90, v90, v223
    v_mul_f32 v91, v91, v224
    v_mul_f32 v92, v92, v221
    v_mul_f32 v93, v93, v222
    v_mul_f32 v94, v94, v223
    v_mul_f32 v95, v95, v224
    v_mul_f32 v96, v96, v221
    v_mul_f32 v97, v97, v222
    v_mul_f32 v98, v98, v223
    v_mul_f32 v99, v99, v224
    v_mul_f32 v100, v100, v221
    v_mul_f32 v101, v101, v222
    v_mul_f32 v102, v102, v223
    v_mul_f32 v103, v103, v224
    v_mul_f32 v104, v104, v221
    v_mul_f32 v105, v105, v222
    v_mul_f32 v106, v106, v223
    v_mul_f32 v107, v107, v224
    v_mul_f32 v108, v108, v221
    v_mul_f32 v109, v109, v222
    v_mul_f32 v110, v110, v223
    v_mul_f32 v111, v111, v224
    v_mul_f32 v112, v112, v221
    v_mul_f32 v113, v113, v222
    v_mul_f32 v114, v114, v223
    v_mul_f32 v115, v115, v224
    v_mul_f32 v116, v116, v221
    v_mul_f32 v117, v117, v222
    v_mul_f32 v118, v118, v223
    v_mul_f32 v119, v119, v224
    v_mul_f32 v120, v120, v221
    v_mul_f32 v121, v121, v222
    v_mul_f32 v122, v122, v223
    v_mul_f32 v123, v123, v224
    v_mul_f32 v124, v124, v221
    v_mul_f32 v125, v125, v222
    v_mul_f32 v126, v126, v223
    v_mul_f32 v127, v127, v224
    v_exp_f32 v208, v128
    s_nop 0
    v_exp_f32 v209, v129
    s_nop 0
    v_exp_f32 v210, v130
    s_nop 0
    v_cvt_pk_bf16_f32 v248, v208, v209
    v_exp_f32 v211, v131
    s_nop 0
    v_exp_f32 v212, v136
    s_nop 0
    v_cvt_pk_bf16_f32 v249, v210, v211
    v_exp_f32 v213, v137
    s_nop 0
    v_exp_f32 v214, v138
    s_nop 0
    v_cvt_pk_bf16_f32 v250, v212, v213
    v_exp_f32 v215, v139
    s_nop 0
    v_exp_f32 v208, v132
    s_nop 0
    v_cvt_pk_bf16_f32 v251, v214, v215
    v_or3_b32 v197, v248, v249, v250
    v_exp_f32 v209, v133
    s_nop 0
    v_exp_f32 v210, v134
    s_nop 0
    v_cvt_pk_bf16_f32 v252, v208, v209
    v_exp_f32 v211, v135
    s_nop 0
    v_exp_f32 v212, v140
    s_nop 0
    v_cvt_pk_bf16_f32 v253, v210, v211
    v_or3_b32 v197, v197, v251, v252
    v_exp_f32 v213, v141
    s_nop 0
    v_exp_f32 v214, v142
    s_nop 0
    v_cvt_pk_bf16_f32 v254, v212, v213
    v_exp_f32 v215, v143
    s_nop 0
    v_or3_b32 v197, v197, v253, v254
    v_cvt_pk_bf16_f32 v255, v214, v215
    v_or_b32 v197, v197, v255
    v_and_b32 v197, s48, v197
    v_cmp_ne_u32 vcc, 0, v197
    s_nop 1
    s_branch L_fback3_3
.section .rodata,"a"
.p2align 6
.amdhsa_kernel standalone__paged_block_table_kv_pagedattention__prompt_kernel
  .amdhsa_next_free_vgpr 404
  .amdhsa_next_free_sgpr 102
  .amdhsa_accum_offset 256
  .amdhsa_group_segment_fixed_size 0
  .amdhsa_kernarg_size 64
  .amdhsa_user_sgpr_count 2
  .amdhsa_user_sgpr_kernarg_segment_ptr 1
  .amdhsa_system_sgpr_workgroup_id_x 1
.end_amdhsa_kernel
```
